```python
import torch

def _softmax(x, axis=-1):
    return torch.softmax(x, dim=axis)
def _gelu(x):
    return torch.nn.functional.gelu(x, approximate="tanh")
def _silu(x):
    return torch.nn.functional.silu(x)
def _sigmoid(x):
    return torch.sigmoid(x)
def _layernorm(x, axis=-1, eps=1e-5):
    m = x.mean(dim=axis, keepdim=True)
    v = x.var(dim=axis, keepdim=True, unbiased=False)
    return (x - m) / torch.sqrt(v + eps)
def _scatter_add(tgt, idx, src, axis=0):
    return tgt.clone().index_add_(axis, idx, src)
def _segment_sum(src, seg, n):
    out = torch.zeros((n,) + src.shape[1:], dtype=src.dtype)
    return out.index_add_(0, seg, src)
def _pad(x, pw):
    flat = tuple(v for pair in reversed(pw) for v in pair)
    return torch.nn.functional.pad(x, flat)

kernel_name = 'interleave_layers__sliding_local_dilated__linear_kernel_hedgehog__prompt'

def setup_inputs():

    _w = (lambda a: (lambda t: t.to(torch.bfloat16) if t.is_floating_point() else t)(torch.as_tensor(a)))
    def _A_setup():
        B, S, D = 1, 2048, 448
        return {
            "x": _w((lambda *s: torch.randn(*s, dtype=torch.bfloat16) * 0.05)(B, S, D)),
            "wqkv": _w((lambda *s: torch.randn(*s, dtype=torch.bfloat16) * 0.05)(D, 3 * D)),
            "wo": _w((lambda *s: torch.randn(*s, dtype=torch.bfloat16) * 0.05)(D, D)),
        }
    _A_in = _A_setup()

    def _B_setup():
        B, S, D, H = 1, 2048, 448, 16
        Dh = D // H
        return {
            "x": _w((lambda *s: torch.randn(*s, dtype=torch.bfloat16) * 0.05)(B, S, D)),
            "wqkv": _w((lambda *s: torch.randn(*s, dtype=torch.bfloat16) * 0.4)(D, 3 * D)),
            "w_phi": _w((lambda *s: torch.randn(*s, dtype=torch.bfloat16) * 0.4)(H, Dh, Dh) * (Dh ** -0.5)),
            "wo": _w((lambda *s: torch.randn(*s, dtype=torch.bfloat16) * 0.1)(D, D)),
        }
    _B_in = _B_setup()

    return {
        "A_x": _A_in["x"],
        "A_wqkv": _A_in["wqkv"],
        "A_wo": _A_in["wo"],
        "B_x": _B_in["x"],
        "B_wqkv": _B_in["wqkv"],
        "B_w_phi": _B_in["w_phi"],
        "B_wo": _B_in["wo"],
    }

def reference(A_x, A_wqkv, A_wo, B_x, B_wqkv, B_w_phi, B_wo):
    def _A_ref(x, wqkv, wo):
        B, S, D = x.shape
        H = 16; Dh = D // H
        W, dil = 8, 2
        qkv = (lambda x, *d: x.permute(*d))((x @ wqkv).reshape(B, S, 3, H, Dh), 2, 0, 3, 1, 4)
        q, k, v = qkv[0], qkv[1], qkv[2]
        scale = Dh ** -0.5
        pos = torch.arange(S)
        off = torch.arange(W) * dil
        idx = pos[:, None] - off[None, :]
        mask = idx >= 0
        idx_c = torch.where(mask, idx, 0).reshape(-1)
        kg = k[:, :, idx_c, :].reshape(B, H, S, W, Dh)
        vg = v[:, :, idx_c, :].reshape(B, H, S, W, Dh)
        logits = torch.einsum("bhsd,bhswd->bhsw", q, kg) * scale
        logits = torch.where(mask[None, None, :, :], logits, -1e9)
        attn = _softmax(logits, axis=-1)
        o = torch.einsum("bhsw,bhswd->bhsd", attn, vg)
        return (lambda x, *d: x.permute(*d))(o, 0, 2, 1, 3).reshape(B, S, D) @ wo

    def _B_ref(x, wqkv, w_phi, wo):
        B, S, D = x.shape
        H = 16; Dh = D // H
        qkv = (lambda x, *d: x.permute(*d))((x @ wqkv).reshape(B, S, 3, H, Dh), 2, 0, 3, 1, 4)
        q, k, v = qkv[0], qkv[1], qkv[2]
        pq = torch.einsum("bhsd,hdf->bhsf", q, w_phi)
        pk = torch.einsum("bhsd,hdf->bhsf", k, w_phi)
        phi_q = torch.concatenate([_softmax(pq, axis=-1), _softmax(-pq, axis=-1)], axis=-1)
        phi_k = torch.concatenate([_softmax(pk, axis=-1), _softmax(-pk, axis=-1)], axis=-1)
        kv = torch.einsum("bhsf,bhsd->bhfd", phi_k, v)
        z  = torch.einsum("bhsf->bhf", phi_k)
        num = torch.einsum("bhqf,bhfd->bhqd", phi_q, kv)
        den = torch.einsum("bhqf,bhf->bhq", phi_q, z)[..., None] + 1e-6
        o = num / den
        return (lambda x, *d: x.permute(*d))(o, 0, 2, 1, 3).reshape(B, S, D) @ wo

    x = A_x
    x = x + _A_ref(_layernorm(x, axis=-1), A_wqkv, A_wo)
    x = x + _B_ref(_layernorm(x, axis=-1), B_wqkv, B_w_phi, B_wo)
    x = x + _A_ref(_layernorm(x, axis=-1), A_wqkv, A_wo)
    x = x + _B_ref(_layernorm(x, axis=-1), B_wqkv, B_w_phi, B_wo)
    return x
```

```asm
; @launch grid=(256,1,1) block=(256,1,1) lds=163840
.amdgcn_target "amdgcn-amd-amdhsa--gfx950"
.text
.globl interleave_layers__sliding_local_dilated__linear_kernel_hedgehog__prompt_kernel
.p2align 8
.type interleave_layers__sliding_local_dilated__linear_kernel_hedgehog__prompt_kernel,@function
interleave_layers__sliding_local_dilated__linear_kernel_hedgehog__prompt_kernel:
    s_cmp_ge_u32 s2, 0x100
    s_cbranch_scc1 L_end
    s_load_dwordx2 s[28:29], s[0:1], 8
    s_load_dwordx2 s[24:25], s[0:1], 0
    s_getpc_b64 s[16:17]
L_pc:
    v_lshrrev_b32_e64 v2, 6, v0
    v_and_b32 v0, 63, v0
    v_readfirstlane_b32 s7, v2
    v_lshlrev_b32 v1, 4, v0
    s_lshr_b32 s12, s2, 3
    s_lshl_b32 s12, s12, 2
    s_add_u32 s15, s12, s7
    v_lshl_add_u32 v2, s15, 10, v1
    v_min_u32 v2, L_code_end-L_pc-16, v2
    global_load_dwordx4 v[252:255], v2, s[16:17]
    s_and_b32 s4, s2, 7
    s_bfe_u32 s5, s2, 0x10003
    s_lshr_b32 s6, s2, 4
    s_mul_i32 s14, s6, 56
    s_and_b32 s14, s14, -16
    v_lshrrev_b32 v236, 2, v0
    v_and_b32 v238, 48, v1
    v_mul_u32_u24 v22, 2688, v236
    v_add3_u32 v22, v22, v238, s14
    s_lshl_b32 s59, s7, 10
    s_add_u32 s59, s59, 57344
    s_mul_i32 s60, s7, 43008
    s_cmp_eq_u32 s4, 7
    s_cselect_b32 s76, 0, s4
    s_sub_u32 s77, s76, 1
    s_add_u32 s77, s77, 1
    s_cmp_eq_u32 s77, 7
    s_cselect_b32 s77, 0, s77
    s_lshl_b32 s78, s77, 12
    s_add_u32 s78, s78, s59
    s_mul_i32 s79, s77, 172032
    s_add_u32 s79, s79, s60
    s_lshl_b32 s80, s77, 7
    s_mov_b32 s30, 1204224
    s_mov_b32 s31, 0x20000
    s_waitcnt lgkmcnt(0)
    s_add_u32 m0, s78, 0
    s_add_u32 s69, s79, 0
    buffer_load_dwordx4 v22, s[28:31], s69 offen lds
    s_add_u32 m0, s78, 28672
    s_add_u32 s69, s79, 896
    buffer_load_dwordx4 v22, s[28:31], s69 offen lds
    s_add_u32 m0, s78, 57344
    s_add_u32 s69, s79, 1792
    buffer_load_dwordx4 v22, s[28:31], s69 offen lds
    s_load_dwordx2 s[52:53], s[0:1], 72
    s_load_dwordx2 s[32:33], s[0:1], 16
    s_load_dwordx2 s[36:37], s[0:1], 32
    s_load_dwordx2 s[40:41], s[0:1], 40
    s_load_dwordx2 s[44:45], s[0:1], 48
    s_load_dwordx2 s[48:49], s[0:1], 56
    s_mov_b32 s26, 1835008
    s_mov_b32 s27, 0x20000
    s_lshl_b32 s12, s4, 8
    s_add_u32 s12, s12, s5
    s_lshl_b32 s13, s7, 6
    s_add_u32 s13, s13, s12
    s_mul_i32 s13, s13, 896
    v_lshrrev_b32 v237, 4, v0
    v_xor_b32 v237, v237, v0
    v_and_b32 v237, 7, v237
    v_lshrrev_b32 v234, 3, v0
    v_mul_u32_u24 v234, 1792, v234
    v_lshl_add_u32 v232, v237, 4, v234
    v_add_u32 v232, s13, v232
    v_xor_b32 v235, 64, v232
    s_mul_i32 s58, s7, 14336
    s_add_u32 m0, s58, 0
    s_add_u32 s69, s80, 0
    buffer_load_dwordx4 v232, s[24:27], s69 offen lds
    s_add_u32 m0, s58, 1024
    s_add_u32 s69, s80, 14336
    buffer_load_dwordx4 v235, s[24:27], s69 offen lds
    s_add_u32 m0, s58, 2048
    s_add_u32 s69, s80, 28672
    buffer_load_dwordx4 v232, s[24:27], s69 offen lds
    s_add_u32 m0, s58, 3072
    s_add_u32 s69, s80, 43008
    buffer_load_dwordx4 v235, s[24:27], s69 offen lds
    s_mov_b32 s17, s15
    s_lshl_b32 s13, s6, 2
    s_add_u32 s13, s13, s7
    s_lshl_b32 s13, s13, 2
    s_add_u32 s13, s13, s12
    s_mul_i32 s13, s13, 896
    v_add_u32 v120, s13, v1
    v_mov_b32 v112, 0
    v_mov_b32 v113, 0
    v_mov_b32 v114, 0
    v_mov_b32 v115, 0
    v_mov_b32 v116, 0
    v_mov_b32 v117, 0
    v_mov_b32_e64 v118, 0
    v_mov_b32 v119, 0
    s_bfm_b64 exec, 56, 0
    buffer_load_dwordx4 v[112:115], v120, s[24:27], 0 offen
    buffer_load_dwordx4 v[116:119], v120, s[24:27], 0 offen offset:1792
    s_mov_b64 exec, -1
    v_lshrrev_b32 v91, 3, v0
    v_mul_u32_u24 v91, 768, v91
    v_lshl_add_u32 v91, v0, 7, v91
    v_add_u32_e64 v91, s13, v91
    s_mov_b32 s54, 268435456
    s_mov_b32 s55, 0x20000
    s_mov_b32 s34, 401408
    s_mov_b32 s35, 0x20000
    s_mov_b32 s38, 1204224
    s_mov_b32 s39, 0x20000
    s_mov_b32 s42, 25088
    s_mov_b32 s43, 0x20000
    s_mov_b32 s46, 401408
    s_mov_b32 s47, 0x20000
    s_mov_b32 s50, 1835008
    s_mov_b32 s51, 0x20000
    s_lshl_b32 s8, s4, 1
    s_or_b32 s8, s8, s5
    s_lshr_b32 s57, s6, 1
    s_mul_i32 s68, s7, 100352
    s_waitcnt lgkmcnt(0)
    buffer_load_dword v30, off, s[52:55], 0 sc1
    s_sub_i32 s13, s12, 16
    s_max_i32 s13, s13, 0
    s_mul_i32 s13, s13, 896
    s_lshl_b32 s14, s7, 8
    s_add_u32 s13, s13, s14
    v_and_b32_e64 v233, 7, v236
    v_mul_u32_u24 v233, 1792, v233
    v_add3_u32 v233, v233, v238, s13
    v_lshrrev_b32_e64 v238, 5, v0
    v_lshl_add_u32 v233, v238, 6, v233
    s_lshl_b32 s3, s7, 11
    s_and_b32 s23, s6, 1
    s_lshl_b32 s23, s23, 1
    s_lshr_b32 s13, s7, 1
    s_add_u32 s23, s23, s13
    s_lshl_b32 s13, s23, 1
    s_and_b32 s14, s7, 1
    s_add_u32 s13, s13, s14
    s_lshl_b32 s13, s13, 5
    s_add_u32 s13, s13, s12
    s_mul_i32 s13, s13, 896
    s_lshl_b32 s14, s57, 7
    s_add_u32 s16, s13, s14
    v_and_b32 v238, 0x70, v1
    v_add3_u32 v234, v234, v238, s16
    v_mul_u32_u24 v93, 128, v0
    s_add_u32 m0, s3, 150288
    s_mov_b32 s69, 0
    buffer_load_dwordx4 v233, s[24:27], s69 offen lds
    s_lshl_b32 s12, s6, 2
    s_add_u32 s12, s12, s7
    s_mul_i32 s13, s12, 1792
    s_mul_i32 s14, s8, 114688
    s_add_u32 s13, s13, s14
    s_add_u32 s13, s13, 4194304
    v_and_b32_e64 v236, 15, v0
    v_bfe_u32 v237, v0, 4, 1
    v_mul_u32_u24 v237, 65536, v237
    v_add_lshl_u32 v92, v236, v237, 7
    v_add_u32 v92, s13, v92
    s_lshl_b32 s13, s8, 13
    s_add_u32 m0, s3, 151312
    s_mov_b32 s69, 128
    buffer_load_dwordx4 v233, s[24:27], s69 offen lds
    s_lshl_b32 s14, s12, 7
    s_add_u32 s13, s13, s14
    s_add_u32 s13, s13, 131072
    v_and_b32 v236, 7, v0
    v_lshlrev_b32 v237, 17, v236
    v_cmp_lt_u32_e64 vcc, 31, v0
    v_add_u32 v237, s13, v237
    s_lshl_b32 s13, s8, 9
    v_cndmask_b32 v92, v92, v237, vcc
    s_lshl_b32 s14, s7, 7
    s_add_u32 s13, s13, s14
    s_add_u32 s13, s13, 8192
    s_add_u32 s77, s77, 1
    s_cmp_eq_u32 s77, 7
    s_cselect_b32 s77, 0, s77
    s_lshl_b32 s78, s77, 12
    s_add_u32 s78, s78, s59
    s_mul_i32 s79, s77, 172032
    s_add_u32 s79, s79, s60
    s_lshl_b32 s80, s77, 7
    s_add_u32 m0, s78, 0
    s_add_u32 s69, s79, 0
    buffer_load_dwordx4 v22, s[28:31], s69 offen lds
    v_lshlrev_b32 v237, 13, v236
    v_cmp_lt_u32 vcc, 39, v0
    v_add_u32 v237, s13, v237
    s_lshl_b32 s13, s8, 16
    v_cndmask_b32_e64 v92, v92, v237, vcc
    s_lshl_b32 s14, s12, 10
    s_add_u32 s13, s13, s14
    s_add_u32 s13, s13, 3145728
    v_lshlrev_b32 v237, 7, v236
    v_cmp_lt_u32 vcc, 47, v0
    v_add_u32 v237, s13, v237
    s_lshl_b32 s13, s4, 16
    s_add_u32 m0, s78, 28672
    s_add_u32 s69, s79, 896
    buffer_load_dwordx4 v22, s[28:31], s69 offen lds
    v_cndmask_b32 v92, v92, v237, vcc
    s_add_u32 s13, s13, s14
    s_lshl_b32 s14, s5, 9
    s_add_u32 s13, s13, s14
    s_add_u32 s13, s13, 2621440
    v_lshlrev_b32 v237, 7, v236
    v_cmp_lt_u32 vcc, 55, v0
    v_add_u32 v237, s13, v237
    s_nop 0
    v_cndmask_b32 v92, v92, v237, vcc
    v_lshrrev_b32 v236, 5, v0
    v_and_b32_e64 v237, 31, v0
    s_add_u32 m0, s78, 57344
    s_add_u32 s69, s79, 1792
    buffer_load_dwordx4 v22, s[28:31], s69 offen lds
    v_bfe_u32 v238, v0, 2, 2
    v_and_b32 v239, 3, v0
    v_lshrrev_b32 v240, 4, v0
    v_and_b32 v241, 15, v0
    v_and_b32 v245, 1, v240
    s_and_b32 s15, s7, 1
    s_mov_b32 s11, 0x40000
    s_mov_b32 s62, 0
    s_mov_b32 s63, -1
    s_mov_b32 s18, 0xf0000000
    s_mov_b32 s19, 0xf0000000
    s_mov_b32 s20, 0x00010001
    s_cmp_eq_u32 s15, 0
    s_cselect_b32 s21, 0x00010001, 1
    s_and_b32 s14, s6, 1
    s_lshl_b32 s14, s14, 3
    s_add_u32 s14, s14, 57344
    v_lshl_add_u32 v243, v236, 3, v238
    v_lshlrev_b32_e64 v243, 6, v243
    v_lshl_add_u32 v244, v245, 2, v239
    v_lshl_add_u32 v243, v244, 3, v243
    v_add_u32_e64 v2, s14, v243
    v_add_u32 v3, 57344, v2
    v_lshl_add_u32 v243, v240, 3, v238
    v_lshlrev_b32_e64 v244, 6, v243
    v_lshl_add_u32 v244, v239, 3, v244
    s_lshl_b32 s13, s15, 5
    s_add_u32 s14, s14, s13
    v_add_u32_e64 v5, s14, v244
    s_lshr_b32 s13, s7, 1
    s_add_u32 s13, s13, 1
    s_mul_i32 s12, s13, 28672
    v_add_u32 v4, s12, v5
    s_lshl_b32 s13, s13, 7
    s_lshl_b32 s12, s15, 6
    s_add_u32 s13, s13, s12
    s_add_u32 s13, s13, 143376
    v_lshlrev_b32 v244, 4, v240
    v_add_u32 v94, s13, v244
    v_lshlrev_b32 v243, 1, v245
    v_xor_b32 v243, v243, v0
    v_and_b32 v243, 7, v243
    v_lshrrev_b32 v244, 3, v0
    v_mul_u32_u24 v244, 896, v244
    v_lshl_add_u32 v244, v243, 4, v244
    s_lshl_b32 s12, s57, 7
    v_add_u32 v20, s12, v244
    v_xor_b32 v21, 64, v20
    s_mul_i32 s12, s6, 7
    v_add_u32_e64 v243, s12, v236
    v_mul_u32_u24 v244, 14336, v245
    v_lshl_add_u32 v244, v241, 4, v244
    s_mul_i32 s12, s7, 28672
    v_add_u32 v244, s12, v244
    v_lshrrev_b32 v242, 1, v243
    v_lshl_add_u32 v244, v242, 8, v244
    v_and_b32_e64 v243, 1, v243
    v_lshl_add_u32 v10, v243, 3, v244
    v_mov_b32_e64 v242, 1073741824
    v_cndmask_b32_e64 v11, v10, v242, s[62:63]
    v_lshlrev_b32 v18, 2, v241
    v_and_b32 v243, 7, v0
    v_lshlrev_b32_e64 v244, 7, v245
    v_lshl_add_u32 v244, v243, 4, v244
    v_lshl_add_u32 v244, v236, 3, v244
    s_lshl_b32 s12, s15, 8
    s_add_u32 s12, s12, 144144
    v_add_u32 v31, s12, v244
    v_bfe_u32 v244, v0, 2, 1
    v_lshlrev_b32_e64 v244, 8, v244
    v_lshl_add_u32 v244, v240, 5, v244
    v_lshl_add_u32 v244, v239, 1, v244
    s_lshl_b32 s12, s15, 7
    s_add_u32 s12, s12, 144656
    v_add_u32 v244, s12, v244
    s_cmp_ge_u32 s7, 2
    s_cselect_b64 vcc, -1, 0
    v_cndmask_b32 v31, v31, v244, vcc
    s_lshl_b32 s12, s7, 10
    s_add_u32 s13, s12, 144144
    v_lshlrev_b32_e64 v244, 7, v236
    v_lshl_add_u32 v244, v243, 4, v244
    v_add_u32_e64 v23, s13, v244
    s_add_u32 s13, s13, 512
    v_lshlrev_b32_e64 v244, 3, v0
    v_add_u32 v24, s13, v244
    s_lshl_b32 s13, s7, 8
    s_add_u32 s13, s13, 149264
    v_lshlrev_b32 v244, 2, v0
    v_add_u32 v25, s13, v244
    v_lshlrev_b32 v244, 4, v236
    v_add_u32 v26, s13, v244
    v_add_u32 v27, 143376, v244
    v_lshlrev_b32_e64 v28, 2, v237
    v_add_u32 v28, 143632, v28
    v_mov_b32 v243, 0x3f803f80
    v_accvgpr_write_b32 a248, v243
    v_accvgpr_write_b32 a249, v243
    v_accvgpr_write_b32 a250, v243
    v_accvgpr_write_b32 a251, v243
    v_cmp_eq_u32 vcc, 28, v237
    v_lshlrev_b32 v244, 2, v236
    v_sub_u32_e64 v242, v237, v244
    v_cndmask_b32_e64 v248, 0, v243, vcc
    v_cndmask_b32_e64 v83, 0, 1.0, vcc
    v_mov_b32_e64 v82, v248
    v_mov_b32 v243, 0xf149f2ca
    v_subrev_u32 v244, 0, v242
    v_subrev_u32 v245, 1, v242
    v_cmp_gt_u32_e64 vcc, 8, v244
    v_cmp_gt_u32 s[66:67], 8, v245
    s_nop 0
    s_mov_b32 s95, s12
    s_mov_b32 s96, s13
    s_mov_b32 s97, s14
    s_mov_b32 s98, s15
    s_and_b32 s12, s6, 1
    s_cmp_eq_u32 s7, 3
    s_cselect_b32 s12, s12, 0
    s_cmp_lt_u32 s6, 14
    s_cselect_b32 s12, s12, 0
    s_cmp_eq_u32 s12, 1
    s_cselect_b32 s12, 0, 1073741824
    s_lshl_b32 s13, s8, 13
    s_add_u32 s12, s12, s13
    s_add_u32 s12, s12, 655360
    s_lshl_b32 s13, s57, 10
    s_add_u32 s13, s13, s12
    s_lshl_b32 s14, s57, 6
    s_add_u32 s14, s14, s12
    s_add_u32 s14, s14, 7168
    v_mov_b32 v96, -1
    v_mov_b32 v97, -1
    v_mov_b32 v98, -1
    v_mov_b32 v99, -1
    v_add_u32_e64 v250, s13, v1
    buffer_store_dwordx4 v[96:99], v250, s[52:55], 0 offen sc1
    v_and_b32_e64 v250, 15, v0
    v_lshl_add_u32 v250, v250, 2, s14
    buffer_store_dword v96, v250, s[52:55], 0 offen sc1
    s_waitcnt vmcnt(7)
    v_add_u32 v30, 1, v30
    s_getreg_b32 s61, hwreg(HW_REG_XCC_ID, 0, 4)
    v_readfirstlane_b32 s9, v30
    v_mov_b32_e64 v252, v30
    v_mov_b32 v253, s61
    s_lshl_b32 s12, s8, 7
    s_lshl_b32 s13, s6, 3
    s_add_u32 s12, s12, s13
    s_add_u32 s12, s12, 4096
    s_cmp_eq_u32 s7, 0
    s_cselect_b32 s12, s12, 1073741824
    s_mov_b64 exec, 1
    buffer_store_dwordx2 v[252:253], off, s[52:55], s12 sc1
    s_mov_b64 exec, -1
    v_mov_b32 v124, 0x3f803f80
    v_mov_b32 v120, 0
    v_mov_b32 v121, 0
    v_mov_b32_e64 v122, 0
    v_mov_b32 v123, 0
    v_dot2c_f32_bf16 v120, v112, v124
    v_dot2c_f32_bf16 v121, v112, v112
    v_dot2c_f32_bf16 v122, v116, v124
    v_dot2c_f32_bf16 v123, v116, v116
    v_dot2c_f32_bf16 v120, v113, v124
    v_dot2c_f32_bf16 v121, v113, v113
    v_dot2c_f32_bf16 v122, v117, v124
    v_dot2c_f32_bf16 v123, v117, v117
    v_dot2c_f32_bf16 v120, v114, v124
    v_dot2c_f32_bf16 v121, v114, v114
    v_dot2c_f32_bf16 v122, v118, v124
    v_dot2c_f32_bf16 v123, v118, v118
    v_dot2c_f32_bf16 v120, v115, v124
    v_dot2c_f32_bf16 v121, v115, v115
    v_dot2c_f32_bf16 v122, v119, v124
    v_dot2c_f32_bf16 v123, v119, v119
    s_lshl_b32 s12, s6, 2
    s_add_u32 s12, s12, s7
    s_lshl_b32 s12, s12, 5
    s_lshl_b32 s13, s8, 11
    s_add_u32 s12, s12, s13
    s_add_u32 s12, s12, 786432
    v_permlane32_swap_b32 v120, v121
    v_permlane32_swap_b32 v122, v123
    v_add_f32 v120, v120, v121
    v_add_f32 v122, v122, v123
    s_nop 1
    v_permlane16_swap_b32 v120, v122
    v_add_f32 v120, v120, v122
    s_nop 1
    v_add_f32_dpp v120, v120, v120 row_ror:8 row_mask:0xf bank_mask:0xf
    s_nop 1
    v_add_f32_dpp v120, v120, v120 row_ror:4 row_mask:0xf bank_mask:0xf
    s_nop 1
    v_add_f32_dpp v120, v120, v120 row_ror:2 row_mask:0xf bank_mask:0xf
    s_nop 1
    v_add_f32_dpp v120, v120, v120 row_ror:1 row_mask:0xf bank_mask:0xf
    v_mov_b32 v121, v120
    v_mov_b32_e64 v122, v30
    v_mov_b32 v123, v30
    v_permlane32_swap_b32 v120, v121
    s_mov_b64 exec, 0x10001
    buffer_store_dwordx4 v[120:123], v0, s[52:55], s12 offen sc1
    s_mov_b64 exec, -1
    s_mov_b32 s12, s95
    s_mov_b32 s13, s96
    s_mov_b32 s14, s97
    s_mov_b32 s15, s98
    s_add_u32 m0, s58, 4096
    s_add_u32 s69, s80, 0
    buffer_load_dwordx4 v232, s[24:27], s69 offen lds
    v_cndmask_b32_e64 v48, v243, 0, vcc
    v_cndmask_b32_e64 v49, v243, 0, s[66:67]
    v_subrev_u32 v244, 2, v242
    v_subrev_u32 v245, 3, v242
    v_cmp_gt_u32 vcc, 8, v244
    v_cmp_gt_u32 s[66:67], 8, v245
    s_nop 0
    v_cndmask_b32_e64 v50, v243, 0, vcc
    v_cndmask_b32_e64 v51, v243, 0, s[66:67]
    v_subrev_u32 v244, 8, v242
    v_subrev_u32 v245, 9, v242
    v_cmp_gt_u32 vcc, 8, v244
    s_add_u32 m0, s58, 5120
    s_add_u32 s69, s80, 14336
    buffer_load_dwordx4 v235, s[24:27], s69 offen lds
    v_cmp_gt_u32 s[66:67], 8, v245
    s_nop 0
    v_cndmask_b32_e64 v52, v243, 0, vcc
    v_cndmask_b32_e64 v53, v243, 0, s[66:67]
    v_subrev_u32 v244, 10, v242
    v_subrev_u32 v245, 11, v242
    v_cmp_gt_u32 vcc, 8, v244
    v_cmp_gt_u32 s[66:67], 8, v245
    s_nop 0
    v_cndmask_b32_e64 v54, v243, 0, vcc
    v_cndmask_b32_e64 v55, v243, 0, s[66:67]
    v_subrev_u32_e64 v244, 16, v242
    s_add_u32 m0, s58, 6144
    s_add_u32 s69, s80, 28672
    buffer_load_dwordx4 v232, s[24:27], s69 offen lds
    v_subrev_u32_e64 v245, 17, v242
    v_cmp_gt_u32 vcc, 8, v244
    v_cmp_gt_u32 s[66:67], 8, v245
    s_nop 0
    v_cndmask_b32_e64 v56, v243, 0, vcc
    v_cndmask_b32_e64 v57, v243, 0, s[66:67]
    v_subrev_u32 v244, 18, v242
    v_subrev_u32 v245, 19, v242
    v_cmp_gt_u32 vcc, 8, v244
    v_cmp_gt_u32 s[66:67], 8, v245
    s_nop 0
    v_cndmask_b32_e64 v58, v243, 0, vcc
    s_add_u32 m0, s58, 7168
    s_add_u32 s69, s80, 43008
    buffer_load_dwordx4 v235, s[24:27], s69 offen lds
    v_cndmask_b32_e64 v59, v243, 0, s[66:67]
    v_subrev_u32 v244, 24, v242
    v_subrev_u32 v245, 25, v242
    v_cmp_gt_u32 vcc, 8, v244
    v_cmp_gt_u32 s[66:67], 8, v245
    s_nop 0
    v_cndmask_b32_e64 v60, v243, 0, vcc
    v_cndmask_b32_e64 v61, v243, 0, s[66:67]
    v_subrev_u32 v244, 26, v242
    v_subrev_u32 v245, 27, v242
    v_cmp_gt_u32 vcc, 8, v244
    v_cmp_gt_u32 s[66:67], 8, v245
    s_nop 0
    v_cndmask_b32_e64 v62, v243, 0, vcc
    v_cndmask_b32_e64 v63, v243, 0, s[66:67]
    s_or_b32 s12, s4, s7
    s_cmp_eq_u32 s12, 0
    s_cselect_b32 s12, 1000, 0
    v_add_u32_e64 v244, s12, v242
    v_cmp_gt_i32 vcc, 0, v244
    v_cmp_gt_i32 s[66:67], 1, v244
    s_nop 0
    v_cndmask_b32_e64 v64, v243, 0, vcc
    v_cndmask_b32_e64 v65, v243, 0, s[66:67]
    v_cmp_gt_i32 vcc, 2, v244
    v_cmp_gt_i32 s[66:67], 3, v244
    s_nop 0
    v_cndmask_b32_e64 v66, v243, 0, vcc
    v_cndmask_b32_e64 v67, v243, 0, s[66:67]
    v_mov_b32 v243, 0
    v_lshlrev_b32 v245, 2, v0
    v_add_u32 v245, 143376, v245
    ds_write_b32 v245, v243 offset:0
    ds_write_b32 v245, v243 offset:256
    ds_write_b32 v245, v243 offset:512
    v_mov_b32 v244, 0
    v_lshlrev_b32 v245, 12, v0
    v_add_u32 v245, 57344, v245
    s_and_b32 s12, s6, 1
    s_mul_i32 s12, s12, 0x1fffff
    s_or_b32 s12, s12, 0x200000
    s_mov_b32 exec_hi, 0
    s_mov_b32 exec_lo, s12
    ds_write_b32 v245, v243
    ds_write_b32 v245, v243 offset:4
    s_mov_b64 exec, -1
    v_lshlrev_b32_e64 v245, 3, v0
    v_add_u32 v245, 144656, v245
    v_mov_b32_e64 v249, v248
    ds_write_b64 v245, v[248:249]
    v_and_b32 v179, 31, v0
    v_lshrrev_b32 v180, 5, v0
    v_bfe_u32 v184, v0, 1, 3
    v_xor_b32 v184, v184, v180
    v_lshlrev_b32 v184, 4, v184
    v_lshl_add_u32 v184, v179, 7, v184
    v_add_u32 v184, s58, v184
    v_xor_b32 v185, 32, v184
    v_xor_b32 v186, 64, v184
    v_xor_b32 v187, 96, v184
    s_lshl_b32 s12, s8, 11
    s_lshl_b32 s13, s7, 9
    s_add_u32 s13, s13, s12
    v_lshl_add_u32 v176, v179, 4, s13
    s_add_u32 s12, s12, -2176
    s_cmp_eq_u32 s4, 0
    s_cselect_b32 s12, 1073741824, s12
    s_cselect_b64 s[70:71], 0, -1
    v_and_b32 v179, 7, v0
    v_lshl_add_u32 v177, v179, 4, s12
    v_lshrrev_b32 v180, 4, v0
    v_lshlrev_b32 v233, 3, v180
    v_lshlrev_b32_e64 v180, 4, v180
    v_lshl_add_u32 v81, v179, 6, v180
    v_add_u32 v81, 150288, v81
    v_and_b32_e64 v179, 15, v0
    v_lshl_add_u32 v233, v179, 7, v233
    v_add_u32 v233, s58, v233
    s_lshl_b32 s69, s8, 7
    v_lshl_add_u32 v178, v0, 3, s69
    s_xor_b32 s69, s69, 128
    v_mov_b32_e64 v180, s6
    v_lshl_add_u32 v180, v180, 3, s69
    v_cmp_lt_u32_e64 vcc, 15, v0
    s_mov_b32 s69, 4096
    s_nop 0
    v_cndmask_b32 v178, v178, v180, vcc
    s_mov_b32 s81, s76
    s_lshl_b32 s82, s76, 12
    v_add_u32 v2, s82, v2
    v_add_u32 v3, s82, v3
    v_add_u32_e64 v4, s82, v4
    v_add_u32 v5, s82, v5
    s_ashr_i32 s82, s82, 2
    v_add_u32 v81, s82, v81
    s_waitcnt vmcnt(11)
    s_waitcnt lgkmcnt(0)
    s_barrier
    ds_read_b128 a[0:3], v184 offset:0
    ds_read_b64_tr_b16 v[144:145], v2 offset:0
    ds_read_b64_tr_b16 v[146:147], v2 offset:256
    ds_read_b64_tr_b16 v[148:149], v2 offset:28672
    ds_read_b64_tr_b16 v[150:151], v2 offset:28928
    ds_read_b64_tr_b16 v[152:153], v3 offset:0
    ds_read_b64_tr_b16 v[154:155], v3 offset:256
    ds_read_b128 a[4:7], v185 offset:0
    ds_read_b128 a[8:11], v186 offset:0
    ds_read_b128 a[12:15], v187 offset:0
    s_waitcnt lgkmcnt(7)
    v_mfma_f32_32x32x16_bf16 v[96:111], v[144:147], a[0:3], 0
    ds_read_b64_tr_b16 v[156:157], v2 offset:1024
    ds_read_b64_tr_b16 v[158:159], v2 offset:1280
    ds_read_b128 a[32:35], v81 offset:0
    s_waitcnt lgkmcnt(8)
    v_mfma_f32_32x32x16_bf16 v[112:127], v[148:151], a[0:3], 0
    ds_read_b64_tr_b16 v[160:161], v2 offset:29696
    ds_read_b64_tr_b16 v[162:163], v2 offset:29952
    ds_read_b64_tr_b16 a[40:41], v4 offset:0
    ds_read_b64_tr_b16 a[42:43], v4 offset:256
    s_waitcnt lgkmcnt(7)
    s_add_u32 s77, s77, 1
    s_cmp_eq_u32 s77, 7
    s_cselect_b32 s77, 0, s77
    s_lshl_b32 s78, s77, 12
    s_add_u32 s78, s78, s59
    s_mul_i32 s79, s77, 172032
    s_add_u32 s79, s79, s60
    s_lshl_b32 s80, s77, 7
    s_add_u32 m0, s78, 0
    s_add_u32 s69, s79, 0
    buffer_load_dwordx4 v22, s[28:31], s69 offen lds
    v_mfma_f32_32x32x16_bf16 v[128:143], a[0:3], v[152:155], 0
    ds_read_b64_tr_b16 v[164:165], v3 offset:1024
    ds_read_b64_tr_b16 v[166:167], v3 offset:1280
    ds_read_b64_tr_b16 a[44:45], v5 offset:0
    ds_read_b64_tr_b16 a[46:47], v5 offset:256
    s_add_u32 m0, s78, 28672
    s_add_u32 s69, s79, 896
    buffer_load_dwordx4 v22, s[28:31], s69 offen lds
    s_waitcnt lgkmcnt(9)
    v_mfma_f32_32x32x16_bf16 v[96:111], v[156:159], a[4:7], v[96:111]
    ds_read_b64_tr_b16 v[144:145], v2 offset:2048
    ds_read_b64_tr_b16 v[146:147], v2 offset:2304
    s_add_u32 m0, s78, 57344
    s_add_u32 s69, s79, 1792
    buffer_load_dwordx4 v22, s[28:31], s69 offen lds
    s_waitcnt lgkmcnt(8)
    v_mfma_f32_32x32x16_bf16 v[112:127], v[160:163], a[4:7], v[112:127]
    ds_read_b64_tr_b16 v[148:149], v2 offset:30720
    ds_read_b64_tr_b16 v[150:151], v2 offset:30976
    s_add_u32 m0, s58, 8192
    s_add_u32 s69, s80, 0
    buffer_load_dwordx4 v232, s[24:27], s69 offen lds
    s_waitcnt lgkmcnt(6)
    v_mfma_f32_32x32x16_bf16 v[128:143], a[4:7], v[164:167], v[128:143]
    ds_read_b64_tr_b16 v[152:153], v3 offset:2048
    ds_read_b64_tr_b16 v[154:155], v3 offset:2304
    s_add_u32 m0, s58, 9216
    s_add_u32 s69, s80, 14336
    buffer_load_dwordx4 v235, s[24:27], s69 offen lds
    v_mfma_f32_16x16x32_bf16 v[248:251], a[40:43], a[248:251], 0
    s_waitcnt lgkmcnt(6)
    v_mfma_f32_16x16x32_bf16 v[252:255], a[44:47], a[248:251], 0
    v_mfma_f32_16x16x32_bf16 v[244:247], a[40:43], a[32:35], 0
    s_waitcnt lgkmcnt(4)
    v_mfma_f32_32x32x16_bf16 v[96:111], v[144:147], a[8:11], v[96:111]
    ds_read_b64_tr_b16 v[156:157], v2 offset:3072
    ds_read_b64_tr_b16 v[158:159], v2 offset:3328
    ds_read_b128 a[36:39], v81 offset:512
    s_add_u32 m0, s58, 10240
    s_add_u32 s69, s80, 28672
    buffer_load_dwordx4 v232, s[24:27], s69 offen lds
    s_waitcnt lgkmcnt(5)
    v_mfma_f32_32x32x16_bf16 v[112:127], v[148:151], a[8:11], v[112:127]
    ds_read_b64_tr_b16 v[160:161], v2 offset:31744
    ds_read_b64_tr_b16 v[162:163], v2 offset:32000
    ds_read_b64_tr_b16 a[40:41], v4 offset:2048
    ds_read_b64_tr_b16 a[42:43], v4 offset:2304
    s_add_u32 m0, s58, 11264
    s_add_u32 s69, s80, 43008
    buffer_load_dwordx4 v235, s[24:27], s69 offen lds
    s_waitcnt lgkmcnt(7)
    v_mfma_f32_32x32x16_bf16 v[128:143], a[8:11], v[152:155], v[128:143]
    ds_read_b64_tr_b16 v[164:165], v3 offset:3072
    ds_read_b64_tr_b16 v[166:167], v3 offset:3328
    ds_read_b64_tr_b16 a[44:45], v5 offset:2048
    ds_read_b64_tr_b16 a[46:47], v5 offset:2304
    s_waitcnt lgkmcnt(9)
    v_mfma_f32_32x32x16_bf16 v[96:111], v[156:159], a[12:15], v[96:111]
    s_add_u32 s81, s81, 1
    s_cmp_eq_u32 s81, 7
    s_cselect_b32 s82, -6, 1
    s_cselect_b32 s81, 0, s81
    s_lshl_b32 s82, s82, 12
    v_add_u32 v2, s82, v2
    v_add_u32 v3, s82, v3
    v_add_u32 v4, s82, v4
    v_add_u32 v5, s82, v5
    s_ashr_i32 s82, s82, 2
    v_add_u32 v81, s82, v81
    s_waitcnt vmcnt(7)
    s_barrier
    ds_read_b128 a[16:19], v184 offset:4096
    ds_read_b64_tr_b16 v[144:145], v2 offset:0
    ds_read_b64_tr_b16 v[146:147], v2 offset:256
    s_waitcnt lgkmcnt(9)
    v_mfma_f32_32x32x16_bf16 v[112:127], v[160:163], a[12:15], v[112:127]
    ds_read_b64_tr_b16 v[148:149], v2 offset:28672
    ds_read_b64_tr_b16 v[150:151], v2 offset:28928
    ds_read_b64_tr_b16 v[152:153], v3 offset:0
    ds_read_b64_tr_b16 v[154:155], v3 offset:256
    s_waitcnt lgkmcnt(9)
    v_mfma_f32_32x32x16_bf16 v[128:143], a[12:15], v[164:167], v[128:143]
    ds_read_b128 a[20:23], v185 offset:4096
    ds_read_b128 a[24:27], v186 offset:4096
    ds_read_b128 a[28:31], v187 offset:4096
    v_mfma_f32_16x16x32_bf16 v[248:251], a[40:43], a[248:251], v[248:251]
    s_waitcnt lgkmcnt(10)
    v_mfma_f32_16x16x32_bf16 v[252:255], a[44:47], a[248:251], v[252:255]
    v_mfma_f32_16x16x32_bf16 v[244:247], a[40:43], a[36:39], v[244:247]
    s_waitcnt lgkmcnt(7)
    v_mfma_f32_32x32x16_bf16 v[96:111], v[144:147], a[16:19], v[96:111]
    ds_read_b64_tr_b16 v[156:157], v2 offset:1024
    ds_read_b64_tr_b16 v[158:159], v2 offset:1280
    ds_read_b128 a[32:35], v81 offset:0
    s_waitcnt lgkmcnt(8)
    v_mfma_f32_32x32x16_bf16 v[112:127], v[148:151], a[16:19], v[112:127]
    ds_read_b64_tr_b16 v[160:161], v2 offset:29696
    ds_read_b64_tr_b16 v[162:163], v2 offset:29952
    ds_read_b64_tr_b16 a[40:41], v4 offset:0
    ds_read_b64_tr_b16 a[42:43], v4 offset:256
    s_waitcnt lgkmcnt(7)
    s_add_u32 s77, s77, 1
    s_cmp_eq_u32 s77, 7
    s_cselect_b32 s77, 0, s77
    s_lshl_b32 s78, s77, 12
    s_add_u32 s78, s78, s59
    s_mul_i32 s79, s77, 172032
    s_add_u32 s79, s79, s60
    s_lshl_b32 s80, s77, 7
    s_add_u32 m0, s78, 0
    s_add_u32 s69, s79, 0
    buffer_load_dwordx4 v22, s[28:31], s69 offen lds
    v_mfma_f32_32x32x16_bf16 v[128:143], a[16:19], v[152:155], v[128:143]
    ds_read_b64_tr_b16 v[164:165], v3 offset:1024
    ds_read_b64_tr_b16 v[166:167], v3 offset:1280
    ds_read_b64_tr_b16 a[44:45], v5 offset:0
    ds_read_b64_tr_b16 a[46:47], v5 offset:256
    s_add_u32 m0, s78, 28672
    s_add_u32 s69, s79, 896
    buffer_load_dwordx4 v22, s[28:31], s69 offen lds
    s_waitcnt lgkmcnt(9)
    v_mfma_f32_32x32x16_bf16 v[96:111], v[156:159], a[20:23], v[96:111]
    ds_read_b64_tr_b16 v[144:145], v2 offset:2048
    ds_read_b64_tr_b16 v[146:147], v2 offset:2304
    s_add_u32 m0, s78, 57344
    s_add_u32 s69, s79, 1792
    buffer_load_dwordx4 v22, s[28:31], s69 offen lds
    s_waitcnt lgkmcnt(8)
    v_mfma_f32_32x32x16_bf16 v[112:127], v[160:163], a[20:23], v[112:127]
    ds_read_b64_tr_b16 v[148:149], v2 offset:30720
    ds_read_b64_tr_b16 v[150:151], v2 offset:30976
    s_add_u32 m0, s58, 0
    s_add_u32 s69, s80, 0
    buffer_load_dwordx4 v232, s[24:27], s69 offen lds
    s_waitcnt lgkmcnt(6)
    v_mfma_f32_32x32x16_bf16 v[128:143], a[20:23], v[164:167], v[128:143]
    ds_read_b64_tr_b16 v[152:153], v3 offset:2048
    ds_read_b64_tr_b16 v[154:155], v3 offset:2304
    s_add_u32 m0, s58, 1024
    s_add_u32 s69, s80, 14336
    buffer_load_dwordx4 v235, s[24:27], s69 offen lds
    v_mfma_f32_16x16x32_bf16 v[248:251], a[40:43], a[248:251], v[248:251]
    s_waitcnt lgkmcnt(6)
    v_mfma_f32_16x16x32_bf16 v[252:255], a[44:47], a[248:251], v[252:255]
    v_mfma_f32_16x16x32_bf16 v[244:247], a[40:43], a[32:35], v[244:247]
    s_waitcnt lgkmcnt(4)
    v_mfma_f32_32x32x16_bf16 v[96:111], v[144:147], a[24:27], v[96:111]
    ds_read_b64_tr_b16 v[156:157], v2 offset:3072
    ds_read_b64_tr_b16 v[158:159], v2 offset:3328
    ds_read_b128 a[36:39], v81 offset:512
    s_add_u32 m0, s58, 2048
    s_add_u32 s69, s80, 28672
    buffer_load_dwordx4 v232, s[24:27], s69 offen lds
    s_waitcnt lgkmcnt(5)
    v_mfma_f32_32x32x16_bf16 v[112:127], v[148:151], a[24:27], v[112:127]
    ds_read_b64_tr_b16 v[160:161], v2 offset:31744
    ds_read_b64_tr_b16 v[162:163], v2 offset:32000
    ds_read_b64_tr_b16 a[40:41], v4 offset:2048
    ds_read_b64_tr_b16 a[42:43], v4 offset:2304
    s_add_u32 m0, s58, 3072
    s_add_u32 s69, s80, 43008
    buffer_load_dwordx4 v235, s[24:27], s69 offen lds
    s_waitcnt lgkmcnt(7)
    v_mfma_f32_32x32x16_bf16 v[128:143], a[24:27], v[152:155], v[128:143]
    ds_read_b64_tr_b16 v[164:165], v3 offset:3072
    ds_read_b64_tr_b16 v[166:167], v3 offset:3328
    ds_read_b64_tr_b16 a[44:45], v5 offset:2048
    ds_read_b64_tr_b16 a[46:47], v5 offset:2304
    s_add_u32 m0, s58, 12288
    s_mov_b32 s69, 0
    buffer_load_dwordx4 v234, s[24:27], s69 offen lds
    s_waitcnt lgkmcnt(9)
    v_mfma_f32_32x32x16_bf16 v[96:111], v[156:159], a[28:31], v[96:111]
    s_add_u32 s81, s81, 1
    s_cmp_eq_u32 s81, 7
    s_cselect_b32 s82, -6, 1
    s_cselect_b32 s81, 0, s81
    s_lshl_b32 s82, s82, 12
    v_add_u32 v2, s82, v2
    v_add_u32 v3, s82, v3
    v_add_u32 v4, s82, v4
    v_add_u32 v5, s82, v5
    s_ashr_i32 s82, s82, 2
    v_add_u32 v81, s82, v81
    s_waitcnt vmcnt(8)
    s_barrier
    ds_read_b128 a[0:3], v184 offset:8192
    ds_read_b64_tr_b16 v[144:145], v2 offset:0
    ds_read_b64_tr_b16 v[146:147], v2 offset:256
    s_waitcnt lgkmcnt(9)
    v_mfma_f32_32x32x16_bf16 v[112:127], v[160:163], a[28:31], v[112:127]
    ds_read_b64_tr_b16 v[148:149], v2 offset:28672
    ds_read_b64_tr_b16 v[150:151], v2 offset:28928
    ds_read_b64_tr_b16 v[152:153], v3 offset:0
    ds_read_b64_tr_b16 v[154:155], v3 offset:256
    s_add_u32 m0, s58, 13312
    s_mov_b32 s69, 14336
    buffer_load_dwordx4 v234, s[24:27], s69 offen lds
    s_waitcnt lgkmcnt(9)
    v_mfma_f32_32x32x16_bf16 v[128:143], a[28:31], v[164:167], v[128:143]
    ds_read_b128 a[4:7], v185 offset:8192
    ds_read_b128 a[8:11], v186 offset:8192
    ds_read_b128 a[12:15], v187 offset:8192
    v_mfma_f32_16x16x32_bf16 v[248:251], a[40:43], a[248:251], v[248:251]
    s_waitcnt lgkmcnt(10)
    v_mfma_f32_16x16x32_bf16 v[252:255], a[44:47], a[248:251], v[252:255]
    v_mfma_f32_16x16x32_bf16 v[244:247], a[40:43], a[36:39], v[244:247]
    s_waitcnt lgkmcnt(7)
    v_mfma_f32_32x32x16_bf16 v[96:111], v[144:147], a[0:3], v[96:111]
    ds_read_b64_tr_b16 v[156:157], v2 offset:1024
    ds_read_b64_tr_b16 v[158:159], v2 offset:1280
    ds_read_b128 a[32:35], v81 offset:0
    s_waitcnt lgkmcnt(8)
    v_mfma_f32_32x32x16_bf16 v[112:127], v[148:151], a[0:3], v[112:127]
    ds_read_b64_tr_b16 v[160:161], v2 offset:29696
    ds_read_b64_tr_b16 v[162:163], v2 offset:29952
    ds_read_b64_tr_b16 a[40:41], v4 offset:0
    ds_read_b64_tr_b16 a[42:43], v4 offset:256
    s_waitcnt lgkmcnt(7)
    s_add_u32 s77, s77, 1
    s_cmp_eq_u32 s77, 7
    s_cselect_b32 s77, 0, s77
    s_lshl_b32 s78, s77, 12
    s_add_u32 s78, s78, s59
    s_mul_i32 s79, s77, 172032
    s_add_u32 s79, s79, s60
    s_lshl_b32 s80, s77, 7
    s_add_u32 m0, s78, 0
    s_add_u32 s69, s79, 0
    buffer_load_dwordx4 v22, s[28:31], s69 offen lds
    v_mfma_f32_32x32x16_bf16 v[128:143], a[0:3], v[152:155], v[128:143]
    ds_read_b64_tr_b16 v[164:165], v3 offset:1024
    ds_read_b64_tr_b16 v[166:167], v3 offset:1280
    ds_read_b64_tr_b16 a[44:45], v5 offset:0
    ds_read_b64_tr_b16 a[46:47], v5 offset:256
    s_add_u32 m0, s78, 28672
    s_add_u32 s69, s79, 896
    buffer_load_dwordx4 v22, s[28:31], s69 offen lds
    s_waitcnt lgkmcnt(9)
    v_mfma_f32_32x32x16_bf16 v[96:111], v[156:159], a[4:7], v[96:111]
    ds_read_b64_tr_b16 v[144:145], v2 offset:2048
    ds_read_b64_tr_b16 v[146:147], v2 offset:2304
    s_add_u32 m0, s78, 57344
    s_add_u32 s69, s79, 1792
    buffer_load_dwordx4 v22, s[28:31], s69 offen lds
    s_waitcnt lgkmcnt(8)
    v_mfma_f32_32x32x16_bf16 v[112:127], v[160:163], a[4:7], v[112:127]
    ds_read_b64_tr_b16 v[148:149], v2 offset:30720
    ds_read_b64_tr_b16 v[150:151], v2 offset:30976
    s_add_u32 m0, s58, 4096
    s_add_u32 s69, s80, 0
    buffer_load_dwordx4 v232, s[24:27], s69 offen lds
    s_waitcnt lgkmcnt(6)
    v_mfma_f32_32x32x16_bf16 v[128:143], a[4:7], v[164:167], v[128:143]
    ds_read_b64_tr_b16 v[152:153], v3 offset:2048
    ds_read_b64_tr_b16 v[154:155], v3 offset:2304
    s_add_u32 m0, s58, 5120
    s_add_u32 s69, s80, 14336
    buffer_load_dwordx4 v235, s[24:27], s69 offen lds
    v_mfma_f32_16x16x32_bf16 v[248:251], a[40:43], a[248:251], v[248:251]
    s_waitcnt lgkmcnt(6)
    v_mfma_f32_16x16x32_bf16 v[252:255], a[44:47], a[248:251], v[252:255]
    v_mfma_f32_16x16x32_bf16 v[244:247], a[40:43], a[32:35], v[244:247]
    s_waitcnt lgkmcnt(4)
    v_mfma_f32_32x32x16_bf16 v[96:111], v[144:147], a[8:11], v[96:111]
    ds_read_b64_tr_b16 v[156:157], v2 offset:3072
    ds_read_b64_tr_b16 v[158:159], v2 offset:3328
    ds_read_b128 a[36:39], v81 offset:512
    s_add_u32 m0, s58, 6144
    s_add_u32 s69, s80, 28672
    buffer_load_dwordx4 v232, s[24:27], s69 offen lds
    s_waitcnt lgkmcnt(5)
    v_mfma_f32_32x32x16_bf16 v[112:127], v[148:151], a[8:11], v[112:127]
    ds_read_b64_tr_b16 v[160:161], v2 offset:31744
    ds_read_b64_tr_b16 v[162:163], v2 offset:32000
    ds_read_b64_tr_b16 a[40:41], v4 offset:2048
    ds_read_b64_tr_b16 a[42:43], v4 offset:2304
    s_add_u32 m0, s58, 7168
    s_add_u32 s69, s80, 43008
    buffer_load_dwordx4 v235, s[24:27], s69 offen lds
    s_waitcnt lgkmcnt(7)
    v_mfma_f32_32x32x16_bf16 v[128:143], a[8:11], v[152:155], v[128:143]
    ds_read_b64_tr_b16 v[164:165], v3 offset:3072
    ds_read_b64_tr_b16 v[166:167], v3 offset:3328
    ds_read_b64_tr_b16 a[44:45], v5 offset:2048
    ds_read_b64_tr_b16 a[46:47], v5 offset:2304
    s_waitcnt lgkmcnt(9)
    v_mfma_f32_32x32x16_bf16 v[96:111], v[156:159], a[12:15], v[96:111]
    s_add_u32 s81, s81, 1
    s_cmp_eq_u32 s81, 7
    s_cselect_b32 s82, -6, 1
    s_cselect_b32 s81, 0, s81
    s_lshl_b32 s82, s82, 12
    v_add_u32 v2, s82, v2
    v_add_u32 v3, s82, v3
    v_add_u32 v4, s82, v4
    v_add_u32 v5, s82, v5
    s_ashr_i32 s82, s82, 2
    v_add_u32 v81, s82, v81
    s_waitcnt vmcnt(9)
    s_barrier
    ds_read_b128 a[16:19], v184 offset:0
    ds_read_b64_tr_b16 v[144:145], v2 offset:0
    ds_read_b64_tr_b16 v[146:147], v2 offset:256
    s_waitcnt lgkmcnt(9)
    v_mfma_f32_32x32x16_bf16 v[112:127], v[160:163], a[12:15], v[112:127]
    ds_read_b64_tr_b16 v[148:149], v2 offset:28672
    ds_read_b64_tr_b16 v[150:151], v2 offset:28928
    ds_read_b64_tr_b16 v[152:153], v3 offset:0
    ds_read_b64_tr_b16 v[154:155], v3 offset:256
    s_waitcnt lgkmcnt(9)
    v_mfma_f32_32x32x16_bf16 v[128:143], a[12:15], v[164:167], v[128:143]
    ds_read_b128 a[20:23], v185 offset:0
    ds_read_b128 a[24:27], v186 offset:0
    ds_read_b128 a[28:31], v187 offset:0
    v_mfma_f32_16x16x32_bf16 v[248:251], a[40:43], a[248:251], v[248:251]
    s_waitcnt lgkmcnt(10)
    v_mfma_f32_16x16x32_bf16 v[252:255], a[44:47], a[248:251], v[252:255]
    v_mfma_f32_16x16x32_bf16 v[244:247], a[40:43], a[36:39], v[244:247]
    s_waitcnt lgkmcnt(7)
    v_mfma_f32_32x32x16_bf16 v[96:111], v[144:147], a[16:19], v[96:111]
    ds_read_b64_tr_b16 v[156:157], v2 offset:1024
    ds_read_b64_tr_b16 v[158:159], v2 offset:1280
    ds_read_b128 a[32:35], v81 offset:0
    s_waitcnt lgkmcnt(8)
    v_mfma_f32_32x32x16_bf16 v[112:127], v[148:151], a[16:19], v[112:127]
    ds_read_b64_tr_b16 v[160:161], v2 offset:29696
    ds_read_b64_tr_b16 v[162:163], v2 offset:29952
    ds_read_b64_tr_b16 a[40:41], v4 offset:0
    ds_read_b64_tr_b16 a[42:43], v4 offset:256
    s_waitcnt lgkmcnt(7)
    s_add_u32 s77, s77, 1
    s_cmp_eq_u32 s77, 7
    s_cselect_b32 s77, 0, s77
    s_lshl_b32 s78, s77, 12
    s_add_u32 s78, s78, s59
    s_mul_i32 s79, s77, 172032
    s_add_u32 s79, s79, s60
    s_lshl_b32 s80, s77, 7
    s_add_u32 m0, s78, 0
    s_add_u32 s69, s79, 0
    buffer_load_dwordx4 v22, s[28:31], s69 offen lds
    v_mfma_f32_32x32x16_bf16 v[128:143], a[16:19], v[152:155], v[128:143]
    ds_read_b64_tr_b16 v[164:165], v3 offset:1024
    ds_read_b64_tr_b16 v[166:167], v3 offset:1280
    ds_read_b64_tr_b16 a[44:45], v5 offset:0
    ds_read_b64_tr_b16 a[46:47], v5 offset:256
    s_add_u32 m0, s78, 28672
    s_add_u32 s69, s79, 896
    buffer_load_dwordx4 v22, s[28:31], s69 offen lds
    s_waitcnt vmcnt(9)
    ds_read_b64 v[34:35], v233 offset:12288
    ds_read_b64 v[38:39], v233 offset:12320
    ds_read_b64 v[42:43], v233 offset:12352
    ds_read_b64 v[46:47], v233 offset:12384
    s_waitcnt lgkmcnt(13)
    v_mfma_f32_32x32x16_bf16 v[96:111], v[156:159], a[20:23], v[96:111]
    ds_read_b64_tr_b16 v[144:145], v2 offset:2048
    ds_read_b64_tr_b16 v[146:147], v2 offset:2304
    s_add_u32 m0, s78, 57344
    s_add_u32 s69, s79, 1792
    buffer_load_dwordx4 v22, s[28:31], s69 offen lds
    s_waitcnt lgkmcnt(12)
    v_mfma_f32_32x32x16_bf16 v[112:127], v[160:163], a[20:23], v[112:127]
    ds_read_b64_tr_b16 v[148:149], v2 offset:30720
    ds_read_b64_tr_b16 v[150:151], v2 offset:30976
    s_add_u32 m0, s58, 8192
    s_add_u32 s69, s80, 0
    buffer_load_dwordx4 v232, s[24:27], s69 offen lds
    s_waitcnt lgkmcnt(10)
    v_mfma_f32_32x32x16_bf16 v[128:143], a[20:23], v[164:167], v[128:143]
    ds_read_b64_tr_b16 v[152:153], v3 offset:2048
    ds_read_b64_tr_b16 v[154:155], v3 offset:2304
    s_add_u32 m0, s58, 9216
    s_add_u32 s69, s80, 14336
    buffer_load_dwordx4 v235, s[24:27], s69 offen lds
    v_mfma_f32_16x16x32_bf16 v[248:251], a[40:43], a[248:251], v[248:251]
    s_waitcnt lgkmcnt(10)
    v_mfma_f32_16x16x32_bf16 v[252:255], a[44:47], a[248:251], v[252:255]
    v_mfma_f32_16x16x32_bf16 v[244:247], a[40:43], a[32:35], v[244:247]
    s_waitcnt lgkmcnt(4)
    v_mfma_f32_32x32x16_bf16 v[96:111], v[144:147], a[24:27], v[96:111]
    ds_read_b64_tr_b16 v[156:157], v2 offset:3072
    ds_read_b64_tr_b16 v[158:159], v2 offset:3328
    ds_read_b128 a[36:39], v81 offset:512
    s_add_u32 m0, s58, 10240
    s_add_u32 s69, s80, 28672
    buffer_load_dwordx4 v232, s[24:27], s69 offen lds
    s_waitcnt lgkmcnt(5)
    v_mfma_f32_32x32x16_bf16 v[112:127], v[148:151], a[24:27], v[112:127]
    ds_read_b64_tr_b16 v[160:161], v2 offset:31744
    ds_read_b64_tr_b16 v[162:163], v2 offset:32000
    ds_read_b64_tr_b16 a[40:41], v4 offset:2048
    ds_read_b64_tr_b16 a[42:43], v4 offset:2304
    s_add_u32 m0, s58, 11264
    s_add_u32 s69, s80, 43008
    buffer_load_dwordx4 v235, s[24:27], s69 offen lds
    s_waitcnt lgkmcnt(7)
    v_mfma_f32_32x32x16_bf16 v[128:143], a[24:27], v[152:155], v[128:143]
    ds_read_b64_tr_b16 v[164:165], v3 offset:3072
    ds_read_b64_tr_b16 v[166:167], v3 offset:3328
    ds_read_b64_tr_b16 a[44:45], v5 offset:2048
    ds_read_b64_tr_b16 a[46:47], v5 offset:2304
    v_lshlrev_b32_e64 v32, 16, v34
    v_and_b32 v33, 0xffff0000, v34
    v_lshlrev_b32_e64 v34, 16, v35
    v_and_b32 v35, 0xffff0000, v35
    v_lshlrev_b32_e64 v36, 16, v38
    v_and_b32 v37, 0xffff0000, v38
    v_lshlrev_b32_e64 v38, 16, v39
    v_and_b32 v39, 0xffff0000, v39
    v_lshlrev_b32_e64 v40, 16, v42
    v_and_b32 v41, 0xffff0000, v42
    v_lshlrev_b32_e64 v42, 16, v43
    v_and_b32 v43, 0xffff0000, v43
    v_lshlrev_b32_e64 v44, 16, v46
    v_and_b32 v45, 0xffff0000, v46
    v_lshlrev_b32_e64 v46, 16, v47
    v_and_b32 v47, 0xffff0000, v47
    s_waitcnt lgkmcnt(9)
    v_mfma_f32_32x32x16_bf16 v[96:111], v[156:159], a[28:31], v[96:111]
    s_add_u32 s81, s81, 1
    s_cmp_eq_u32 s81, 7
    s_cselect_b32 s82, -6, 1
    s_cselect_b32 s81, 0, s81
    s_lshl_b32 s82, s82, 12
    v_add_u32 v2, s82, v2
    v_add_u32 v3, s82, v3
    v_add_u32 v4, s82, v4
    v_add_u32 v5, s82, v5
    s_ashr_i32 s82, s82, 2
    v_add_u32 v81, s82, v81
    s_waitcnt vmcnt(7)
    s_barrier
    ds_read_b128 a[0:3], v184 offset:4096
    ds_read_b64_tr_b16 v[144:145], v2 offset:0
    ds_read_b64_tr_b16 v[146:147], v2 offset:256
    s_waitcnt lgkmcnt(9)
    v_mfma_f32_32x32x16_bf16 v[112:127], v[160:163], a[28:31], v[112:127]
    ds_read_b64_tr_b16 v[148:149], v2 offset:28672
    ds_read_b64_tr_b16 v[150:151], v2 offset:28928
    ds_read_b64_tr_b16 v[152:153], v3 offset:0
    ds_read_b64_tr_b16 v[154:155], v3 offset:256
    s_waitcnt lgkmcnt(9)
    v_mfma_f32_32x32x16_bf16 v[128:143], a[28:31], v[164:167], v[128:143]
    ds_read_b128 a[4:7], v185 offset:4096
    ds_read_b128 a[8:11], v186 offset:4096
    ds_read_b128 a[12:15], v187 offset:4096
    v_mfma_f32_16x16x32_bf16 v[248:251], a[40:43], a[248:251], v[248:251]
    s_waitcnt lgkmcnt(10)
    v_mfma_f32_16x16x32_bf16 v[252:255], a[44:47], a[248:251], v[252:255]
    v_mfma_f32_16x16x32_bf16 v[244:247], a[40:43], a[36:39], v[244:247]
    s_waitcnt lgkmcnt(7)
    v_mfma_f32_32x32x16_bf16 v[96:111], v[144:147], a[0:3], v[96:111]
    ds_read_b64_tr_b16 v[156:157], v2 offset:1024
    ds_read_b64_tr_b16 v[158:159], v2 offset:1280
    ds_read_b128 a[32:35], v81 offset:0
    s_waitcnt lgkmcnt(8)
    v_mfma_f32_32x32x16_bf16 v[112:127], v[148:151], a[0:3], v[112:127]
    ds_read_b64_tr_b16 v[160:161], v2 offset:29696
    ds_read_b64_tr_b16 v[162:163], v2 offset:29952
    ds_read_b64_tr_b16 a[40:41], v4 offset:0
    ds_read_b64_tr_b16 a[42:43], v4 offset:256
    s_waitcnt lgkmcnt(7)
    s_add_u32 s77, s77, 1
    s_cmp_eq_u32 s77, 7
    s_cselect_b32 s77, 0, s77
    s_lshl_b32 s78, s77, 12
    s_add_u32 s78, s78, s59
    s_mul_i32 s79, s77, 172032
    s_add_u32 s79, s79, s60
    s_lshl_b32 s80, s77, 7
    s_add_u32 m0, s78, 0
    s_add_u32 s69, s79, 0
    buffer_load_dwordx4 v22, s[28:31], s69 offen lds
    v_mfma_f32_32x32x16_bf16 v[128:143], a[0:3], v[152:155], v[128:143]
    ds_read_b64_tr_b16 v[164:165], v3 offset:1024
    ds_read_b64_tr_b16 v[166:167], v3 offset:1280
    ds_read_b64_tr_b16 a[44:45], v5 offset:0
    ds_read_b64_tr_b16 a[46:47], v5 offset:256
    s_add_u32 m0, s78, 28672
    s_add_u32 s69, s79, 896
    buffer_load_dwordx4 v22, s[28:31], s69 offen lds
    s_waitcnt lgkmcnt(9)
    v_mfma_f32_32x32x16_bf16 v[96:111], v[156:159], a[4:7], v[96:111]
    ds_read_b64_tr_b16 v[144:145], v2 offset:2048
    ds_read_b64_tr_b16 v[146:147], v2 offset:2304
    s_add_u32 m0, s78, 57344
    s_add_u32 s69, s79, 1792
    buffer_load_dwordx4 v22, s[28:31], s69 offen lds
    s_waitcnt lgkmcnt(8)
    v_mfma_f32_32x32x16_bf16 v[112:127], v[160:163], a[4:7], v[112:127]
    ds_read_b64_tr_b16 v[148:149], v2 offset:30720
    ds_read_b64_tr_b16 v[150:151], v2 offset:30976
    s_add_u32 m0, s58, 0
    s_add_u32 s69, s80, 0
    buffer_load_dwordx4 v232, s[24:27], s69 offen lds
    s_waitcnt lgkmcnt(6)
    v_mfma_f32_32x32x16_bf16 v[128:143], a[4:7], v[164:167], v[128:143]
    ds_read_b64_tr_b16 v[152:153], v3 offset:2048
    ds_read_b64_tr_b16 v[154:155], v3 offset:2304
    s_add_u32 m0, s58, 1024
    s_add_u32 s69, s80, 14336
    buffer_load_dwordx4 v235, s[24:27], s69 offen lds
    v_mfma_f32_16x16x32_bf16 v[248:251], a[40:43], a[248:251], v[248:251]
    s_waitcnt lgkmcnt(6)
    v_mfma_f32_16x16x32_bf16 v[252:255], a[44:47], a[248:251], v[252:255]
    v_mfma_f32_16x16x32_bf16 v[244:247], a[40:43], a[32:35], v[244:247]
    s_waitcnt lgkmcnt(4)
    v_mfma_f32_32x32x16_bf16 v[96:111], v[144:147], a[8:11], v[96:111]
    ds_read_b64_tr_b16 v[156:157], v2 offset:3072
    ds_read_b64_tr_b16 v[158:159], v2 offset:3328
    ds_read_b128 a[36:39], v81 offset:512
    s_add_u32 m0, s58, 2048
    s_add_u32 s69, s80, 28672
    buffer_load_dwordx4 v232, s[24:27], s69 offen lds
    s_waitcnt lgkmcnt(5)
    v_mfma_f32_32x32x16_bf16 v[112:127], v[148:151], a[8:11], v[112:127]
    ds_read_b64_tr_b16 v[160:161], v2 offset:31744
    ds_read_b64_tr_b16 v[162:163], v2 offset:32000
    ds_read_b64_tr_b16 a[40:41], v4 offset:2048
    ds_read_b64_tr_b16 a[42:43], v4 offset:2304
    s_add_u32 m0, s58, 3072
    s_add_u32 s69, s80, 43008
    buffer_load_dwordx4 v235, s[24:27], s69 offen lds
    s_waitcnt lgkmcnt(7)
    v_mfma_f32_32x32x16_bf16 v[128:143], a[8:11], v[152:155], v[128:143]
    ds_read_b64_tr_b16 v[164:165], v3 offset:3072
    ds_read_b64_tr_b16 v[166:167], v3 offset:3328
    ds_read_b64_tr_b16 a[44:45], v5 offset:2048
    ds_read_b64_tr_b16 a[46:47], v5 offset:2304
    s_mov_b32 s69, 786432
    buffer_load_dwordx4 v[168:171], v176, s[52:55], s69 offen sc1
    s_waitcnt lgkmcnt(9)
    v_mfma_f32_32x32x16_bf16 v[96:111], v[156:159], a[12:15], v[96:111]
    s_add_u32 s81, s81, 1
    s_cmp_eq_u32 s81, 7
    s_cselect_b32 s82, -6, 1
    s_cselect_b32 s81, 0, s81
    s_lshl_b32 s82, s82, 12
    v_add_u32 v2, s82, v2
    v_add_u32 v3, s82, v3
    v_add_u32_e64 v4, s82, v4
    v_add_u32 v5, s82, v5
    s_ashr_i32 s82, s82, 2
    v_add_u32 v81, s82, v81
    s_waitcnt vmcnt(8)
    s_barrier
    ds_read_b128 a[16:19], v184 offset:8192
    ds_read_b64_tr_b16 v[144:145], v2 offset:0
    ds_read_b64_tr_b16 v[146:147], v2 offset:256
    s_waitcnt lgkmcnt(9)
    v_mfma_f32_32x32x16_bf16 v[112:127], v[160:163], a[12:15], v[112:127]
    ds_read_b64_tr_b16 v[148:149], v2 offset:28672
    ds_read_b64_tr_b16 v[150:151], v2 offset:28928
    ds_read_b64_tr_b16 v[152:153], v3 offset:0
    ds_read_b64_tr_b16 v[154:155], v3 offset:256
    s_mov_b32 s69, 786432
    buffer_load_dwordx4 v[172:175], v177, s[52:55], s69 offen sc1
    s_waitcnt lgkmcnt(9)
    v_mfma_f32_32x32x16_bf16 v[128:143], a[12:15], v[164:167], v[128:143]
    ds_read_b128 a[20:23], v185 offset:8192
    ds_read_b128 a[24:27], v186 offset:8192
    ds_read_b128 a[28:31], v187 offset:8192
    s_mov_b32 s69, 4096
    buffer_load_dwordx2 v[242:243], v178, s[52:55], s69 offen sc1
    v_mfma_f32_16x16x32_bf16 v[248:251], a[40:43], a[248:251], v[248:251]
    s_waitcnt lgkmcnt(10)
    v_mfma_f32_16x16x32_bf16 v[252:255], a[44:47], a[248:251], v[252:255]
    v_mfma_f32_16x16x32_bf16 v[244:247], a[40:43], a[36:39], v[244:247]
    s_waitcnt lgkmcnt(7)
    v_mfma_f32_32x32x16_bf16 v[96:111], v[144:147], a[16:19], v[96:111]
    ds_read_b64_tr_b16 v[156:157], v2 offset:1024
    ds_read_b64_tr_b16 v[158:159], v2 offset:1280
    ds_read_b128 a[32:35], v81 offset:0
    s_waitcnt lgkmcnt(8)
    v_mfma_f32_32x32x16_bf16 v[112:127], v[148:151], a[16:19], v[112:127]
    ds_read_b64_tr_b16 v[160:161], v2 offset:29696
    ds_read_b64_tr_b16 v[162:163], v2 offset:29952
    ds_read_b64_tr_b16 a[40:41], v4 offset:0
    ds_read_b64_tr_b16 a[42:43], v4 offset:256
    s_waitcnt lgkmcnt(7)
    s_mov_b32 exec_lo, 0x3fff
    s_mov_b32 exec_hi, 0xffff07
    buffer_load_dword a255, v92, s[52:55], 0 offen
    s_mov_b64 exec, -1
    v_mfma_f32_32x32x16_bf16 v[128:143], a[16:19], v[152:155], v[128:143]
    ds_read_b64_tr_b16 v[164:165], v3 offset:1024
    ds_read_b64_tr_b16 v[166:167], v3 offset:1280
    ds_read_b64_tr_b16 a[44:45], v5 offset:0
    ds_read_b64_tr_b16 a[46:47], v5 offset:256
    s_mov_b64 exec, 0x7f7f
    buffer_load_dword a255, v91, s[48:51], 0 offen
    s_mov_b64 exec, -1
    s_waitcnt lgkmcnt(9)
    v_mfma_f32_32x32x16_bf16 v[96:111], v[156:159], a[20:23], v[96:111]
    ds_read_b64_tr_b16 v[144:145], v2 offset:2048
    ds_read_b64_tr_b16 v[146:147], v2 offset:2304
    s_add_u32 m0, s58, 4096
    s_add_u32 s69, s68, 28672
    buffer_load_dwordx4 v20, s[32:35], s69 offen lds
    s_waitcnt lgkmcnt(8)
    v_mfma_f32_32x32x16_bf16 v[112:127], v[160:163], a[20:23], v[112:127]
    ds_read_b64_tr_b16 v[148:149], v2 offset:30720
    ds_read_b64_tr_b16 v[150:151], v2 offset:30976
    s_add_u32 m0, s58, 5120
    s_add_u32 s69, s68, 35840
    buffer_load_dwordx4 v21, s[32:35], s69 offen lds
    s_waitcnt lgkmcnt(6)
    v_mfma_f32_32x32x16_bf16 v[128:143], a[20:23], v[164:167], v[128:143]
    ds_read_b64_tr_b16 v[152:153], v3 offset:2048
    ds_read_b64_tr_b16 v[154:155], v3 offset:2304
    s_add_u32 m0, s58, 6144
    s_add_u32 s69, s68, 43008
    buffer_load_dwordx4 v20, s[32:35], s69 offen lds
    v_mfma_f32_16x16x32_bf16 v[248:251], a[40:43], a[248:251], v[248:251]
    s_waitcnt lgkmcnt(6)
    v_mfma_f32_16x16x32_bf16 v[252:255], a[44:47], a[248:251], v[252:255]
    v_mfma_f32_16x16x32_bf16 v[244:247], a[40:43], a[32:35], v[244:247]
    s_waitcnt lgkmcnt(4)
    v_mfma_f32_32x32x16_bf16 v[96:111], v[144:147], a[24:27], v[96:111]
    ds_read_b64_tr_b16 v[156:157], v2 offset:3072
    ds_read_b64_tr_b16 v[158:159], v2 offset:3328
    ds_read_b128 a[36:39], v81 offset:512
    s_add_u32 m0, s58, 7168
    s_add_u32 s69, s68, 50176
    buffer_load_dwordx4 v21, s[32:35], s69 offen lds
    s_waitcnt vmcnt(7)
    v_cmp_ne_u32 s[66:67], s9, v175
    v_cmp_ne_u32 vcc, s9, v171
    s_and_b64 s[66:67], s[66:67], s[70:71]
    s_or_b64 vcc, vcc, s[66:67]
    s_cbranch_scc1 Ls0retry_1
Ls0ok_2:
    s_waitcnt lgkmcnt(5)
    v_mfma_f32_32x32x16_bf16 v[112:127], v[148:151], a[24:27], v[112:127]
    ds_read_b64_tr_b16 v[160:161], v2 offset:31744
    ds_read_b64_tr_b16 v[162:163], v2 offset:32000
    ds_read_b64_tr_b16 a[40:41], v4 offset:2048
    ds_read_b64_tr_b16 a[42:43], v4 offset:2304
    s_waitcnt lgkmcnt(7)
    v_mfma_f32_32x32x16_bf16 v[128:143], a[24:27], v[152:155], v[128:143]
    ds_read_b64_tr_b16 v[164:165], v3 offset:3072
    ds_read_b64_tr_b16 v[166:167], v3 offset:3328
    ds_read_b64_tr_b16 a[44:45], v5 offset:2048
    ds_read_b64_tr_b16 a[46:47], v5 offset:2304
    s_waitcnt lgkmcnt(9)
    v_mfma_f32_32x32x16_bf16 v[96:111], v[156:159], a[28:31], v[96:111]
    s_add_u32 s81, s81, 1
    s_cmp_eq_u32 s81, 7
    s_cselect_b32 s82, -6, 1
    s_cselect_b32 s81, 0, s81
    s_lshl_b32 s82, s82, 12
    v_add_u32 v2, s82, v2
    v_add_u32 v3, s82, v3
    v_add_u32 v4, s82, v4
    v_add_u32 v5, s82, v5
    s_ashr_i32 s82, s82, 2
    v_add_u32_e64 v81, s82, v81
    s_barrier
    ds_read_b128 a[0:3], v184 offset:0
    ds_read_b64_tr_b16 v[144:145], v2 offset:0
    ds_read_b64_tr_b16 v[146:147], v2 offset:256
    v_mul_f32 v168, 0x3b124925, v168
    v_mul_f32 v169, 0x3b124925, v169
    s_waitcnt lgkmcnt(9)
    v_mfma_f32_32x32x16_bf16 v[112:127], v[160:163], a[28:31], v[112:127]
    ds_read_b64_tr_b16 v[148:149], v2 offset:28672
    ds_read_b64_tr_b16 v[150:151], v2 offset:28928
    ds_read_b64_tr_b16 v[152:153], v3 offset:0
    ds_read_b64_tr_b16 v[154:155], v3 offset:256
    v_fma_f32 v169, -v168, v168, v169
    v_max_f32 v169, 0, v169
    s_waitcnt lgkmcnt(9)
    v_mfma_f32_32x32x16_bf16 v[128:143], a[28:31], v[164:167], v[128:143]
    ds_read_b128 a[4:7], v185 offset:0
    ds_read_b128 a[8:11], v186 offset:0
    ds_read_b128 a[12:15], v187 offset:0
    v_add_f32 v169, 0x3727c5ac, v169
    v_rsq_f32_e64 v234, v169
    v_mfma_f32_16x16x32_bf16 v[248:251], a[40:43], a[248:251], v[248:251]
    s_waitcnt lgkmcnt(10)
    v_mfma_f32_16x16x32_bf16 v[252:255], a[44:47], a[248:251], v[252:255]
    v_mfma_f32_16x16x32_bf16 v[244:247], a[40:43], a[36:39], v[244:247]
    s_waitcnt lgkmcnt(7)
    v_mfma_f32_32x32x16_bf16 v[96:111], v[144:147], a[0:3], v[96:111]
    ds_read_b64_tr_b16 v[156:157], v2 offset:1024
    ds_read_b64_tr_b16 v[158:159], v2 offset:1280
    ds_read_b128 a[32:35], v81 offset:0
    v_mul_f32_e64 v235, v234, v168
    v_cndmask_b32_e64 v232, v234, v235, s[62:63]
    s_waitcnt lgkmcnt(8)
    v_mfma_f32_32x32x16_bf16 v[112:127], v[148:151], a[0:3], v[112:127]
    ds_read_b64_tr_b16 v[160:161], v2 offset:29696
    ds_read_b64_tr_b16 v[162:163], v2 offset:29952
    ds_read_b64_tr_b16 a[40:41], v4 offset:0
    ds_read_b64_tr_b16 a[42:43], v4 offset:256
    s_waitcnt lgkmcnt(7)
    s_add_u32 m0, s58, 12288
    s_add_u32 s69, s68, 86016
    buffer_load_dwordx4 v20, s[32:35], s69 offen lds
    ds_write_b32 v25, v232
    v_mul_f32 v172, 0x3b124925, v172
    v_mfma_f32_32x32x16_bf16 v[128:143], a[0:3], v[152:155], v[128:143]
    ds_read_b64_tr_b16 v[164:165], v3 offset:1024
    ds_read_b64_tr_b16 v[166:167], v3 offset:1280
    ds_read_b64_tr_b16 a[44:45], v5 offset:0
    ds_read_b64_tr_b16 a[46:47], v5 offset:256
    s_add_u32 m0, s58, 13312
    s_add_u32 s69, s68, 93184
    buffer_load_dwordx4 v21, s[32:35], s69 offen lds
    v_mul_f32 v173, 0x3b124925, v173
    v_fma_f32 v173, -v172, v172, v173
    s_waitcnt lgkmcnt(10)
    v_mfma_f32_32x32x16_bf16 v[96:111], v[156:159], a[4:7], v[96:111]
    ds_read_b64_tr_b16 v[144:145], v2 offset:2048
    ds_read_b64_tr_b16 v[146:147], v2 offset:2304
    s_add_u32 m0, s58, 8192
    s_add_u32 s69, s68, 57344
    buffer_load_dwordx4 v20, s[32:35], s69 offen lds
    v_max_f32_e64 v173, 0, v173
    v_add_f32 v173, 0x3727c5ac, v173
    s_waitcnt lgkmcnt(9)
    v_mfma_f32_32x32x16_bf16 v[112:127], v[160:163], a[4:7], v[112:127]
    ds_read_b64_tr_b16 v[148:149], v2 offset:30720
    ds_read_b64_tr_b16 v[150:151], v2 offset:30976
    s_add_u32 m0, s58, 9216
    s_add_u32 s69, s68, 64512
    buffer_load_dwordx4 v21, s[32:35], s69 offen lds
    v_rsq_f32 v240, v173
    s_nop 0
    v_mul_f32 v241, v240, v172
    s_waitcnt lgkmcnt(6)
    v_mfma_f32_32x32x16_bf16 v[128:143], a[4:7], v[164:167], v[128:143]
    ds_read_b64_tr_b16 v[152:153], v3 offset:2048
    ds_read_b64_tr_b16 v[154:155], v3 offset:2304
    v_mul_f32 v236, 0x3e8b97f6, v234
    v_mul_f32 v237, 0x3e8b97f6, v235
    v_mfma_f32_16x16x32_bf16 v[248:251], a[40:43], a[248:251], v[248:251]
    s_waitcnt lgkmcnt(6)
    v_mfma_f32_16x16x32_bf16 v[252:255], a[44:47], a[248:251], v[252:255]
    v_mfma_f32_16x16x32_bf16 v[244:247], a[40:43], a[32:35], v[244:247]
    s_waitcnt lgkmcnt(4)
    v_mfma_f32_32x32x16_bf16 v[96:111], v[144:147], a[8:11], v[96:111]
    ds_read_b64_tr_b16 v[156:157], v2 offset:3072
    ds_read_b64_tr_b16 v[158:159], v2 offset:3328
    ds_read_b128 a[36:39], v81 offset:512
    v_cndmask_b32_e64 v238, v236, 0, s[62:63]
    ds_read_b128 v[200:203], v26 offset:0
    s_waitcnt lgkmcnt(6)
    v_mfma_f32_32x32x16_bf16 v[112:127], v[148:151], a[8:11], v[112:127]
    ds_read_b64_tr_b16 v[160:161], v2 offset:31744
    ds_read_b64_tr_b16 v[162:163], v2 offset:32000
    ds_read_b64_tr_b16 a[40:41], v4 offset:2048
    ds_read_b64_tr_b16 a[42:43], v4 offset:2304
    ds_read_b128 v[204:207], v26 offset:32
    ds_read_b128 v[208:211], v26 offset:64
    s_waitcnt lgkmcnt(10)
    v_mfma_f32_32x32x16_bf16 v[128:143], a[8:11], v[152:155], v[128:143]
    ds_read_b64_tr_b16 v[164:165], v3 offset:3072
    ds_read_b64_tr_b16 v[166:167], v3 offset:3328
    ds_read_b64_tr_b16 a[44:45], v5 offset:2048
    ds_read_b64_tr_b16 a[46:47], v5 offset:2304
    ds_read_b128 v[212:215], v26 offset:96
    ds_read_b128 v[216:219], v26 offset:128
    s_waitcnt lgkmcnt(14)
    v_mfma_f32_32x32x16_bf16 v[96:111], v[156:159], a[12:15], v[96:111]
    ds_read_b128 v[220:223], v26 offset:160
    ds_read_b128 v[224:227], v26 offset:192
    s_waitcnt lgkmcnt(12)
    v_mfma_f32_32x32x16_bf16 v[112:127], v[160:163], a[12:15], v[112:127]
    ds_read_b128 v[228:231], v26 offset:224
    s_waitcnt lgkmcnt(7)
    v_mfma_f32_32x32x16_bf16 v[128:143], a[12:15], v[164:167], v[128:143]
    v_mfma_f32_16x16x32_bf16 v[248:251], a[40:43], a[248:251], v[248:251]
    s_waitcnt lgkmcnt(5)
    v_mfma_f32_16x16x32_bf16 v[252:255], a[44:47], a[248:251], v[252:255]
    v_mfma_f32_16x16x32_bf16 v[244:247], a[40:43], a[36:39], v[244:247]
    s_lshr_b32 s13, s7, 1
    s_add_u32 s13, s13, 1
    s_lshl_b32 s13, s13, 7
    v_subrev_u32 v180, s13, v94
    s_mul_i32 s82, s81, -4096
    s_mov_b64 exec, s[20:21]
    ds_write_b128 v94, v[248:251]
    ds_write_b128 v180, v[252:255]
    s_mov_b64 exec, -1
    v_add_u32 v2, s82, v2
    v_add_u32 v3, s82, v3
    v_add_u32 v4, s82, v4
    v_add_u32 v5, s82, v5
    s_ashr_i32 s82, s82, 2
    v_add_u32 v81, s82, v81
    v_pk_mul_f32 v[112:113], v[112:113], v[234:235] op_sel_hi:[1,0]
    v_pk_mul_f32 v[114:115], v[114:115], v[234:235] op_sel_hi:[1,0]
    v_pk_mul_f32 v[116:117], v[116:117], v[234:235] op_sel_hi:[1,0]
    v_pk_mul_f32 v[118:119], v[118:119], v[234:235] op_sel_hi:[1,0]
    v_pk_mul_f32 v[120:121], v[120:121], v[234:235] op_sel_hi:[1,0]
    v_pk_mul_f32 v[122:123], v[122:123], v[234:235] op_sel_hi:[1,0]
    v_pk_mul_f32 v[124:125], v[124:125], v[234:235] op_sel_hi:[1,0]
    v_pk_mul_f32 v[126:127], v[126:127], v[234:235] op_sel_hi:[1,0]
    s_waitcnt lgkmcnt(0)
    s_barrier
    ds_read_b128 v[184:187], v27 offset:128
    ds_read_b128 v[188:191], v27 offset:160
    ds_read_b128 v[192:195], v27 offset:192
    ds_read_b128 v[196:199], v27 offset:224
    ds_read_b32 v239, v28 offset:0
    ds_read_b128 v[168:171], v27 offset:0
    ds_read_b128 v[172:175], v27 offset:32
    ds_read_b128 v[176:179], v27 offset:64
    ds_read_b128 v[180:183], v27 offset:96
    v_pk_mul_f32 v[128:129], v[128:129], v[200:201]
    v_pk_mul_f32 v[130:131], v[130:131], v[202:203]
    v_pk_mul_f32 v[132:133], v[132:133], v[204:205]
    v_pk_mul_f32 v[134:135], v[134:135], v[206:207]
    v_pk_mul_f32 v[136:137], v[136:137], v[208:209]
    v_pk_mul_f32 v[138:139], v[138:139], v[210:211]
    v_pk_mul_f32 v[140:141], v[140:141], v[212:213]
    v_pk_mul_f32 v[142:143], v[142:143], v[214:215]
    v_pk_mul_f32 v[96:97], v[96:97], v[236:237] op_sel_hi:[1,0]
    v_pk_mul_f32 v[98:99], v[98:99], v[236:237] op_sel_hi:[1,0]
    v_pk_mul_f32 v[100:101], v[100:101], v[236:237] op_sel_hi:[1,0]
    v_pk_mul_f32 v[102:103], v[102:103], v[236:237] op_sel_hi:[1,0]
    v_pk_mul_f32 v[104:105], v[104:105], v[236:237] op_sel_hi:[1,0]
    v_pk_mul_f32 v[106:107], v[106:107], v[236:237] op_sel_hi:[1,0]
    s_waitcnt lgkmcnt(4)
    v_pk_mul_f32 v[108:109], v[108:109], v[238:239] op_sel_hi:[1,0]
    v_pk_mul_f32 v[110:111], v[110:111], v[238:239] op_sel_hi:[1,0]
    v_add_u32 v254, s59, v1
    v_add_u32 v255, 57344, v254
    ds_read_b128 a[116:119], v254 offset:0
    ds_read_b128 a[120:123], v254 offset:4096
    ds_read_b128 a[124:127], v254 offset:8192
    v_pk_fma_f32 v[112:113], v[184:185], v[234:235], v[112:113] op_sel:[0,1,0] neg_lo:[1,0,0] neg_hi:[1,0,0]
    v_pk_fma_f32 v[114:115], v[186:187], v[234:235], v[114:115] op_sel:[0,1,0] neg_lo:[1,0,0] neg_hi:[1,0,0]
    v_pk_fma_f32 v[116:117], v[188:189], v[234:235], v[116:117] op_sel:[0,1,0] neg_lo:[1,0,0] neg_hi:[1,0,0]
    v_pk_fma_f32 v[118:119], v[190:191], v[234:235], v[118:119] op_sel:[0,1,0] neg_lo:[1,0,0] neg_hi:[1,0,0]
    v_pk_fma_f32 v[120:121], v[192:193], v[234:235], v[120:121] op_sel:[0,1,0] neg_lo:[1,0,0] neg_hi:[1,0,0]
    v_pk_fma_f32 v[122:123], v[194:195], v[234:235], v[122:123] op_sel:[0,1,0] neg_lo:[1,0,0] neg_hi:[1,0,0]
    s_add_u32 m0, s58, 10240
    s_add_u32 s69, s68, 71680
    buffer_load_dwordx4 v20, s[32:35], s69 offen lds
    v_pk_fma_f32 v[124:125], v[196:197], v[234:235], v[124:125] op_sel:[0,1,0] neg_lo:[1,0,0] neg_hi:[1,0,0]
    v_pk_fma_f32 v[126:127], v[198:199], v[234:235], v[126:127] op_sel:[0,1,0] neg_lo:[1,0,0] neg_hi:[1,0,0]
    v_cvt_pk_bf16_f32 v144, v112, v113
    v_cvt_pk_bf16_f32 v145, v114, v115
    v_cvt_pk_bf16_f32 v146, v116, v117
    v_cvt_pk_bf16_f32 v147, v118, v119
    ds_read_b128 a[128:131], v254 offset:12288
    ds_read_b128 a[132:135], v254 offset:16384
    ds_read_b128 a[136:139], v254 offset:20480
    v_cvt_pk_bf16_f32 v148, v120, v121
    v_cvt_pk_bf16_f32 v149, v122, v123
    v_cvt_pk_bf16_f32 v150, v124, v125
    v_cvt_pk_bf16_f32 v151, v126, v127
    s_mov_b32 exec_lo, 0xff000000
    s_mov_b32 exec_hi, 0xff000000
    ds_write_b128 v23, v[144:147] offset:1024
    ds_write_b128 v23, v[148:151] offset:1280
    s_mov_b64 exec, -1
    s_add_u32 m0, s58, 11264
    s_add_u32 s69, s68, 78848
    buffer_load_dwordx4 v21, s[32:35], s69 offen lds
    s_waitcnt lgkmcnt(11)
    v_pk_fma_f32 v[96:97], v[168:169], v[236:237], v[96:97] op_sel:[0,1,0] neg_lo:[1,0,0] neg_hi:[1,0,0]
    v_pk_fma_f32 v[98:99], v[170:171], v[236:237], v[98:99] op_sel:[0,1,0] neg_lo:[1,0,0] neg_hi:[1,0,0]
    s_waitcnt lgkmcnt(10)
    v_pk_fma_f32 v[100:101], v[172:173], v[236:237], v[100:101] op_sel:[0,1,0] neg_lo:[1,0,0] neg_hi:[1,0,0]
    v_pk_fma_f32 v[102:103], v[174:175], v[236:237], v[102:103] op_sel:[0,1,0] neg_lo:[1,0,0] neg_hi:[1,0,0]
    s_waitcnt lgkmcnt(9)
    v_pk_fma_f32 v[104:105], v[176:177], v[236:237], v[104:105] op_sel:[0,1,0] neg_lo:[1,0,0] neg_hi:[1,0,0]
    v_pk_fma_f32 v[106:107], v[178:179], v[236:237], v[106:107] op_sel:[0,1,0] neg_lo:[1,0,0] neg_hi:[1,0,0]
    ds_read_b128 a[140:143], v254 offset:24576
    ds_read_b128 a[144:147], v254 offset:28672
    ds_read_b128 a[148:151], v254 offset:32768
    s_waitcnt lgkmcnt(11)
    s_nop 0
    v_pk_fma_f32 v[108:109], v[180:181], v[236:237], v[108:109] op_sel:[0,1,0] neg_lo:[1,0,0] neg_hi:[1,0,0]
    v_pk_fma_f32 v[110:111], v[182:183], v[236:237], v[110:111] op_sel:[0,1,0] neg_lo:[1,0,0] neg_hi:[1,0,0]
    v_cvt_pk_bf16_f32 v160, v96, v97
    v_cvt_pk_bf16_f32 v161, v98, v99
    v_cvt_pk_bf16_f32 v162, v100, v101
    v_cvt_pk_bf16_f32 v163, v102, v103
    s_add_u32 m0, s58, 0
    s_add_u32 s69, s68, 0
    buffer_load_dwordx4 v20, s[32:35], s69 offen lds
    v_cvt_pk_bf16_f32 v164, v104, v105
    v_cvt_pk_bf16_f32 v165, v106, v107
    v_cvt_pk_bf16_f32 v166, v108, v109
    v_cvt_pk_bf16_f32 v167, v110, v111
    v_mfma_f32_32x32x16_bf16 v[112:127], v[144:147], v[160:163], v[48:63]
    s_nop 0
    s_nop 0
    v_mfma_f32_32x32x16_bf16 v[112:127], v[148:151], v[164:167], v[112:127]
    ds_read_b128 a[152:155], v254 offset:36864
    ds_read_b128 a[156:159], v254 offset:40960
    ds_read_b128 a[160:163], v254 offset:45056
    v_pk_fma_f32 v[128:129], v[216:217], v[238:239], v[128:129] op_sel:[0,1,0] neg_lo:[1,0,0] neg_hi:[1,0,0]
    v_pk_fma_f32 v[130:131], v[218:219], v[238:239], v[130:131] op_sel:[0,1,0] neg_lo:[1,0,0] neg_hi:[1,0,0]
    v_pk_fma_f32 v[132:133], v[220:221], v[238:239], v[132:133] op_sel:[0,1,0] neg_lo:[1,0,0] neg_hi:[1,0,0]
    v_pk_fma_f32 v[134:135], v[222:223], v[238:239], v[134:135] op_sel:[0,1,0] neg_lo:[1,0,0] neg_hi:[1,0,0]
    v_pk_fma_f32 v[136:137], v[224:225], v[238:239], v[136:137] op_sel:[0,1,0] neg_lo:[1,0,0] neg_hi:[1,0,0]
    v_pk_fma_f32 v[138:139], v[226:227], v[238:239], v[138:139] op_sel:[0,1,0] neg_lo:[1,0,0] neg_hi:[1,0,0]
    s_add_u32 m0, s58, 1024
    s_add_u32 s69, s68, 7168
    buffer_load_dwordx4 v21, s[32:35], s69 offen lds
    v_pk_fma_f32 v[140:141], v[228:229], v[238:239], v[140:141] op_sel:[0,1,0] neg_lo:[1,0,0] neg_hi:[1,0,0]
    v_pk_fma_f32 v[142:143], v[230:231], v[238:239], v[142:143] op_sel:[0,1,0] neg_lo:[1,0,0] neg_hi:[1,0,0]
    v_cvt_pk_bf16_f32 v152, v128, v129
    v_cvt_pk_bf16_f32 v153, v130, v131
    v_cvt_pk_bf16_f32 v154, v132, v133
    v_cvt_pk_bf16_f32 v155, v134, v135
    ds_read_b128 a[164:167], v254 offset:49152
    ds_read_b128 a[168:171], v254 offset:53248
    ds_read_b128 a[172:175], v255 offset:0
    v_cvt_pk_bf16_f32 v156, v136, v137
    v_cvt_pk_bf16_f32 v157, v138, v139
    v_cvt_pk_bf16_f32 v158, v140, v141
    v_cvt_pk_bf16_f32 v159, v142, v143
    v_cndmask_b32_e64 v152, v152, v82, s[18:19]
    v_cndmask_b32_e64 v153, v153, v82, s[18:19]
    s_add_u32 m0, s58, 2048
    s_add_u32 s69, s68, 14336
    buffer_load_dwordx4 v20, s[32:35], s69 offen lds
    v_cndmask_b32_e64 v154, v154, v82, s[18:19]
    v_cndmask_b32_e64 v155, v155, v82, s[18:19]
    v_cndmask_b32_e64 v156, v156, v82, s[18:19]
    v_cndmask_b32_e64 v157, v157, v82, s[18:19]
    v_cndmask_b32_e64 v158, v158, v82, s[18:19]
    v_cndmask_b32_e64 v159, v159, v82, s[18:19]
    ds_read_b128 a[176:179], v255 offset:4096
    ds_read_b128 a[180:183], v255 offset:8192
    ds_read_b128 a[184:187], v255 offset:12288
    ds_write_b64 v24, v[158:159] offset:1024
    v_pk_mul_f32 v[248:249], v[248:249], v[240:241] op_sel:[0,1]
    v_pk_fma_f32 v[244:245], v[244:245], v[240:241], v[248:249] op_sel_hi:[1,0,1] neg_lo:[0,0,1] neg_hi:[0,0,1]
    v_pk_mul_f32 v[250:251], v[250:251], v[240:241] op_sel:[0,1]
    v_pk_fma_f32 v[246:247], v[246:247], v[240:241], v[250:251] op_sel_hi:[1,0,1] neg_lo:[0,0,1] neg_hi:[0,0,1]
    v_cvt_pk_bf16_f32 v244, v244, v245
    s_add_u32 m0, s58, 3072
    s_add_u32 s69, s68, 21504
    buffer_load_dwordx4 v21, s[32:35], s69 offen lds
    v_cvt_pk_bf16_f32 v245, v246, v247
    s_mov_b32 exec_lo, 0xff00ff00
    s_mov_b32 exec_hi, 0xff00ff00
    s_cmp_ge_u32 s7, 2
    s_cbranch_scc1 Lhv_3
    ds_write_b64 v31, v[244:245]
Lhj_4:
    s_mov_b64 exec, -1
    ds_read_b128 a[188:191], v255 offset:16384
    ds_read_b128 a[192:195], v255 offset:20480
    ds_read_b128 a[196:199], v255 offset:24576
    s_waitcnt vmcnt(16)
    v_cmp_ne_u32 vcc, s9, v242
    s_cbranch_vccnz Ltabretry_5
Ltabok_6:
    v_cmp_ne_u32_e64 vcc, s61, v243
    s_cmp_lg_u64 vcc, 0
    s_cselect_b32 s10, 1, 0
    v_max3_f32 v239, v112, v113, v114
    v_max3_f32 v233, v115, v116, v117
    v_max3_f32 v239, v239, v118, v119
    v_max3_f32 v233, v233, v120, v121
    v_max3_f32 v239, v239, v122, v123
    s_waitcnt lgkmcnt(0)
    s_add_u32 s77, s77, 1
    s_cmp_eq_u32 s77, 7
    s_cselect_b32 s77, 0, s77
    s_lshl_b32 s78, s77, 12
    s_add_u32 s78, s78, s59
    s_mul_i32 s79, s77, 172032
    s_add_u32 s79, s79, s60
    s_lshl_b32 s80, s77, 7
    s_add_u32 m0, s78, 28672
    s_add_u32 s69, s79, 896
    buffer_load_dwordx4 v22, s[36:39], s69 offen lds
    v_max3_f32 v233, v233, v124, v125
    v_max3_f32 v233, v233, v126, v127
    v_max_f32 v239, v239, v233
    v_mov_b32 v233, v239
    s_nop 1
    v_permlane32_swap_b32 v239, v233
    v_max_f32_e64 v239, v239, v233
    s_add_u32 m0, s78, 57344
    s_add_u32 s69, s79, 1792
    buffer_load_dwordx4 v22, s[36:39], s69 offen lds
    v_pk_add_f32 v[112:113], v[112:113], v[238:239] op_sel:[0,1] neg_lo:[0,1] neg_hi:[0,1]
    v_pk_add_f32 v[114:115], v[114:115], v[238:239] op_sel:[0,1] neg_lo:[0,1] neg_hi:[0,1]
    v_pk_add_f32 v[116:117], v[116:117], v[238:239] op_sel:[0,1] neg_lo:[0,1] neg_hi:[0,1]
    v_pk_add_f32 v[118:119], v[118:119], v[238:239] op_sel:[0,1] neg_lo:[0,1] neg_hi:[0,1]
    v_pk_add_f32 v[120:121], v[120:121], v[238:239] op_sel:[0,1] neg_lo:[0,1] neg_hi:[0,1]
    v_pk_add_f32 v[122:123], v[122:123], v[238:239] op_sel:[0,1] neg_lo:[0,1] neg_hi:[0,1]
    s_add_u32 s77, s77, 1
    s_cmp_eq_u32 s77, 7
    s_cselect_b32 s77, 0, s77
    s_lshl_b32 s78, s77, 12
    s_add_u32 s78, s78, s59
    s_mul_i32 s79, s77, 172032
    s_add_u32 s79, s79, s60
    s_lshl_b32 s80, s77, 7
    s_add_u32 m0, s78, 28672
    s_add_u32 s69, s79, 896
    buffer_load_dwordx4 v22, s[36:39], s69 offen lds
    v_pk_add_f32 v[124:125], v[124:125], v[238:239] op_sel:[0,1] neg_lo:[0,1] neg_hi:[0,1]
    v_pk_add_f32 v[126:127], v[126:127], v[238:239] op_sel:[0,1] neg_lo:[0,1] neg_hi:[0,1]
    v_exp_f32 v112, v112
    v_exp_f32 v113, v113
    v_exp_f32 v114, v114
    v_exp_f32_e64 v115, v115
    s_add_u32 m0, s78, 57344
    s_add_u32 s69, s79, 1792
    buffer_load_dwordx4 v22, s[36:39], s69 offen lds
    v_exp_f32 v116, v116
    v_exp_f32 v117, v117
    v_exp_f32_e64 v118, v118
    v_exp_f32 v119, v119
    v_cvt_pk_bf16_f32 v184, v112, v113
    v_cvt_pk_bf16_f32 v185, v114, v115
    s_add_u32 s77, s77, 1
    s_cmp_eq_u32 s77, 7
    s_cselect_b32 s77, 0, s77
    s_lshl_b32 s78, s77, 12
    s_add_u32 s78, s78, s59
    s_mul_i32 s79, s77, 172032
    s_add_u32 s79, s79, s60
    s_lshl_b32 s80, s77, 7
    s_add_u32 m0, s78, 28672
    s_add_u32 s69, s79, 896
    buffer_load_dwordx4 v22, s[36:39], s69 offen lds
    v_cvt_pk_bf16_f32 v186, v116, v117
    v_cvt_pk_bf16_f32 v187, v118, v119
    v_exp_f32 v120, v120
    v_exp_f32 v121, v121
    v_exp_f32 v122, v122
    v_exp_f32 v123, v123
    s_add_u32 m0, s78, 57344
    s_add_u32 s69, s79, 1792
    buffer_load_dwordx4 v22, s[36:39], s69 offen lds
    v_exp_f32 v124, v124
    v_exp_f32 v125, v125
    v_exp_f32 v126, v126
    v_exp_f32 v127, v127
    v_mfma_f32_32x32x16_bf16 v[128:143], v[152:155], v[184:187], 0
    v_cvt_pk_bf16_f32 v188, v120, v121
    v_cvt_pk_bf16_f32 v189, v122, v123
    v_cvt_pk_bf16_f32 v190, v124, v125
    v_cvt_pk_bf16_f32 v191, v126, v127
    s_nop 1
    v_mfma_f32_32x32x16_bf16 v[128:143], v[156:159], v[188:191], v[128:143]
    s_waitcnt lgkmcnt(0)
    s_barrier
    ds_read_b128 v[168:171], v23
    ds_read_b128 v[172:175], v23 offset:256
    ds_read_b64 v[178:179], v24
    v_mov_b32 v176, 0
    v_mov_b32 v177, 0
    v_mov_b32 v192, 0
    v_mov_b32 v193, 0
    s_waitcnt lgkmcnt(2)
    v_mfma_f32_32x32x16_bf16 v[96:111], v[168:171], v[160:163], v[52:67]
    s_waitcnt lgkmcnt(1)
    v_mfma_f32_32x32x16_bf16 v[96:111], v[172:175], v[164:167], v[96:111]
    s_nop 11
    v_max3_f32 v232, v239, v108, v109
    v_max3_f32 v232, v232, v110, v111
    v_mov_b32 v233, v232
    s_nop 1
    v_permlane32_swap_b32 v232, v233
    v_max_f32 v232, v232, v233
    v_sub_f32_e64 v239, v239, v232
    v_pk_add_f32 v[108:109], v[108:109], v[232:233] op_sel_hi:[1,0] neg_lo:[0,1] neg_hi:[0,1]
    v_pk_add_f32 v[110:111], v[110:111], v[232:233] op_sel_hi:[1,0] neg_lo:[0,1] neg_hi:[0,1]
    v_exp_f32 v239, v239
    v_exp_f32 v108, v108
    v_exp_f32 v109, v109
    v_exp_f32 v110, v110
    v_exp_f32_e64 v111, v111
    v_pk_mul_f32 v[128:129], v[128:129], v[238:239] op_sel:[0,1]
    v_pk_mul_f32 v[130:131], v[130:131], v[238:239] op_sel:[0,1]
    v_pk_mul_f32 v[132:133], v[132:133], v[238:239] op_sel:[0,1]
    v_pk_mul_f32 v[134:135], v[134:135], v[238:239] op_sel:[0,1]
    v_pk_mul_f32 v[136:137], v[136:137], v[238:239] op_sel:[0,1]
    v_pk_mul_f32 v[138:139], v[138:139], v[238:239] op_sel:[0,1]
    v_pk_mul_f32 v[140:141], v[140:141], v[238:239] op_sel:[0,1]
    v_pk_mul_f32 v[142:143], v[142:143], v[238:239] op_sel:[0,1]
    v_cvt_pk_bf16_f32 v194, v108, v109
    v_cvt_pk_bf16_f32 v195, v110, v111
    s_waitcnt lgkmcnt(0)
    s_nop 0
    v_mfma_f32_32x32x16_bf16 v[128:143], v[176:179], v[192:195], v[128:143]
    s_nop 11
    v_mov_b32 v232, v140
    v_mov_b32 v233, v140
    s_mul_i32 s56, s8, 114688
    s_add_u32 s56, s56, 4194304
    v_permlane32_swap_b32 v232, v233
    v_rcp_f32 v233, v233
    s_nop 0
    v_pk_mul_f32 v[128:129], v[128:129], v[232:233] op_sel:[0,1]
    v_pk_mul_f32 v[130:131], v[130:131], v[232:233] op_sel:[0,1]
    v_pk_mul_f32 v[132:133], v[132:133], v[232:233] op_sel:[0,1]
    v_pk_mul_f32 v[134:135], v[134:135], v[232:233] op_sel:[0,1]
    v_pk_mul_f32 v[136:137], v[136:137], v[232:233] op_sel:[0,1]
    v_pk_mul_f32 v[138:139], v[138:139], v[232:233] op_sel:[0,1]
    v_pk_mul_f32 v[140:141], v[140:141], v[232:233] op_sel:[0,1]
    v_pk_mul_f32 v[142:143], v[142:143], v[232:233] op_sel:[0,1]
    v_cvt_pk_bf16_f32 v144, v128, v129
    v_cvt_pk_bf16_f32 v145, v130, v131
    v_cvt_pk_bf16_f32 v146, v132, v133
    v_cvt_pk_bf16_f32 v147, v134, v135
    v_cvt_pk_bf16_f32 v148, v136, v137
    v_cvt_pk_bf16_f32 v149, v138, v139
    v_cvt_pk_bf16_f32 v150, v140, v141
    v_cvt_pk_bf16_f32 v151, v142, v143
    s_cmp_lg_u32 s10, 0
    s_cbranch_scc1 Lslow_7
    buffer_store_dwordx2 v[144:145], v10, s[52:55], s56 offen offset:0
    buffer_store_dwordx2 v[146:147], v10, s[52:55], s56 offen offset:256
    buffer_store_dwordx2 v[148:149], v10, s[52:55], s56 offen offset:512
    buffer_store_dwordx2 v[150:151], v11, s[52:55], s56 offen offset:768
Ljoin_8:
    s_lshl_b32 s13, s8, 2
    s_add_u32 s13, s13, s7
    s_lshl_b32 s13, s13, 7
    s_lshl_b32 s14, s6, 2
    s_add_u32 s13, s13, s14
    s_add_u32 s56, s13, 8192
    s_lshl_b32 s90, s8, 2
    s_add_u32 s90, s90, s23
    s_lshl_b32 s90, s90, 7
    s_add_u32 s90, s90, 8192
    s_mul_i32 s91, s8, 114688
    s_mul_i32 s14, s23, 28672
    s_add_u32 s91, s91, s14
    s_and_b32 s14, s7, 1
    s_mul_i32 s14, s14, 14336
    s_add_u32 s91, s91, s14
    s_add_u32 s91, s91, 4194304
    s_mul_i32 s3, s6, 1568
    s_add_u32 s77, s77, 1
    s_cmp_eq_u32 s77, 7
    s_cselect_b32 s77, 0, s77
    s_lshl_b32 s78, s77, 12
    s_add_u32 s78, s78, s59
    s_mul_i32 s79, s77, 172032
    s_add_u32 s79, s79, s60
    s_lshl_b32 s80, s77, 7
    s_add_u32 m0, s78, 28672
    s_add_u32 s69, s79, 896
    buffer_load_dwordx4 v22, s[36:39], s69 offen lds
    v_add_u32_e64 v254, s59, v1
    v_add_u32 v255, 57344, v254
    v_lshrrev_b32 v236, 5, v0
    v_and_b32 v237, 31, v0
    v_bfe_u32 v238, v0, 2, 2
    v_and_b32 v239, 3, v0
    v_lshrrev_b32 v240, 4, v0
    v_and_b32_e64 v241, 15, v0
    v_and_b32 v245, 1, v240
    s_and_b32 s15, s7, 1
    v_lshl_add_u32 v243, v240, 3, v238
    v_lshlrev_b32_e64 v243, 7, v243
    v_lshl_add_u32 v243, v239, 3, v243
    v_lshrrev_b32_e64 v244, 1, v238
    v_lshl_add_u32 v244, v245, 1, v244
    v_lshl_add_u32 v6, v244, 5, v243
    v_xor_b32 v7, 32, v6
    v_xor_b32 v8, 64, v6
    v_xor_b32 v9, 96, v6
    v_mov_b32 v242, 1073741824
    v_lshlrev_b32 v243, 1, v245
    v_add_u32_e64 v243, v243, v236
    v_bfe_u32 v244, v0, 3, 1
    v_lshl_add_u32 v243, v243, 2, v244
    v_mul_u32_u24 v243, 1792, v243
    v_and_b32_e64 v244, 7, v0
    v_lshl_add_u32 v243, v244, 4, v243
    s_mul_i32 s12, s15, -25088
    s_add_u32 s12, s12, s16
    v_add_u32 v14, s12, v243
    s_add_u32 m0, s78, 57344
    s_add_u32 s69, s79, 1792
    buffer_load_dwordx4 v22, s[36:39], s69 offen lds
    v_lshrrev_b32_e64 v243, 3, v0
    v_mul_u32_u24 v243, 1792, v243
    v_lshl_add_u32 v29, v244, 4, v243
    s_lshl_b32 s12, s4, 8
    s_add_u32 s12, s12, s5
    s_lshl_b32 s13, s7, 6
    s_add_u32 s12, s12, s13
    s_mul_i32 s84, s12, 896
    s_add_u32 s85, s84, 14336
    s_add_u32 s86, s84, 28672
    s_waitcnt vmcnt(2)
    s_mov_b64 exec, 1
    s_cmp_lg_u32 s10, 0
    s_cbranch_scc1 Lslow_9
    buffer_store_dword v30, off, s[52:55], s56
Ljoin_10:
    s_mov_b64 exec, -1
    s_add_u32 s87, s84, 43008
    s_mov_b32 s88, 28672
    v_lshlrev_b32 v243, 3, v241
    v_lshl_add_u32 v243, v236, 2, v243
    s_lshl_b32 s12, s23, 11
    s_lshl_b32 s13, s57, 8
    s_add_u32 s12, s12, s13
    s_lshl_b32 s13, s15, 7
    s_add_u32 s12, s12, s13
    v_add_u32 v15, s12, v243
    s_mov_b32 s66, 0xffff0000
    s_mov_b32 s67, 0xffff0000
    v_cndmask_b32_e64 v15, v15, v242, s[66:67]
    s_and_b32 s12, s6, 1
    s_cmp_eq_u32 s7, 3
    s_cselect_b32 s12, s12, 0
    s_cmp_lt_u32 s6, 14
    s_cselect_b32 s12, s12, 0
    s_cmp_eq_u32 s12, 1
    s_cselect_b32 s12, 0, 1073741824
    s_add_u32 s77, s77, 1
    s_cmp_eq_u32 s77, 7
    s_cselect_b32 s77, 0, s77
    s_lshl_b32 s78, s77, 12
    s_add_u32 s78, s78, s59
    s_mul_i32 s79, s77, 172032
    s_add_u32 s79, s79, s60
    s_lshl_b32 s80, s77, 7
    s_add_u32 m0, s78, 28672
    s_add_u32 s69, s79, 896
    buffer_load_dwordx4 v22, s[36:39], s69 offen lds
    s_lshl_b32 s13, s8, 13
    s_add_u32 s12, s12, s13
    s_add_u32 s12, s12, 655360
    s_lshl_b32 s13, s57, 10
    s_add_u32 s13, s13, s12
    s_lshl_b32 s14, s57, 6
    s_add_u32 s14, s14, s12
    s_add_u32 s14, s14, 7168
    s_mov_b32 s66, 0x00ff00ff
    s_mov_b32 s67, 0x00ff00ff
    v_and_b32_e64 v243, 7, v0
    v_lshl_add_u32 v244, v245, 1, v236
    v_lshlrev_b32_e64 v244, 7, v244
    v_lshl_add_u32 v244, v243, 4, v244
    v_add_u32_e64 v84, s13, v244
    v_cndmask_b32_e64 v84, v84, v242, s[66:67]
    v_lshlrev_b32_e64 v244, 3, v243
    v_lshl_add_u32 v87, v236, 2, v244
    v_add_u32_e64 v87, s14, v87
    s_mov_b32 s70, 0xffff00ff
    s_mov_b32 s71, 0xffff00ff
    v_cndmask_b32_e64 v87, v87, v242, s[70:71]
    s_lshl_b32 s12, s8, 13
    s_add_u32 s12, s12, 638976
    s_cmp_eq_u32 s4, 0
    s_cselect_b32 s12, 1073741824, s12
    s_lshl_b32 s13, s7, 11
    s_add_u32 s13, s13, s12
    v_add_u32 v13, s13, v1
    v_lshlrev_b32_e64 v85, 7, v240
    s_add_u32 m0, s78, 57344
    s_add_u32 s69, s79, 1792
    buffer_load_dwordx4 v22, s[36:39], s69 offen lds
    v_lshl_add_u32 v85, v243, 4, v85
    v_add_u32_e64 v85, s12, v85
    v_cndmask_b32_e64 v85, v85, v242, s[66:67]
    v_lshl_add_u32 v86, v240, 6, v244
    s_add_u32 s12, s12, 7168
    v_add_u32 v86, s12, v86
    v_cndmask_b32_e64 v86, v86, v242, s[66:67]
    s_mov_b32 s66, 0
    s_mov_b32 s67, 0xffff0000
    v_cndmask_b32_e64 v12, v86, v242, s[66:67]
    v_lshlrev_b32_e64 v244, 3, v237
    v_lshl_add_u32 v244, v236, 8, v244
    s_lshl_b32 s12, s7, 11
    v_add_u32 v16, s12, v244
    v_cndmask_b32_e64 v17, v16, v242, s[62:63]
    v_min_u32_e64 v19, 52, v18
    v_mul_u32_u24 v88, 144, v237
    v_lshl_add_u32 v88, v236, 4, v88
    s_mul_i32 s13, s7, 4608
    s_add_u32 s13, s13, 0
    v_add_u32 v88, s13, v88
    s_lshl_b32 s13, s7, 11
    s_add_u32 s13, s13, 18432
    v_add_u32 v89, s13, v1
    v_lshlrev_b32_e64 v244, 4, v236
    v_lshl_add_u32 v244, v245, 2, v244
    v_add_u32_e64 v244, v244, v238
    v_mul_u32_u24 v244, 144, v244
    v_lshl_add_u32 v244, v239, 3, v244
    s_lshl_b32 s13, s7, 5
    s_add_u32 s77, s77, 1
    s_cmp_eq_u32 s77, 7
    s_cselect_b32 s77, 0, s77
    s_lshl_b32 s78, s77, 12
    s_add_u32 s78, s78, s59
    s_mul_i32 s79, s77, 172032
    s_add_u32 s79, s79, s60
    s_lshl_b32 s80, s77, 7
    s_add_u32 m0, s78, 28672
    s_add_u32 s69, s79, 896
    buffer_load_dwordx4 v22, s[36:39], s69 offen lds
    s_add_u32 s13, s13, 0
    v_add_u32 v90, s13, v244
    s_lshl_b32 s13, s5, 8
    v_lshlrev_b32 v244, 9, v236
    v_lshl_add_u32 v244, v241, 4, v244
    v_add_u32_e64 v244, s13, v244
    s_mov_b32 s66, 0xffff0000
    s_mov_b32 s67, 0xffff0000
    v_cndmask_b32_e64 v80, v244, v242, s[66:67]
    v_mov_b32 v243, 0x3f80
    v_mov_b32_e64 v244, 0x3f800000
    v_cmp_eq_u32 vcc, 0, v241
    v_cmp_eq_u32 s[66:67], 1, v241
    s_nop 0
    v_cndmask_b32_e64 v76, 0, v243, vcc
    v_cndmask_b32_e64 v76, v76, v244, s[66:67]
    v_cmp_eq_u32 vcc, 2, v241
    v_cmp_eq_u32 s[66:67], 3, v241
    s_nop 0
    v_cndmask_b32_e64 v77, 0, v243, vcc
    v_cndmask_b32_e64 v77, v77, v244, s[66:67]
    v_cmp_eq_u32 vcc, 4, v241
    v_cmp_eq_u32 s[66:67], 5, v241
    s_nop 0
    v_cndmask_b32_e64 v78, 0, v243, vcc
    v_cndmask_b32_e64 v78, v78, v244, s[66:67]
    v_cmp_eq_u32 vcc, 6, v241
    v_cmp_eq_u32 s[66:67], 7, v241
    s_nop 0
    v_cndmask_b32_e64 v79, 0, v243, vcc
    s_mov_b32 m0, 150288
    s_add_u32 s69, s3, 0
    buffer_load_dwordx4 v1, s[40:43], s69 offen lds
    s_sub_u32 s12, s9, 1
    s_bfe_u32 s12, s12, 0x10010
    s_xor_b32 s12, s12, 1
    s_and_b32 s22, s9, 0xfff
    s_lshl_b32 s22, s22, 1
    s_or_b32 s22, s22, s12
    s_lshl_b32 s89, s4, 4
    s_add_u32 s89, s89, s6
    s_lshl_b32 s89, s89, 2
    s_add_u32 s89, s89, s7
    s_lshl_b32 s89, s89, 10
    s_add_u32 s89, s89, 2621440
    s_lshl_b32 s12, s7, 10
    s_add_u32 s13, s12, 158480
    v_lshlrev_b32 v92, 4, v241
    v_lshl_add_u32 v92, v240, 3, v92
    v_add_u32_e64 v92, s13, v92
    v_add_u32 v93, 158480, v1
    v_lshlrev_b32_e64 v244, 10, v236
    v_lshl_add_u32 v244, v245, 9, v244
    v_lshl_add_u32 v244, v241, 4, v244
    s_lshl_b32 s13, s5, 8
    s_add_u32 s14, s13, 18432
    v_add_u32_e64 v91, s14, v244
    s_mov_b32 m0, 151312
    s_add_u32 s69, s3, 1024
    buffer_load_dwordx4 v1, s[40:43], s69 offen lds
    s_barrier
    s_cmp_ge_u32 s6, 14
    s_cbranch_scc1 Lskipw_12
    buffer_load_dword v232, v18, s[52:55], s90 offen sc1
    ds_read_b64_tr_b16 v[96:97], v6 offset:0
    ds_read_b64_tr_b16 v[98:99], v6 offset:512
    ds_read_b64_tr_b16 v[100:101], v7 offset:0
    ds_read_b64_tr_b16 v[102:103], v7 offset:512
    ds_read_b64_tr_b16 v[104:105], v8 offset:0
    ds_read_b64_tr_b16 v[106:107], v8 offset:512
    ds_read_b64_tr_b16 v[108:109], v9 offset:0
    ds_read_b64_tr_b16 v[110:111], v9 offset:512
    ds_read_b64_tr_b16 v[112:113], v6 offset:4096
    ds_read_b64_tr_b16 v[114:115], v6 offset:4608
    ds_read_b64_tr_b16 v[116:117], v7 offset:4096
    ds_read_b64_tr_b16 v[118:119], v7 offset:4608
    ds_read_b64_tr_b16 v[120:121], v8 offset:4096
    ds_read_b64_tr_b16 v[122:123], v8 offset:4608
    ds_read_b64_tr_b16 v[124:125], v9 offset:4096
    ds_read_b64_tr_b16 v[126:127], v9 offset:4608
    ds_read_b64_tr_b16 v[128:129], v6 offset:8192
    ds_read_b64_tr_b16 v[130:131], v6 offset:8704
    ds_read_b64_tr_b16 v[132:133], v7 offset:8192
    ds_read_b64_tr_b16 v[134:135], v7 offset:8704
    ds_read_b64_tr_b16 v[136:137], v8 offset:8192
    ds_read_b64_tr_b16 v[138:139], v8 offset:8704
    ds_read_b64_tr_b16 v[140:141], v9 offset:8192
    ds_read_b64_tr_b16 v[142:143], v9 offset:8704
    ds_read_b64_tr_b16 v[144:145], v6 offset:12288
    ds_read_b64_tr_b16 v[146:147], v6 offset:12800
    ds_read_b64_tr_b16 v[148:149], v7 offset:12288
    ds_read_b64_tr_b16 v[150:151], v7 offset:12800
    ds_read_b64_tr_b16 v[152:153], v8 offset:12288
    ds_read_b64_tr_b16 v[154:155], v8 offset:12800
    ds_read_b64_tr_b16 v[156:157], v9 offset:12288
    ds_read_b64_tr_b16 v[158:159], v9 offset:12800
    ds_read_b64_tr_b16 v[160:161], v6 offset:16384
    ds_read_b64_tr_b16 v[162:163], v6 offset:16896
    ds_read_b64_tr_b16 v[164:165], v7 offset:16384
    ds_read_b64_tr_b16 v[166:167], v7 offset:16896
    ds_read_b64_tr_b16 v[168:169], v8 offset:16384
    ds_read_b64_tr_b16 v[170:171], v8 offset:16896
    ds_read_b64_tr_b16 v[172:173], v9 offset:16384
    ds_read_b64_tr_b16 v[174:175], v9 offset:16896
    ds_read_b64_tr_b16 v[176:177], v6 offset:20480
    ds_read_b64_tr_b16 v[178:179], v6 offset:20992
    ds_read_b64_tr_b16 v[180:181], v7 offset:20480
    ds_read_b64_tr_b16 v[182:183], v7 offset:20992
    ds_read_b64_tr_b16 v[184:185], v8 offset:20480
    ds_read_b64_tr_b16 v[186:187], v8 offset:20992
    ds_read_b64_tr_b16 v[188:189], v9 offset:20480
    ds_read_b64_tr_b16 v[190:191], v9 offset:20992
    ds_read_b64_tr_b16 v[192:193], v6 offset:24576
    ds_read_b64_tr_b16 v[194:195], v6 offset:25088
    ds_read_b64_tr_b16 v[196:197], v7 offset:24576
    ds_read_b64_tr_b16 v[198:199], v7 offset:25088
    ds_read_b64_tr_b16 v[200:201], v8 offset:24576
    ds_read_b64_tr_b16 v[202:203], v8 offset:25088
    ds_read_b64_tr_b16 v[204:205], v9 offset:24576
    ds_read_b64_tr_b16 v[206:207], v9 offset:25088
Lpoll_13:
    buffer_load_dword v233, v18, s[52:55], s90 offen sc1
    s_waitcnt vmcnt(1)
    v_cmp_ne_u32 vcc, s9, v232
    s_cbranch_vccz Ldone_14
    buffer_load_dword v232, v18, s[52:55], s90 offen sc1
    s_waitcnt vmcnt(1)
    v_cmp_ne_u32 vcc, s9, v233
    s_cbranch_vccz Ldone_14
    s_sub_u32 s11, s11, 1
    s_cbranch_scc0 Lpoll_13
    s_mov_b32 s11, 0
Ldone_14:
    buffer_load_dwordx4 a[0:3], v1, s[52:55], s91 offen offset:0 sc1
    buffer_load_dwordx4 a[4:7], v1, s[52:55], s91 offen offset:1024 sc1
    buffer_load_dwordx4 a[8:11], v1, s[52:55], s91 offen offset:2048 sc1
    buffer_load_dwordx4 a[12:15], v1, s[52:55], s91 offen offset:3072 sc1
    s_add_u32 s91, s91, 4096
    buffer_load_dwordx4 a[16:19], v1, s[52:55], s91 offen offset:0 sc1
    s_waitcnt vmcnt(4) lgkmcnt(15)
    v_mfma_f32_16x16x32_bf16 v[32:35], v[96:99], a[0:3], v[32:35]
    buffer_load_dwordx4 a[20:23], v1, s[52:55], s91 offen offset:1024 sc1
    ds_read_b64_tr_b16 v[208:209], v6 offset:28672
    ds_read_b64_tr_b16 v[210:211], v6 offset:29184
    v_mfma_f32_16x16x32_bf16 v[36:39], v[100:103], a[0:3], v[36:39]
    ds_read_b64_tr_b16 v[212:213], v7 offset:28672
    ds_read_b64_tr_b16 v[214:215], v7 offset:29184
    v_mfma_f32_16x16x32_bf16 v[40:43], v[104:107], a[0:3], v[40:43]
    ds_read_b64_tr_b16 v[216:217], v8 offset:28672
    ds_read_b64_tr_b16 v[218:219], v8 offset:29184
    v_mfma_f32_16x16x32_bf16 v[44:47], v[108:111], a[0:3], v[44:47]
    ds_read_b64_tr_b16 v[220:221], v9 offset:28672
    ds_read_b64_tr_b16 v[222:223], v9 offset:29184
    s_waitcnt vmcnt(4)
    v_mfma_f32_16x16x32_bf16 v[32:35], v[112:115], a[4:7], v[32:35]
    buffer_load_dwordx4 a[24:27], v1, s[52:55], s91 offen offset:2048 sc1
    ds_read_b64_tr_b16 v[96:97], v6 offset:32768
    ds_read_b64_tr_b16 v[98:99], v6 offset:33280
    v_mfma_f32_16x16x32_bf16 v[36:39], v[116:119], a[4:7], v[36:39]
    ds_read_b64_tr_b16 v[100:101], v7 offset:32768
    ds_read_b64_tr_b16 v[102:103], v7 offset:33280
    v_mfma_f32_16x16x32_bf16 v[40:43], v[120:123], a[4:7], v[40:43]
    ds_read_b64_tr_b16 v[104:105], v8 offset:32768
    ds_read_b64_tr_b16 v[106:107], v8 offset:33280
    v_mfma_f32_16x16x32_bf16 v[44:47], v[124:127], a[4:7], v[44:47]
    ds_read_b64_tr_b16 v[108:109], v9 offset:32768
    ds_read_b64_tr_b16 v[110:111], v9 offset:33280
    s_waitcnt vmcnt(4)
    v_mfma_f32_16x16x32_bf16 v[32:35], v[128:131], a[8:11], v[32:35]
    buffer_load_dwordx4 a[28:31], v1, s[52:55], s91 offen offset:3072 sc1
    ds_read_b64_tr_b16 v[112:113], v6 offset:36864
    ds_read_b64_tr_b16 v[114:115], v6 offset:37376
    v_mfma_f32_16x16x32_bf16 v[36:39], v[132:135], a[8:11], v[36:39]
    ds_read_b64_tr_b16 v[116:117], v7 offset:36864
    ds_read_b64_tr_b16 v[118:119], v7 offset:37376
    v_mfma_f32_16x16x32_bf16 v[40:43], v[136:139], a[8:11], v[40:43]
    ds_read_b64_tr_b16 v[120:121], v8 offset:36864
    ds_read_b64_tr_b16 v[122:123], v8 offset:37376
    v_mfma_f32_16x16x32_bf16 v[44:47], v[140:143], a[8:11], v[44:47]
    ds_read_b64_tr_b16 v[124:125], v9 offset:36864
    ds_read_b64_tr_b16 v[126:127], v9 offset:37376
    s_waitcnt vmcnt(4)
    v_mfma_f32_16x16x32_bf16 v[32:35], v[144:147], a[12:15], v[32:35]
    s_add_u32 s91, s91, 4096
    buffer_load_dwordx4 a[32:35], v1, s[52:55], s91 offen offset:0 sc1
    ds_read_b64_tr_b16 v[128:129], v6 offset:40960
    ds_read_b64_tr_b16 v[130:131], v6 offset:41472
    v_mfma_f32_16x16x32_bf16 v[36:39], v[148:151], a[12:15], v[36:39]
    ds_read_b64_tr_b16 v[132:133], v7 offset:40960
    ds_read_b64_tr_b16 v[134:135], v7 offset:41472
    v_mfma_f32_16x16x32_bf16 v[40:43], v[152:155], a[12:15], v[40:43]
    ds_read_b64_tr_b16 v[136:137], v8 offset:40960
    ds_read_b64_tr_b16 v[138:139], v8 offset:41472
    v_mfma_f32_16x16x32_bf16 v[44:47], v[156:159], a[12:15], v[44:47]
    ds_read_b64_tr_b16 v[140:141], v9 offset:40960
    ds_read_b64_tr_b16 v[142:143], v9 offset:41472
    s_waitcnt vmcnt(4)
    v_mfma_f32_16x16x32_bf16 v[32:35], v[160:163], a[16:19], v[32:35]
    buffer_load_dwordx4 a[36:39], v1, s[52:55], s91 offen offset:1024 sc1
    ds_read_b64_tr_b16 v[144:145], v6 offset:45056
    ds_read_b64_tr_b16 v[146:147], v6 offset:45568
    v_mfma_f32_16x16x32_bf16 v[36:39], v[164:167], a[16:19], v[36:39]
    ds_read_b64_tr_b16 v[148:149], v7 offset:45056
    ds_read_b64_tr_b16 v[150:151], v7 offset:45568
    v_mfma_f32_16x16x32_bf16 v[40:43], v[168:171], a[16:19], v[40:43]
    ds_read_b64_tr_b16 v[152:153], v8 offset:45056
    ds_read_b64_tr_b16 v[154:155], v8 offset:45568
    v_mfma_f32_16x16x32_bf16 v[44:47], v[172:175], a[16:19], v[44:47]
    ds_read_b64_tr_b16 v[156:157], v9 offset:45056
    ds_read_b64_tr_b16 v[158:159], v9 offset:45568
    s_waitcnt vmcnt(4) lgkmcnt(15)
    v_mfma_f32_16x16x32_bf16 v[32:35], v[176:179], a[20:23], v[32:35]
    buffer_load_dwordx4 a[40:43], v1, s[52:55], s91 offen offset:2048 sc1
    ds_read_b64_tr_b16 v[160:161], v6 offset:49152
    ds_read_b64_tr_b16 v[162:163], v6 offset:49664
    v_mfma_f32_16x16x32_bf16 v[36:39], v[180:183], a[20:23], v[36:39]
    ds_read_b64_tr_b16 v[164:165], v7 offset:49152
    ds_read_b64_tr_b16 v[166:167], v7 offset:49664
    v_mfma_f32_16x16x32_bf16 v[40:43], v[184:187], a[20:23], v[40:43]
    ds_read_b64_tr_b16 v[168:169], v8 offset:49152
    ds_read_b64_tr_b16 v[170:171], v8 offset:49664
    v_mfma_f32_16x16x32_bf16 v[44:47], v[188:191], a[20:23], v[44:47]
    ds_read_b64_tr_b16 v[172:173], v9 offset:49152
    ds_read_b64_tr_b16 v[174:175], v9 offset:49664
    s_waitcnt vmcnt(4)
    v_mfma_f32_16x16x32_bf16 v[32:35], v[192:195], a[24:27], v[32:35]
    buffer_load_dwordx4 a[44:47], v1, s[52:55], s91 offen offset:3072 sc1
    ds_read_b64_tr_b16 v[176:177], v6 offset:53248
    ds_read_b64_tr_b16 v[178:179], v6 offset:53760
    v_mfma_f32_16x16x32_bf16 v[36:39], v[196:199], a[24:27], v[36:39]
    ds_read_b64_tr_b16 v[180:181], v7 offset:53248
    ds_read_b64_tr_b16 v[182:183], v7 offset:53760
    v_mfma_f32_16x16x32_bf16 v[40:43], v[200:203], a[24:27], v[40:43]
    ds_read_b64_tr_b16 v[184:185], v8 offset:53248
    ds_read_b64_tr_b16 v[186:187], v8 offset:53760
    v_mfma_f32_16x16x32_bf16 v[44:47], v[204:207], a[24:27], v[44:47]
    ds_read_b64_tr_b16 v[188:189], v9 offset:53248
    ds_read_b64_tr_b16 v[190:191], v9 offset:53760
    s_waitcnt vmcnt(4)
    v_mfma_f32_16x16x32_bf16 v[32:35], v[208:211], a[28:31], v[32:35]
    s_add_u32 s91, s91, 4096
    buffer_load_dwordx4 a[48:51], v1, s[52:55], s91 offen offset:0 sc1
    v_mfma_f32_16x16x32_bf16 v[36:39], v[212:215], a[28:31], v[36:39]
    v_mfma_f32_16x16x32_bf16 v[40:43], v[216:219], a[28:31], v[40:43]
    v_mfma_f32_16x16x32_bf16 v[44:47], v[220:223], a[28:31], v[44:47]
    s_waitcnt vmcnt(4)
    v_mfma_f32_16x16x32_bf16 v[32:35], v[96:99], a[32:35], v[32:35]
    buffer_load_dwordx4 a[52:55], v1, s[52:55], s91 offen offset:1024 sc1
    v_mfma_f32_16x16x32_bf16 v[36:39], v[100:103], a[32:35], v[36:39]
    v_mfma_f32_16x16x32_bf16 v[40:43], v[104:107], a[32:35], v[40:43]
    v_mfma_f32_16x16x32_bf16 v[44:47], v[108:111], a[32:35], v[44:47]
    s_waitcnt vmcnt(4)
    v_mfma_f32_16x16x32_bf16 v[32:35], v[112:115], a[36:39], v[32:35]
    v_mfma_f32_16x16x32_bf16 v[36:39], v[116:119], a[36:39], v[36:39]
    v_mfma_f32_16x16x32_bf16 v[40:43], v[120:123], a[36:39], v[40:43]
    v_mfma_f32_16x16x32_bf16 v[44:47], v[124:127], a[36:39], v[44:47]
    s_waitcnt vmcnt(3) lgkmcnt(15)
    v_mfma_f32_16x16x32_bf16 v[32:35], v[128:131], a[40:43], v[32:35]
    v_mfma_f32_16x16x32_bf16 v[36:39], v[132:135], a[40:43], v[36:39]
    v_mfma_f32_16x16x32_bf16 v[40:43], v[136:139], a[40:43], v[40:43]
    v_mfma_f32_16x16x32_bf16 v[44:47], v[140:143], a[40:43], v[44:47]
    s_waitcnt vmcnt(2)
    v_mfma_f32_16x16x32_bf16 v[32:35], v[144:147], a[44:47], v[32:35]
    v_mfma_f32_16x16x32_bf16 v[36:39], v[148:151], a[44:47], v[36:39]
    v_mfma_f32_16x16x32_bf16 v[40:43], v[152:155], a[44:47], v[40:43]
    v_mfma_f32_16x16x32_bf16 v[44:47], v[156:159], a[44:47], v[44:47]
    s_waitcnt vmcnt(1) lgkmcnt(8)
    v_mfma_f32_16x16x32_bf16 v[32:35], v[160:163], a[48:51], v[32:35]
    v_mfma_f32_16x16x32_bf16 v[36:39], v[164:167], a[48:51], v[36:39]
    v_mfma_f32_16x16x32_bf16 v[40:43], v[168:171], a[48:51], v[40:43]
    v_mfma_f32_16x16x32_bf16 v[44:47], v[172:175], a[48:51], v[44:47]
    s_waitcnt vmcnt(0) lgkmcnt(0)
    v_mfma_f32_16x16x32_bf16 v[32:35], v[176:179], a[52:55], v[32:35]
    v_mfma_f32_16x16x32_bf16 v[36:39], v[180:183], a[52:55], v[36:39]
    v_mfma_f32_16x16x32_bf16 v[40:43], v[184:187], a[52:55], v[40:43]
    v_mfma_f32_16x16x32_bf16 v[44:47], v[188:191], a[52:55], v[44:47]
    s_nop 4
    v_cvt_pk_bf16_f32 v144, v32, v33
    v_cvt_pk_bf16_f32 v145, v34, v35
    v_cvt_pk_bf16_f32 v146, v36, v37
    v_cvt_pk_bf16_f32 v147, v38, v39
    v_cvt_pk_bf16_f32 v148, v40, v41
    v_cvt_pk_bf16_f32 v149, v42, v43
    v_cvt_pk_bf16_f32 v150, v44, v45
    v_cvt_pk_bf16_f32 v151, v46, v47
    v_permlane16_swap_b32 v144, v146
    v_permlane16_swap_b32 v145, v147
    v_permlane16_swap_b32 v148, v150
    v_permlane16_swap_b32 v149, v151
    s_cmp_lg_u32 s10, 0
    s_cbranch_scc1 Lslow_15
    buffer_store_dwordx4 v[144:147], v14, s[48:51], 0 offen
    buffer_store_dwordx4 v[148:151], v14, s[48:51], s88 offen
Ljoin_16:
    v_pk_add_f32 v[232:233], v[32:33], v[34:35]
    v_pk_mul_f32 v[234:235], v[32:33], v[32:33]
    v_pk_fma_f32 v[234:235], v[34:35], v[34:35], v[234:235]
    v_pk_add_f32 v[232:233], v[232:233], v[36:37]
    v_pk_fma_f32 v[234:235], v[36:37], v[36:37], v[234:235]
    v_pk_add_f32 v[232:233], v[232:233], v[38:39]
    v_pk_fma_f32 v[234:235], v[38:39], v[38:39], v[234:235]
    v_pk_add_f32 v[232:233], v[232:233], v[40:41]
    v_pk_fma_f32 v[234:235], v[40:41], v[40:41], v[234:235]
    v_pk_add_f32 v[232:233], v[232:233], v[42:43]
    v_pk_fma_f32 v[234:235], v[42:43], v[42:43], v[234:235]
    v_pk_add_f32 v[232:233], v[232:233], v[44:45]
    v_pk_fma_f32 v[234:235], v[44:45], v[44:45], v[234:235]
    v_pk_add_f32 v[232:233], v[232:233], v[46:47]
    v_pk_fma_f32 v[234:235], v[46:47], v[46:47], v[234:235]
    v_add_f32_e64 v232, v232, v233
    v_add_f32 v234, v234, v235
    s_lshl_b32 s14, s8, 13
    s_add_u32 s14, s14, 131072
    v_permlane32_swap_b32 v232, v234
    v_add_f32 v232, v232, v234
    v_mov_b32 v234, v232
    s_nop 1
    v_permlane16_swap_b32 v232, v234
    v_add_f32 v232, v232, v234
    s_cmp_lg_u32 s10, 0
    s_cbranch_scc1 Lslow_17
    buffer_store_dword v232, v15, s[52:55], s14 offen
Ljoin_18:
    s_lshl_b32 s13, s8, 2
    s_add_u32 s13, s13, s23
    s_lshl_b32 s13, s13, 7
    s_lshl_b32 s14, s57, 1
    s_and_b32 s15, s7, 1
    s_add_u32 s14, s14, s15
    s_lshl_b32 s14, s14, 2
    s_add_u32 s13, s13, s14
    s_add_u32 s13, s13, 40960
    s_waitcnt vmcnt(0)
    s_mov_b64 exec, 1
    s_cmp_lg_u32 s10, 0
    s_cbranch_scc1 Lslow_19
    buffer_store_dword v30, off, s[52:55], s13
Ljoin_20:
    s_mov_b64 exec, -1
Lskip_11:
    s_add_u32 m0, s78, 57344
    s_add_u32 s69, s79, 1792
    buffer_load_dwordx4 v22, s[36:39], s69 offen lds
    v_and_b32 v236, 31, v0
    v_lshrrev_b32_e64 v237, 4, v236
    v_bfe_u32 v238, v236, 2, 1
    v_lshl_add_u32 v237, v237, 1, v238
    v_mul_u32_u24_e64 v237, 7, v237
    v_bfe_u32 v238, v236, 3, 1
    v_and_b32_e64 v239, 3, v236
    v_lshl_add_u32 v238, v238, 2, v239
    v_add_u32_e64 v237, v237, v238
    v_cmp_eq_u32 s[66:67], 7, v238
    v_lshrrev_b32_e64 v239, 5, v0
    v_mul_u32_u24 v239, 224, v239
    v_lshl_add_u32 v237, v237, 1, v239
    v_add_u32 v237, 150288, v237
    ds_read_u16 v168, v237 offset:0
    ds_read_u16 v169, v237 offset:56
    ds_read_u16 v170, v237 offset:112
    ds_read_u16 v171, v237 offset:168
    ds_read_u16 v172, v237 offset:448
    ds_read_u16 v173, v237 offset:504
    ds_read_u16 v174, v237 offset:560
    ds_read_u16 v175, v237 offset:616
    ds_read_u16 v176, v237 offset:896
    ds_read_u16 v177, v237 offset:952
    ds_read_u16 v178, v237 offset:1008
    ds_read_u16 v179, v237 offset:1064
    ds_read_u16 v180, v237 offset:1344
    ds_read_u16 v181, v237 offset:1400
    ds_read_u16 v182, v237 offset:1456
    ds_read_u16 v183, v237 offset:1512
    s_add_u32 s77, s77, 1
    s_cmp_eq_u32 s77, 7
    s_cselect_b32 s77, 0, s77
    s_lshl_b32 s78, s77, 12
    s_add_u32 s78, s78, s59
    s_mul_i32 s79, s77, 172032
    s_add_u32 s79, s79, s60
    s_lshl_b32 s80, s77, 7
    s_add_u32 m0, s78, 28672
    s_add_u32 s69, s79, 896
    buffer_load_dwordx4 v22, s[36:39], s69 offen lds
    s_or_b64 s[70:71], s[66:67], s[62:63]
    s_waitcnt lgkmcnt(14)
    v_lshl_or_b32 v68, v169, 16, v168
    v_cndmask_b32_e64 v68, v68, 0, s[66:67]
    s_waitcnt lgkmcnt(12)
    v_lshl_or_b32 v69, v171, 16, v170
    v_cndmask_b32_e64 v69, v69, 0, s[66:67]
    s_waitcnt lgkmcnt(10)
    v_lshl_or_b32 v70, v173, 16, v172
    v_cndmask_b32_e64 v70, v70, 0, s[66:67]
    s_waitcnt lgkmcnt(8)
    v_lshl_or_b32 v71, v175, 16, v174
    v_cndmask_b32_e64 v71, v71, 0, s[66:67]
    s_waitcnt lgkmcnt(6)
    v_lshl_or_b32 v72, v177, 16, v176
    v_cndmask_b32_e64 v72, v72, 0, s[66:67]
    s_waitcnt lgkmcnt(4)
    v_lshl_or_b32 v73, v179, 16, v178
    v_cndmask_b32_e64 v73, v73, 0, s[66:67]
    s_waitcnt lgkmcnt(2)
    v_lshl_or_b32 v74, v181, 16, v180
    v_cndmask_b32_e64 v74, v74, 0, s[70:71]
    s_waitcnt lgkmcnt(0)
    v_lshl_or_b32 v75, v183, 16, v182
    v_cndmask_b32_e64 v75, v75, 0, s[70:71]
    s_add_u32 m0, s78, 57344
    s_add_u32 s69, s79, 1792
    buffer_load_dwordx4 v22, s[36:39], s69 offen lds
    s_add_u32 s77, s77, 1
    s_cmp_eq_u32 s77, 7
    s_cselect_b32 s77, 0, s77
    s_lshl_b32 s78, s77, 12
    s_add_u32 s78, s78, s59
    s_mul_i32 s79, s77, 172032
    s_add_u32 s79, s79, s60
    s_lshl_b32 s80, s77, 7
    s_add_u32 m0, s78, 0
    s_add_u32 s69, s79, 0
    buffer_load_dwordx4 v22, s[36:39], s69 offen lds
    s_add_u32 s77, s77, 1
    s_cmp_eq_u32 s77, 7
    s_cselect_b32 s77, 0, s77
    s_lshl_b32 s78, s77, 12
    s_add_u32 s78, s78, s59
    s_mul_i32 s79, s77, 172032
    s_add_u32 s79, s79, s60
    s_lshl_b32 s80, s77, 7
    s_add_u32 m0, s78, 0
    s_add_u32 s69, s79, 0
    buffer_load_dwordx4 v22, s[36:39], s69 offen lds
    s_lshl_b32 s13, s8, 2
    s_add_u32 s13, s13, s7
    s_lshl_b32 s13, s13, 7
    s_add_u32 s13, s13, 40960
    s_mul_i32 s56, s8, 114688
    s_mul_i32 s14, s7, 28672
    s_add_u32 s56, s56, s14
    s_add_u32 s56, s56, 12582912
    s_lshl_b32 s14, s8, 13
    s_add_u32 s14, s14, 131072
    buffer_load_dword v232, v19, s[52:55], s13 offen sc1
Lpoll_21:
    buffer_load_dword v233, v19, s[52:55], s13 offen sc1
    s_waitcnt vmcnt(1)
    v_cmp_ne_u32_e64 vcc, s9, v232
    s_cbranch_vccz Ldone_22
    buffer_load_dword v232, v19, s[52:55], s13 offen sc1
    s_waitcnt vmcnt(1)
    v_cmp_ne_u32 vcc, s9, v233
    s_cbranch_vccz Ldone_22
    s_sub_u32 s11, s11, 1
    s_cbranch_scc0 Lpoll_21
    s_mov_b32 s11, 0
Ldone_22:
    buffer_load_dwordx4 a[0:3], v29, s[48:51], s84 offen offset:0 sc1
    buffer_load_dwordx4 a[4:7], v29, s[48:51], s85 offen offset:0 sc1
    buffer_load_dwordx4 a[8:11], v29, s[48:51], s86 offen offset:0 sc1
    buffer_load_dwordx4 a[12:15], v29, s[48:51], s87 offen offset:0 sc1
    buffer_load_dwordx4 a[16:19], v29, s[48:51], s84 offen offset:128 sc1
    s_barrier
    ds_read_b64_tr_b16 a[200:201], v2 offset:28672
    ds_read_b64_tr_b16 a[202:203], v2 offset:28928
    ds_read_b64_tr_b16 a[204:205], v3 offset:0
    ds_read_b64_tr_b16 a[206:207], v3 offset:256
    ds_read_b64_tr_b16 a[208:209], v2 offset:29696
    ds_read_b64_tr_b16 a[210:211], v2 offset:29952
    ds_read_b64_tr_b16 a[212:213], v3 offset:1024
    ds_read_b64_tr_b16 a[214:215], v3 offset:1280
    s_waitcnt vmcnt(4) lgkmcnt(4)
    v_mfma_f32_32x32x16_bf16 v[112:127], a[200:203], a[0:3], 0
    buffer_load_dwordx2 v[200:201], v16, s[52:55], s14 offen offset:0 sc1
    buffer_load_dwordx2 v[202:203], v16, s[52:55], s14 offen offset:512 sc1
    ds_read_b64_tr_b16 a[216:217], v2 offset:30720
    ds_read_b64_tr_b16 a[218:219], v2 offset:30976
    ds_read_b64_tr_b16 a[224:225], v4 offset:0
    v_mfma_f32_32x32x16_bf16 v[128:143], a[0:3], a[204:207], 0
    buffer_load_dwordx4 a[20:23], v29, s[48:51], s85 offen offset:128 sc1
    ds_read_b64_tr_b16 a[220:221], v3 offset:2048
    ds_read_b64_tr_b16 a[222:223], v3 offset:2304
    ds_read_b64_tr_b16 a[226:227], v4 offset:256
    s_waitcnt vmcnt(6) lgkmcnt(6)
    v_mfma_f32_32x32x16_bf16 v[112:127], a[208:211], a[4:7], v[112:127]
    buffer_load_dwordx2 v[204:205], v16, s[52:55], s14 offen offset:1024 sc1
    buffer_load_dwordx2 v[206:207], v17, s[52:55], s14 offen offset:1536 sc1
    ds_read_b64_tr_b16 a[200:201], v2 offset:31744
    ds_read_b64_tr_b16 a[202:203], v2 offset:32000
    ds_read_b64_tr_b16 a[228:229], v4 offset:2048
    v_mfma_f32_32x32x16_bf16 v[128:143], a[4:7], a[212:215], v[128:143]
    buffer_load_dwordx4 a[24:27], v29, s[48:51], s86 offen offset:128 sc1
    ds_read_b64_tr_b16 a[204:205], v3 offset:3072
    ds_read_b64_tr_b16 a[206:207], v3 offset:3328
    ds_read_b64_tr_b16 a[230:231], v4 offset:2304
    s_waitcnt lgkmcnt(6)
    v_mfma_f32_16x16x32_bf16 v[248:251], a[224:227], a[248:251], 0
    s_waitcnt vmcnt(8)
    v_mfma_f32_32x32x16_bf16 v[112:127], a[216:219], a[8:11], v[112:127]
    buffer_load_dwordx4 a[28:31], v29, s[48:51], s87 offen offset:128 sc1
    ds_read_b64_tr_b16 a[208:209], v2 offset:32768
    ds_read_b64_tr_b16 a[210:211], v2 offset:33024
    ds_read_b64_tr_b16 a[224:225], v4 offset:4096
    v_mfma_f32_32x32x16_bf16 v[128:143], a[8:11], a[220:223], v[128:143]
    buffer_load_dwordx4 a[32:35], v29, s[48:51], s84 offen offset:256 sc1
    ds_read_b64_tr_b16 a[212:213], v3 offset:4096
    ds_read_b64_tr_b16 a[214:215], v3 offset:4352
    ds_read_b64_tr_b16 a[226:227], v4 offset:4352
    s_waitcnt lgkmcnt(6)
    v_mfma_f32_16x16x32_bf16 v[248:251], a[228:231], a[248:251], v[248:251]
    s_waitcnt vmcnt(9)
    v_mfma_f32_32x32x16_bf16 v[112:127], a[200:203], a[12:15], v[112:127]
    buffer_load_dwordx4 a[36:39], v29, s[48:51], s85 offen offset:256 sc1
    ds_read_b64_tr_b16 a[216:217], v2 offset:33792
    ds_read_b64_tr_b16 a[218:219], v2 offset:34048
    ds_read_b64_tr_b16 a[228:229], v4 offset:6144
    v_mfma_f32_32x32x16_bf16 v[128:143], a[12:15], a[204:207], v[128:143]
    ds_read_b64_tr_b16 a[220:221], v3 offset:5120
    ds_read_b64_tr_b16 a[222:223], v3 offset:5376
    ds_read_b64_tr_b16 a[230:231], v4 offset:6400
    s_waitcnt lgkmcnt(6)
    v_mfma_f32_16x16x32_bf16 v[248:251], a[224:227], a[248:251], v[248:251]
    s_waitcnt vmcnt(9)
    v_mfma_f32_32x32x16_bf16 v[112:127], a[208:211], a[16:19], v[112:127]
    buffer_load_dwordx4 a[40:43], v29, s[48:51], s86 offen offset:256 sc1
    ds_read_b64_tr_b16 a[200:201], v2 offset:34816
    ds_read_b64_tr_b16 a[202:203], v2 offset:35072
    ds_read_b64_tr_b16 a[224:225], v4 offset:8192
    v_mfma_f32_32x32x16_bf16 v[128:143], a[16:19], a[212:215], v[128:143]
    buffer_load_dwordx4 a[44:47], v29, s[48:51], s87 offen offset:256 sc1
    ds_read_b64_tr_b16 a[204:205], v3 offset:6144
    ds_read_b64_tr_b16 a[206:207], v3 offset:6400
    ds_read_b64_tr_b16 a[226:227], v4 offset:8448
    s_waitcnt lgkmcnt(6)
    v_mfma_f32_16x16x32_bf16 v[248:251], a[228:231], a[248:251], v[248:251]
    s_waitcnt vmcnt(8)
    v_mfma_f32_32x32x16_bf16 v[112:127], a[216:219], a[20:23], v[112:127]
    buffer_load_dwordx4 a[48:51], v29, s[48:51], s84 offen offset:384 sc1
    ds_read_b64_tr_b16 a[208:209], v2 offset:35840
    ds_read_b64_tr_b16 a[210:211], v2 offset:36096
    v_add_f32 v242, v200, v202
    v_add_f32 v243, v201, v203
    s_waitcnt vmcnt(7)
    v_add_f32 v204, v204, v206
    v_mfma_f32_32x32x16_bf16 v[128:143], a[20:23], a[220:223], v[128:143]
    ds_read_b64_tr_b16 a[212:213], v3 offset:7168
    ds_read_b64_tr_b16 a[214:215], v3 offset:7424
    v_add_f32_e64 v205, v205, v207
    ds_read_b64_tr_b16 a[228:229], v4 offset:10240
    ds_read_b64_tr_b16 a[230:231], v4 offset:10496
    s_waitcnt lgkmcnt(6)
    v_mfma_f32_16x16x32_bf16 v[248:251], a[224:227], a[248:251], v[248:251]
    s_waitcnt vmcnt(6)
    v_mfma_f32_32x32x16_bf16 v[112:127], a[200:203], a[24:27], v[112:127]
    buffer_load_dwordx4 a[52:55], v29, s[48:51], s85 offen offset:384 sc1
    ds_read_b64_tr_b16 a[216:217], v2 offset:36864
    ds_read_b64_tr_b16 a[218:219], v2 offset:37120
    v_add_f32 v242, v242, v204
    v_add_f32 v243, v243, v205
    v_mov_b32_e64 v232, v242
    v_mfma_f32_32x32x16_bf16 v[128:143], a[24:27], a[204:207], v[128:143]
    buffer_load_dwordx4 a[56:59], v29, s[48:51], s86 offen offset:384 sc1
    ds_read_b64_tr_b16 a[220:221], v3 offset:8192
    ds_read_b64_tr_b16 a[222:223], v3 offset:8448
    v_mov_b32_e64 v233, v243
    ds_read_b64_tr_b16 a[224:225], v4 offset:12288
    ds_read_b64_tr_b16 a[226:227], v4 offset:12544
    s_waitcnt lgkmcnt(6)
    v_mfma_f32_16x16x32_bf16 v[248:251], a[228:231], a[248:251], v[248:251]
    s_waitcnt vmcnt(7)
    v_mfma_f32_32x32x16_bf16 v[112:127], a[208:211], a[28:31], v[112:127]
    buffer_load_dwordx4 a[60:63], v29, s[48:51], s87 offen offset:384 sc1
    ds_read_b64_tr_b16 a[200:201], v2 offset:37888
    ds_read_b64_tr_b16 a[202:203], v2 offset:38144
    v_permlane32_swap_b32 v242, v232
    v_permlane32_swap_b32 v243, v233
    v_add_f32_e64 v242, v242, v232
    v_mfma_f32_32x32x16_bf16 v[128:143], a[28:31], a[212:215], v[128:143]
    ds_read_b64_tr_b16 a[204:205], v3 offset:9216
    ds_read_b64_tr_b16 a[206:207], v3 offset:9472
    v_add_f32_e64 v243, v243, v233
    ds_read_b64_tr_b16 a[228:229], v4 offset:14336
    ds_read_b64_tr_b16 a[230:231], v4 offset:14592
    s_waitcnt lgkmcnt(6)
    v_mfma_f32_16x16x32_bf16 v[248:251], a[224:227], a[248:251], v[248:251]
    s_waitcnt vmcnt(7)
    v_mfma_f32_32x32x16_bf16 v[112:127], a[216:219], a[32:35], v[112:127]
    buffer_load_dwordx4 a[64:67], v29, s[48:51], s84 offen offset:512 sc1
    ds_read_b64_tr_b16 a[208:209], v2 offset:38912
    ds_read_b64_tr_b16 a[210:211], v2 offset:39168
    v_mul_f32 v242, 0x3b124925, v242
    v_mul_f32 v243, 0x3b124925, v243
    v_fma_f32 v243, -v242, v242, v243
    v_mfma_f32_32x32x16_bf16 v[128:143], a[32:35], a[220:223], v[128:143]
    ds_read_b64_tr_b16 a[212:213], v3 offset:10240
    ds_read_b64_tr_b16 a[214:215], v3 offset:10496
    v_max_f32_e64 v243, 0, v243
    ds_read_b64_tr_b16 a[224:225], v4 offset:16384
    ds_read_b64_tr_b16 a[226:227], v4 offset:16640
    s_waitcnt lgkmcnt(6)
    v_mfma_f32_16x16x32_bf16 v[248:251], a[228:231], a[248:251], v[248:251]
    s_waitcnt vmcnt(7)
    v_mfma_f32_32x32x16_bf16 v[112:127], a[200:203], a[36:39], v[112:127]
    buffer_load_dwordx4 a[68:71], v29, s[48:51], s85 offen offset:512 sc1
    ds_read_b64_tr_b16 a[216:217], v2 offset:39936
    ds_read_b64_tr_b16 a[218:219], v2 offset:40192
    v_add_f32 v243, 0x3727c5ac, v243
    v_rsq_f32_e64 v234, v243
    v_mfma_f32_32x32x16_bf16 v[128:143], a[36:39], a[204:207], v[128:143]
    ds_read_b64_tr_b16 a[220:221], v3 offset:11264
    ds_read_b64_tr_b16 a[222:223], v3 offset:11520
    ds_read_b64_tr_b16 a[228:229], v4 offset:18432
    ds_read_b64_tr_b16 a[230:231], v4 offset:18688
    s_waitcnt lgkmcnt(6)
    v_mfma_f32_16x16x32_bf16 v[248:251], a[224:227], a[248:251], v[248:251]
    s_waitcnt vmcnt(7)
    v_mfma_f32_32x32x16_bf16 v[112:127], a[208:211], a[40:43], v[112:127]
    buffer_load_dwordx4 a[72:75], v29, s[48:51], s86 offen offset:512 sc1
    ds_read_b64_tr_b16 a[200:201], v2 offset:40960
    ds_read_b64_tr_b16 a[202:203], v2 offset:41216
    v_mul_f32_e64 v235, v234, v242
    v_cndmask_b32_e64 v232, v234, v235, s[62:63]
    ds_write_b32 v25, v232
    v_mfma_f32_32x32x16_bf16 v[128:143], a[40:43], a[212:215], v[128:143]
    ds_read_b64_tr_b16 a[204:205], v3 offset:12288
    ds_read_b64_tr_b16 a[206:207], v3 offset:12544
    ds_read_b64_tr_b16 a[224:225], v4 offset:20480
    ds_read_b64_tr_b16 a[226:227], v4 offset:20736
    s_waitcnt lgkmcnt(7)
    v_mfma_f32_16x16x32_bf16 v[248:251], a[228:231], a[248:251], v[248:251]
    s_waitcnt vmcnt(7)
    v_mfma_f32_32x32x16_bf16 v[112:127], a[216:219], a[44:47], v[112:127]
    buffer_load_dwordx4 a[76:79], v29, s[48:51], s87 offen offset:512 sc1
    ds_read_b64_tr_b16 a[208:209], v2 offset:41984
    ds_read_b64_tr_b16 a[210:211], v2 offset:42240
    ds_read_b128 v[200:203], v26 offset:0
    ds_read_b128 v[204:207], v26 offset:32
    ds_read_b128 v[208:211], v26 offset:64
    v_mfma_f32_32x32x16_bf16 v[128:143], a[44:47], a[220:223], v[128:143]
    ds_read_b64_tr_b16 a[212:213], v3 offset:13312
    ds_read_b64_tr_b16 a[214:215], v3 offset:13568
    ds_read_b128 v[212:215], v26 offset:96
    ds_read_b64_tr_b16 a[228:229], v4 offset:22528
    ds_read_b64_tr_b16 a[230:231], v4 offset:22784
    s_waitcnt lgkmcnt(10)
    v_mfma_f32_16x16x32_bf16 v[248:251], a[224:227], a[248:251], v[248:251]
    s_waitcnt vmcnt(7)
    v_mfma_f32_32x32x16_bf16 v[112:127], a[200:203], a[48:51], v[112:127]
    buffer_load_dwordx4 a[80:83], v29, s[48:51], s84 offen offset:640 sc1
    ds_read_b64_tr_b16 a[216:217], v2 offset:43008
    ds_read_b64_tr_b16 a[218:219], v2 offset:43264
    ds_read_b128 v[216:219], v26 offset:128
    ds_read_b128 v[220:223], v26 offset:160
    ds_read_b128 v[224:227], v26 offset:192
    v_mfma_f32_32x32x16_bf16 v[128:143], a[48:51], a[204:207], v[128:143]
    ds_read_b64_tr_b16 a[220:221], v3 offset:14336
    ds_read_b64_tr_b16 a[222:223], v3 offset:14592
    ds_read_b128 v[228:231], v26 offset:224
    ds_read_b64_tr_b16 a[224:225], v4 offset:24576
    ds_read_b64_tr_b16 a[226:227], v4 offset:24832
    s_waitcnt lgkmcnt(10)
    v_mfma_f32_16x16x32_bf16 v[248:251], a[228:231], a[248:251], v[248:251]
    s_waitcnt vmcnt(7)
    v_mfma_f32_32x32x16_bf16 v[112:127], a[208:211], a[52:55], v[112:127]
    buffer_load_dwordx4 a[84:87], v29, s[48:51], s85 offen offset:640 sc1
    ds_read_b64_tr_b16 a[200:201], v2 offset:44032
    ds_read_b64_tr_b16 a[202:203], v2 offset:44288
    ds_read_b64_tr_b16 a[228:229], v4 offset:26624
    v_mfma_f32_32x32x16_bf16 v[128:143], a[52:55], a[212:215], v[128:143]
    ds_read_b64_tr_b16 a[204:205], v3 offset:15360
    ds_read_b64_tr_b16 a[206:207], v3 offset:15616
    ds_read_b64_tr_b16 a[230:231], v4 offset:26880
    s_waitcnt lgkmcnt(6)
    v_mfma_f32_16x16x32_bf16 v[248:251], a[224:227], a[248:251], v[248:251]
    s_waitcnt vmcnt(7)
    v_mfma_f32_32x32x16_bf16 v[112:127], a[216:219], a[56:59], v[112:127]
    buffer_load_dwordx4 a[88:91], v29, s[48:51], s86 offen offset:640 sc1
    ds_read_b64_tr_b16 a[208:209], v2 offset:45056
    ds_read_b64_tr_b16 a[210:211], v2 offset:45312
    v_mfma_f32_32x32x16_bf16 v[128:143], a[56:59], a[220:223], v[128:143]
    ds_read_b64_tr_b16 a[212:213], v3 offset:16384
    ds_read_b64_tr_b16 a[214:215], v3 offset:16640
    s_waitcnt lgkmcnt(4)
    v_mfma_f32_16x16x32_bf16 v[248:251], a[228:231], a[248:251], v[248:251]
    s_waitcnt vmcnt(7)
    v_mfma_f32_32x32x16_bf16 v[112:127], a[200:203], a[60:63], v[112:127]
    buffer_load_dwordx4 a[92:95], v29, s[48:51], s87 offen offset:640 sc1
    ds_read_b64_tr_b16 a[216:217], v2 offset:46080
    ds_read_b64_tr_b16 a[218:219], v2 offset:46336
    v_mfma_f32_32x32x16_bf16 v[128:143], a[60:63], a[204:207], v[128:143]
    ds_read_b64_tr_b16 a[220:221], v3 offset:17408
    ds_read_b64_tr_b16 a[222:223], v3 offset:17664
    s_mov_b64 exec, s[20:21]
    ds_write_b128 v94, v[248:251] offset:384
    s_mov_b64 exec, -1
    s_waitcnt vmcnt(7) lgkmcnt(5)
    v_mfma_f32_32x32x16_bf16 v[112:127], a[208:211], a[64:67], v[112:127]
    buffer_load_dwordx4 a[96:99], v29, s[48:51], s84 offen offset:768 sc1
    ds_read_b64_tr_b16 a[200:201], v2 offset:47104
    ds_read_b64_tr_b16 a[202:203], v2 offset:47360
    v_mfma_f32_32x32x16_bf16 v[128:143], a[64:67], a[212:215], v[128:143]
    ds_read_b64_tr_b16 a[204:205], v3 offset:18432
    ds_read_b64_tr_b16 a[206:207], v3 offset:18688
    s_waitcnt lgkmcnt(4)
    s_barrier
    s_waitcnt vmcnt(7)
    v_mfma_f32_32x32x16_bf16 v[112:127], a[216:219], a[68:71], v[112:127]
    buffer_load_dwordx4 a[100:103], v29, s[48:51], s85 offen offset:768 sc1
    ds_read_b64_tr_b16 a[208:209], v2 offset:48128
    ds_read_b64_tr_b16 a[210:211], v2 offset:48384
    ds_read_b128 v[184:187], v27 offset:512
    ds_read_b128 v[188:191], v27 offset:544
    v_mfma_f32_32x32x16_bf16 v[128:143], a[68:71], a[220:223], v[128:143]
    ds_read_b64_tr_b16 a[212:213], v3 offset:19456
    ds_read_b64_tr_b16 a[214:215], v3 offset:19712
    ds_read_b128 v[192:195], v27 offset:576
    s_waitcnt vmcnt(7) lgkmcnt(7)
    v_mfma_f32_32x32x16_bf16 v[112:127], a[200:203], a[72:75], v[112:127]
    buffer_load_dwordx4 a[104:107], v29, s[48:51], s86 offen offset:768 sc1
    ds_read_b64_tr_b16 a[216:217], v2 offset:49152
    ds_read_b64_tr_b16 a[218:219], v2 offset:49408
    ds_read_b128 v[196:199], v27 offset:608
    v_mfma_f32_32x32x16_bf16 v[128:143], a[72:75], a[204:207], v[128:143]
    ds_read_b64_tr_b16 a[220:221], v3 offset:20480
    ds_read_b64_tr_b16 a[222:223], v3 offset:20736
    ds_read_b32 v239, v28 offset:384
    s_waitcnt vmcnt(7) lgkmcnt(7)
    v_mfma_f32_32x32x16_bf16 v[112:127], a[208:211], a[76:79], v[112:127]
    buffer_load_dwordx4 a[108:111], v29, s[48:51], s87 offen offset:768 sc1
    ds_read_b64_tr_b16 a[200:201], v2 offset:50176
    ds_read_b64_tr_b16 a[202:203], v2 offset:50432
    v_mfma_f32_32x32x16_bf16 v[128:143], a[76:79], a[212:215], v[128:143]
    ds_read_b64_tr_b16 a[204:205], v3 offset:21504
    ds_read_b64_tr_b16 a[206:207], v3 offset:21760
    s_waitcnt vmcnt(7) lgkmcnt(5)
    v_mfma_f32_32x32x16_bf16 v[112:127], a[216:219], a[80:83], v[112:127]
    v_mul_u32_u24 v253, 128, v0
    s_mul_i32 s69, s17, 3136
    s_add_u32 s69, s69, 0
    s_bfm_b64 exec, 25, 0
    buffer_load_dword a255, v253, s[44:47], s69 offen
    s_mov_b64 exec, -1
    ds_read_b64_tr_b16 a[208:209], v2 offset:51200
    ds_read_b64_tr_b16 a[210:211], v2 offset:51456
    v_mul_f32 v184, v235, v184
    v_mul_f32 v185, v235, v185
    v_mul_f32_e64 v186, v235, v186
    v_mfma_f32_32x32x16_bf16 v[128:143], a[80:83], a[220:223], v[128:143]
    ds_read_b64_tr_b16 a[212:213], v3 offset:22528
    ds_read_b64_tr_b16 a[214:215], v3 offset:22784
    v_mul_f32_e64 v187, v235, v187
    v_mul_f32 v188, v235, v188
    s_waitcnt vmcnt(7) lgkmcnt(4)
    v_mfma_f32_32x32x16_bf16 v[112:127], a[200:203], a[84:87], v[112:127]
    ds_read_b64_tr_b16 a[216:217], v2 offset:52224
    ds_read_b64_tr_b16 a[218:219], v2 offset:52480
    v_mul_f32 v189, v235, v189
    v_mul_f32 v190, v235, v190
    v_mul_f32_e64 v191, v235, v191
    v_mfma_f32_32x32x16_bf16 v[128:143], a[84:87], a[204:207], v[128:143]
    ds_read_b64_tr_b16 a[220:221], v3 offset:23552
    ds_read_b64_tr_b16 a[222:223], v3 offset:23808
    v_mul_f32_e64 v192, v235, v192
    v_mul_f32 v193, v235, v193
    s_waitcnt vmcnt(6) lgkmcnt(4)
    v_mfma_f32_32x32x16_bf16 v[112:127], a[208:211], a[88:91], v[112:127]
    ds_read_b64_tr_b16 a[200:201], v2 offset:53248
    ds_read_b64_tr_b16 a[202:203], v2 offset:53504
    v_mul_f32 v194, v235, v194
    v_mul_f32 v195, v235, v195
    v_mul_f32_e64 v196, v235, v196
    v_mfma_f32_32x32x16_bf16 v[128:143], a[88:91], a[212:215], v[128:143]
    ds_read_b64_tr_b16 a[204:205], v3 offset:24576
    ds_read_b64_tr_b16 a[206:207], v3 offset:24832
    v_mul_f32 v197, v235, v197
    v_mul_f32 v198, v235, v198
    s_waitcnt vmcnt(5) lgkmcnt(4)
    v_mfma_f32_32x32x16_bf16 v[112:127], a[216:219], a[92:95], v[112:127]
    s_add_u32 s77, s77, 1
    s_cmp_eq_u32 s77, 7
    s_cselect_b32 s77, 0, s77
    s_lshl_b32 s78, s77, 12
    s_add_u32 s78, s78, s59
    s_mul_i32 s79, s77, 172032
    s_add_u32 s79, s79, s60
    s_lshl_b32 s80, s77, 7
    s_add_u32 m0, s78, 0
    s_add_u32 s69, s79, 0
    buffer_load_dwordx4 v22, s[36:39], s69 offen lds
    ds_read_b64_tr_b16 a[208:209], v2 offset:54272
    ds_read_b64_tr_b16 a[210:211], v2 offset:54528
    v_mul_f32 v199, v235, v199
    v_mul_f32 v216, v239, v216
    v_mul_f32_e64 v217, v239, v217
    v_mfma_f32_32x32x16_bf16 v[128:143], a[92:95], a[220:223], v[128:143]
    ds_read_b64_tr_b16 a[212:213], v3 offset:25600
    ds_read_b64_tr_b16 a[214:215], v3 offset:25856
    v_mul_f32 v218, v239, v218
    v_mul_f32 v219, v239, v219
    s_waitcnt vmcnt(5) lgkmcnt(4)
    v_mfma_f32_32x32x16_bf16 v[112:127], a[200:203], a[96:99], v[112:127]
    s_add_u32 s77, s77, 1
    s_cmp_eq_u32 s77, 7
    s_cselect_b32 s77, 0, s77
    s_lshl_b32 s78, s77, 12
    s_add_u32 s78, s78, s59
    s_mul_i32 s79, s77, 172032
    s_add_u32 s79, s79, s60
    s_lshl_b32 s80, s77, 7
    s_add_u32 m0, s78, 0
    s_add_u32 s69, s79, 0
    buffer_load_dwordx4 v22, s[36:39], s69 offen lds
    ds_read_b64_tr_b16 a[216:217], v2 offset:55296
    ds_read_b64_tr_b16 a[218:219], v2 offset:55552
    v_mul_f32 v220, v239, v220
    v_mul_f32 v221, v239, v221
    v_mul_f32_e64 v222, v239, v222
    v_mfma_f32_32x32x16_bf16 v[128:143], a[96:99], a[204:207], v[128:143]
    ds_read_b64_tr_b16 a[220:221], v3 offset:26624
    ds_read_b64_tr_b16 a[222:223], v3 offset:26880
    v_mul_f32 v223, v239, v223
    v_mul_f32 v224, v239, v224
    s_waitcnt vmcnt(5) lgkmcnt(4)
    v_mfma_f32_32x32x16_bf16 v[112:127], a[208:211], a[100:103], v[112:127]
    s_add_u32 s77, s77, 1
    s_cmp_eq_u32 s77, 7
    s_cselect_b32 s77, 0, s77
    s_lshl_b32 s78, s77, 12
    s_add_u32 s78, s78, s59
    s_mul_i32 s79, s77, 172032
    s_add_u32 s79, s79, s60
    s_lshl_b32 s80, s77, 7
    s_add_u32 m0, s78, 0
    s_add_u32 s69, s79, 0
    buffer_load_dwordx4 v22, s[36:39], s69 offen lds
    ds_read_b64_tr_b16 a[200:201], v2 offset:56320
    ds_read_b64_tr_b16 a[202:203], v2 offset:56576
    v_mul_f32 v225, v239, v225
    v_mul_f32 v226, v239, v226
    v_mul_f32_e64 v227, v239, v227
    v_mfma_f32_32x32x16_bf16 v[128:143], a[100:103], a[212:215], v[128:143]
    ds_read_b64_tr_b16 a[204:205], v3 offset:27648
    ds_read_b64_tr_b16 a[206:207], v3 offset:27904
    v_mul_f32 v228, v239, v228
    v_mul_f32 v229, v239, v229
    s_waitcnt vmcnt(5) lgkmcnt(4)
    v_mfma_f32_32x32x16_bf16 v[112:127], a[216:219], a[104:107], v[112:127]
    s_add_u32 s77, s77, 1
    s_cmp_eq_u32 s77, 7
    s_cselect_b32 s77, 0, s77
    s_lshl_b32 s78, s77, 12
    s_add_u32 s78, s78, s59
    s_mul_i32 s79, s77, 172032
    s_add_u32 s79, s79, s60
    s_lshl_b32 s80, s77, 7
    s_add_u32 m0, s78, 0
    s_add_u32 s69, s79, 0
    buffer_load_dwordx4 v22, s[36:39], s69 offen lds
    v_mul_f32_e64 v230, v239, v230
    v_mfma_f32_32x32x16_bf16 v[128:143], a[104:107], a[220:223], v[128:143]
    v_mul_f32_e64 v231, v239, v231
    s_waitcnt vmcnt(5) lgkmcnt(0)
    v_mfma_f32_32x32x16_bf16 v[112:127], a[200:203], a[108:111], v[112:127]
    s_add_u32 s77, s77, 1
    s_cmp_eq_u32 s77, 7
    s_cselect_b32 s77, 0, s77
    s_lshl_b32 s78, s77, 12
    s_add_u32 s78, s78, s59
    s_mul_i32 s79, s77, 172032
    s_add_u32 s79, s79, s60
    s_lshl_b32 s80, s77, 7
    s_add_u32 m0, s78, 0
    s_add_u32 s69, s79, 0
    buffer_load_dwordx4 v22, s[36:39], s69 offen lds
    v_mfma_f32_32x32x16_bf16 v[128:143], a[108:111], a[204:207], v[128:143]
    v_pk_fma_f32 v[112:113], v[112:113], v[234:235], v[184:185] op_sel_hi:[1,0,1] neg_lo:[0,0,1] neg_hi:[0,0,1]
    v_pk_fma_f32 v[114:115], v[114:115], v[234:235], v[186:187] op_sel_hi:[1,0,1] neg_lo:[0,0,1] neg_hi:[0,0,1]
    v_pk_fma_f32 v[116:117], v[116:117], v[234:235], v[188:189] op_sel_hi:[1,0,1] neg_lo:[0,0,1] neg_hi:[0,0,1]
    v_pk_fma_f32 v[118:119], v[118:119], v[234:235], v[190:191] op_sel_hi:[1,0,1] neg_lo:[0,0,1] neg_hi:[0,0,1]
    v_pk_fma_f32 v[120:121], v[120:121], v[234:235], v[192:193] op_sel_hi:[1,0,1] neg_lo:[0,0,1] neg_hi:[0,0,1]
    v_pk_fma_f32 v[122:123], v[122:123], v[234:235], v[194:195] op_sel_hi:[1,0,1] neg_lo:[0,0,1] neg_hi:[0,0,1]
    v_pk_fma_f32 v[124:125], v[124:125], v[234:235], v[196:197] op_sel_hi:[1,0,1] neg_lo:[0,0,1] neg_hi:[0,0,1]
    v_pk_fma_f32 v[126:127], v[126:127], v[234:235], v[198:199] op_sel_hi:[1,0,1] neg_lo:[0,0,1] neg_hi:[0,0,1]
    v_cvt_pk_bf16_f32 v144, v112, v113
    v_cvt_pk_bf16_f32 v145, v114, v115
    v_cvt_pk_bf16_f32 v146, v116, v117
    v_cvt_pk_bf16_f32 v147, v118, v119
    v_cvt_pk_bf16_f32 v148, v120, v121
    v_cvt_pk_bf16_f32 v149, v122, v123
    v_cvt_pk_bf16_f32 v150, v124, v125
    v_cvt_pk_bf16_f32 v151, v126, v127
    v_mfma_f32_32x32x16_bf16 v[112:127], v[68:71], v[144:147], 0
    s_nop 0
    s_nop 0
    v_mfma_f32_32x32x16_bf16 v[112:127], v[72:75], v[148:151], v[112:127]
    v_pk_fma_f32 v[128:129], v[128:129], v[200:201], v[216:217] neg_lo:[0,0,1] neg_hi:[0,0,1]
    v_pk_fma_f32 v[130:131], v[130:131], v[202:203], v[218:219] neg_lo:[0,0,1] neg_hi:[0,0,1]
    v_pk_fma_f32 v[132:133], v[132:133], v[204:205], v[220:221] neg_lo:[0,0,1] neg_hi:[0,0,1]
    v_pk_fma_f32 v[134:135], v[134:135], v[206:207], v[222:223] neg_lo:[0,0,1] neg_hi:[0,0,1]
    v_pk_fma_f32 v[136:137], v[136:137], v[208:209], v[224:225] neg_lo:[0,0,1] neg_hi:[0,0,1]
    v_pk_fma_f32 v[138:139], v[138:139], v[210:211], v[226:227] neg_lo:[0,0,1] neg_hi:[0,0,1]
    v_pk_fma_f32 v[140:141], v[140:141], v[212:213], v[228:229] neg_lo:[0,0,1] neg_hi:[0,0,1]
    v_pk_fma_f32 v[142:143], v[142:143], v[214:215], v[230:231] neg_lo:[0,0,1] neg_hi:[0,0,1]
    v_cvt_pk_bf16_f32 v152, v128, v129
    v_cvt_pk_bf16_f32 v153, v130, v131
    v_cvt_pk_bf16_f32 v154, v132, v133
    v_cvt_pk_bf16_f32 v155, v134, v135
    v_cvt_pk_bf16_f32 v156, v136, v137
    v_cvt_pk_bf16_f32 v157, v138, v139
    v_cvt_pk_bf16_f32 v158, v140, v141
    v_cvt_pk_bf16_f32 v159, v142, v143
    v_cndmask_b32_e64 v152, v152, v82, s[18:19]
    v_cndmask_b32_e64 v153, v153, v82, s[18:19]
    v_cndmask_b32_e64 v154, v154, v82, s[18:19]
    v_cndmask_b32_e64 v155, v155, v82, s[18:19]
    v_cndmask_b32_e64 v156, v156, v82, s[18:19]
    v_cndmask_b32_e64 v157, v157, v82, s[18:19]
    v_cndmask_b32_e64 v158, v158, v82, s[18:19]
    v_cndmask_b32_e64 v159, v159, v82, s[18:19]
    ds_write_b128 v89, v[152:155]
    ds_write_b128 v89, v[156:159] offset:1024
    v_max3_f32 v232, v112, v113, v114
    v_min3_f32 v233, v112, v113, v114
    v_max3_f32 v232, v232, v115, v116
    v_min3_f32 v233, v233, v115, v116
    v_max3_f32 v232, v232, v117, v118
    v_min3_f32 v233, v233, v117, v118
    v_max3_f32 v232, v232, v120, v121
    v_min3_f32 v233, v233, v120, v121
    v_max3_f32 v232, v232, v122, v123
    v_min3_f32 v233, v233, v122, v123
    v_max3_f32 v232, v232, v124, v125
    v_min3_f32 v233, v233, v124, v125
    v_max_f32 v232, v232, v126
    v_min_f32 v233, v233, v126
    v_mov_b32 v242, v232
    v_mov_b32 v243, v233
    s_mov_b32 s64, 0x3fb8aa3b
    s_mov_b32 s65, 0x3fb8aa3b
    v_permlane32_swap_b32 v232, v242
    v_permlane32_swap_b32 v233, v243
    v_max_f32 v232, v232, v242
    v_min_f32 v233, v233, v243
    v_mul_f32 v232, s64, v232
    v_mul_f32 v233, s64, v233
    v_pk_fma_f32 v[184:185], v[112:113], s[64:65], v[232:233] op_sel:[0,0,1] neg_lo:[1,0,0] neg_hi:[1,0,0]
    v_pk_fma_f32 v[112:113], v[112:113], s[64:65], v[232:233] op_sel_hi:[1,1,0] neg_lo:[0,0,1] neg_hi:[0,0,1]
    v_pk_fma_f32 v[186:187], v[114:115], s[64:65], v[232:233] op_sel:[0,0,1] neg_lo:[1,0,0] neg_hi:[1,0,0]
    v_pk_fma_f32 v[114:115], v[114:115], s[64:65], v[232:233] op_sel_hi:[1,1,0] neg_lo:[0,0,1] neg_hi:[0,0,1]
    v_pk_fma_f32 v[188:189], v[116:117], s[64:65], v[232:233] op_sel:[0,0,1] neg_lo:[1,0,0] neg_hi:[1,0,0]
    v_pk_fma_f32 v[116:117], v[116:117], s[64:65], v[232:233] op_sel_hi:[1,1,0] neg_lo:[0,0,1] neg_hi:[0,0,1]
    v_pk_fma_f32 v[190:191], v[118:119], s[64:65], v[232:233] op_sel:[0,0,1] neg_lo:[1,0,0] neg_hi:[1,0,0]
    v_pk_fma_f32 v[118:119], v[118:119], s[64:65], v[232:233] op_sel_hi:[1,1,0] neg_lo:[0,0,1] neg_hi:[0,0,1]
    v_pk_fma_f32 v[192:193], v[120:121], s[64:65], v[232:233] op_sel:[0,0,1] neg_lo:[1,0,0] neg_hi:[1,0,0]
    v_pk_fma_f32 v[120:121], v[120:121], s[64:65], v[232:233] op_sel_hi:[1,1,0] neg_lo:[0,0,1] neg_hi:[0,0,1]
    v_pk_fma_f32 v[194:195], v[122:123], s[64:65], v[232:233] op_sel:[0,0,1] neg_lo:[1,0,0] neg_hi:[1,0,0]
    v_pk_fma_f32 v[122:123], v[122:123], s[64:65], v[232:233] op_sel_hi:[1,1,0] neg_lo:[0,0,1] neg_hi:[0,0,1]
    v_pk_fma_f32 v[196:197], v[124:125], s[64:65], v[232:233] op_sel:[0,0,1] neg_lo:[1,0,0] neg_hi:[1,0,0]
    v_pk_fma_f32 v[124:125], v[124:125], s[64:65], v[232:233] op_sel_hi:[1,1,0] neg_lo:[0,0,1] neg_hi:[0,0,1]
    v_pk_fma_f32 v[198:199], v[126:127], s[64:65], v[232:233] op_sel:[0,0,1] neg_lo:[1,0,0] neg_hi:[1,0,0]
    v_pk_fma_f32 v[126:127], v[126:127], s[64:65], v[232:233] op_sel_hi:[1,1,0] neg_lo:[0,0,1] neg_hi:[0,0,1]
    v_exp_f32 v112, v112
    v_exp_f32 v184, v184
    v_exp_f32 v113, v113
    v_exp_f32 v185, v185
    v_exp_f32 v114, v114
    v_exp_f32 v186, v186
    v_exp_f32 v115, v115
    v_exp_f32 v187, v187
    v_exp_f32 v116, v116
    v_exp_f32 v188, v188
    v_exp_f32 v117, v117
    v_exp_f32 v189, v189
    v_exp_f32 v118, v118
    v_exp_f32 v190, v190
    v_exp_f32 v120, v120
    v_exp_f32 v192, v192
    v_exp_f32 v121, v121
    v_exp_f32 v193, v193
    v_exp_f32 v122, v122
    v_exp_f32 v194, v194
    v_exp_f32 v123, v123
    v_exp_f32 v195, v195
    v_exp_f32 v124, v124
    v_exp_f32 v196, v196
    v_exp_f32 v125, v125
    v_exp_f32 v197, v197
    v_exp_f32 v126, v126
    v_exp_f32 v198, v198
    v_pk_add_f32 v[244:245], v[112:113], v[114:115]
    v_pk_add_f32 v[246:247], v[184:185], v[186:187]
    v_pk_add_f32 v[244:245], v[244:245], v[116:117]
    v_pk_add_f32 v[246:247], v[246:247], v[188:189]
    v_pk_add_f32 v[244:245], v[244:245], v[120:121]
    v_pk_add_f32 v[246:247], v[246:247], v[192:193]
    v_pk_add_f32 v[244:245], v[244:245], v[122:123]
    v_pk_add_f32 v[246:247], v[246:247], v[194:195]
    v_pk_add_f32 v[244:245], v[244:245], v[124:125]
    v_pk_add_f32 v[246:247], v[246:247], v[196:197]
    v_add_f32 v244, v244, v245
    v_add_f32 v246, v246, v247
    v_add_f32 v242, v118, v126
    v_add_f32 v243, v190, v198
    v_add_f32 v244, v244, v242
    v_add_f32 v246, v246, v243
    v_mov_b32 v242, v244
    v_mov_b32 v243, v246
    s_nop 0
    v_permlane32_swap_b32 v244, v242
    v_permlane32_swap_b32 v246, v243
    v_add_f32 v244, v244, v242
    v_add_f32 v246, v246, v243
    v_rcp_f32 v244, v244
    v_rcp_f32_e64 v246, v246
    v_pk_mul_f32 v[112:113], v[112:113], v[244:245] op_sel_hi:[1,0]
    v_pk_mul_f32 v[114:115], v[114:115], v[244:245] op_sel_hi:[1,0]
    v_pk_mul_f32 v[116:117], v[116:117], v[244:245] op_sel_hi:[1,0]
    v_pk_mul_f32 v[118:119], v[118:119], v[244:245] op_sel_hi:[1,0]
    v_pk_mul_f32 v[120:121], v[120:121], v[244:245] op_sel_hi:[1,0]
    v_pk_mul_f32 v[122:123], v[122:123], v[244:245] op_sel_hi:[1,0]
    v_pk_mul_f32 v[124:125], v[124:125], v[244:245] op_sel_hi:[1,0]
    v_pk_mul_f32 v[126:127], v[126:127], v[244:245] op_sel_hi:[1,0]
    v_cvt_pk_bf16_f32 v168, v112, v113
    v_cvt_pk_bf16_f32 v169, v114, v115
    v_cvt_pk_bf16_f32 v170, v116, v117
    v_cvt_pk_bf16_f32 v171, v118, 0
    v_cvt_pk_bf16_f32 v172, v120, v121
    v_cvt_pk_bf16_f32 v173, v122, v123
    v_cvt_pk_bf16_f32 v174, v124, v125
    v_cvt_pk_bf16_f32 v175, v126, 0
    ds_write_b128 v88, v[168:171] offset:0
    ds_write_b128 v88, v[172:175] offset:32
    v_pk_mul_f32 v[184:185], v[184:185], v[246:247] op_sel_hi:[1,0]
    v_pk_mul_f32 v[186:187], v[186:187], v[246:247] op_sel_hi:[1,0]
    v_pk_mul_f32 v[188:189], v[188:189], v[246:247] op_sel_hi:[1,0]
    v_pk_mul_f32 v[190:191], v[190:191], v[246:247] op_sel_hi:[1,0]
    v_pk_mul_f32 v[192:193], v[192:193], v[246:247] op_sel_hi:[1,0]
    v_pk_mul_f32 v[194:195], v[194:195], v[246:247] op_sel_hi:[1,0]
    v_pk_mul_f32 v[196:197], v[196:197], v[246:247] op_sel_hi:[1,0]
    v_pk_mul_f32 v[198:199], v[198:199], v[246:247] op_sel_hi:[1,0]
    v_cvt_pk_bf16_f32 v176, v184, v185
    v_cvt_pk_bf16_f32 v177, v186, v187
    v_cvt_pk_bf16_f32 v178, v188, v189
    v_cvt_pk_bf16_f32 v179, v190, 0
    v_cvt_pk_bf16_f32 v180, v192, v193
    v_cvt_pk_bf16_f32 v181, v194, v195
    v_cvt_pk_bf16_f32 v182, v196, v197
    v_cvt_pk_bf16_f32 v183, v198, 0
    ds_write_b128 v88, v[176:179] offset:64
    ds_write_b128 v88, v[180:183] offset:96
    s_waitcnt vmcnt(0)
    s_waitcnt lgkmcnt(0)
    s_barrier
    s_nop 0
    v_xor_b32 v242, 256, v91
    ds_read_b64_tr_b16 v[200:201], v90 offset:0
    ds_read_b64_tr_b16 v[202:203], v90 offset:1152
    ds_read_b128 v[116:119], v242 offset:0
    ds_read_b64_tr_b16 v[204:205], v90 offset:4608
    ds_read_b64_tr_b16 v[206:207], v90 offset:5760
    ds_read_b128 v[124:127], v242 offset:2048
    ds_read_b64_tr_b16 v[208:209], v90 offset:9216
    ds_read_b64_tr_b16 v[210:211], v90 offset:10368
    ds_read_b128 v[132:135], v242 offset:4096
    ds_read_b64_tr_b16 v[212:213], v90 offset:13824
    ds_read_b64_tr_b16 v[214:215], v90 offset:14976
    ds_read_b128 v[140:143], v242 offset:6144
    ds_read_b128 v[112:115], v91 offset:0
    ds_read_b128 v[120:123], v91 offset:2048
    ds_read_b128 v[128:131], v91 offset:4096
    ds_read_b128 v[136:139], v91 offset:6144
    s_waitcnt lgkmcnt(13)
    v_mfma_f32_16x16x32_bf16 v[248:251], v[200:203], v[116:119], 0
    s_waitcnt lgkmcnt(10)
    v_mfma_f32_16x16x32_bf16 v[248:251], v[204:207], v[124:127], v[248:251]
    s_waitcnt lgkmcnt(7)
    v_mfma_f32_16x16x32_bf16 v[248:251], v[208:211], v[132:135], v[248:251]
    s_waitcnt lgkmcnt(4)
    v_mfma_f32_16x16x32_bf16 v[248:251], v[212:215], v[140:143], v[248:251]
    s_lshl_b32 s13, s6, 2
    s_add_u32 s13, s13, s7
    s_lshl_b32 s56, s13, 13
    s_add_u32 s56, s56, 1048576
    s_lshl_b32 s13, s13, 10
    s_lshl_b32 s14, s8, 16
    s_add_u32 s13, s13, s14
    s_add_u32 s13, s13, 3145728
    s_xor_b32 s14, s13, 0x10000
    s_add_u32 s15, s9, 1
    v_mov_b32 v146, s15
    v_mov_b32 v147, s15
    v_mov_b32 v241, s22
    v_cvt_pk_bf16_f32 v144, v248, v249
    v_cvt_pk_bf16_f32 v145, v250, v251
    s_cmp_lg_u32 s10, 0
    s_cbranch_scc1 Lslow_23
    buffer_store_dwordx4 v[144:147], v1, s[52:55], s13 offen
Ljoin_24:
    s_waitcnt lgkmcnt(3)
    v_mfma_f32_16x16x32_bf16 v[244:247], v[200:203], v[112:115], 0
    s_waitcnt lgkmcnt(2)
    v_mfma_f32_16x16x32_bf16 v[244:247], v[204:207], v[120:123], v[244:247]
    s_waitcnt lgkmcnt(1)
    v_mfma_f32_16x16x32_bf16 v[244:247], v[208:211], v[128:131], v[244:247]
    s_waitcnt lgkmcnt(0)
    v_mfma_f32_16x16x32_bf16 v[244:247], v[212:215], v[136:139], v[244:247]
    s_barrier
    ds_read_b64_tr_b16 a[228:229], v2 offset:0
    ds_read_b64_tr_b16 a[230:231], v2 offset:256
    ds_read_b64_tr_b16 a[232:233], v2 offset:1024
    ds_read_b64_tr_b16 a[234:235], v2 offset:1280
    ds_read_b64_tr_b16 a[236:237], v2 offset:2048
    ds_read_b64_tr_b16 a[238:239], v2 offset:2304
    v_add_u32 v254, s59, v1
    v_add_u32 v255, 57344, v254
    s_lshl_b32 s80, s76, 1
    s_waitcnt lgkmcnt(4)
    v_mfma_f32_32x32x16_bf16 v[96:111], a[228:231], a[0:3], 0
    s_add_u32 m0, s58, 0
    s_add_u32 s69, s68, 0
    buffer_load_dwordx4 v20, s[44:47], s69 offen lds
    ds_read_b64_tr_b16 a[240:241], v2 offset:3072
    ds_read_b64_tr_b16 a[242:243], v2 offset:3328
    ds_read_b64_tr_b16 v[216:217], v5 offset:0
    ds_read_b64_tr_b16 v[218:219], v5 offset:256
    s_waitcnt lgkmcnt(6)
    v_mfma_f32_32x32x16_bf16 v[112:127], a[232:235], a[4:7], 0
    s_add_u32 m0, s58, 1024
    s_add_u32 s69, s68, 7168
    buffer_load_dwordx4 v21, s[44:47], s69 offen lds
    ds_read_b64_tr_b16 a[228:229], v2 offset:4096
    ds_read_b64_tr_b16 a[230:231], v2 offset:4352
    s_waitcnt lgkmcnt(6)
    v_mfma_f32_32x32x16_bf16 v[96:111], a[236:239], a[8:11], v[96:111]
    s_add_u32 m0, s58, 2048
    s_add_u32 s69, s68, 14336
    buffer_load_dwordx4 v20, s[44:47], s69 offen lds
    ds_read_b64_tr_b16 a[232:233], v2 offset:5120
    ds_read_b64_tr_b16 a[234:235], v2 offset:5376
    ds_read_b64_tr_b16 v[220:221], v5 offset:2048
    ds_read_b64_tr_b16 v[222:223], v5 offset:2304
    s_waitcnt lgkmcnt(8)
    v_mfma_f32_32x32x16_bf16 v[112:127], a[240:243], a[12:15], v[112:127]
    buffer_load_dwordx4 v[152:155], v1, s[52:55], s14 offen sc1
    ds_read_b64_tr_b16 a[236:237], v2 offset:6144
    ds_read_b64_tr_b16 a[238:239], v2 offset:6400
    s_waitcnt lgkmcnt(8)
    v_mfma_f32_16x16x32_bf16 v[248:251], v[216:219], a[248:251], 0
    s_waitcnt lgkmcnt(6)
    v_mfma_f32_32x32x16_bf16 v[96:111], a[228:231], a[16:19], v[96:111]
    ds_read_b64_tr_b16 a[240:241], v2 offset:7168
    ds_read_b64_tr_b16 a[242:243], v2 offset:7424
    ds_read_b64_tr_b16 v[216:217], v5 offset:4096
    ds_read_b64_tr_b16 v[218:219], v5 offset:4352
    s_waitcnt lgkmcnt(8)
    v_mfma_f32_32x32x16_bf16 v[112:127], a[232:235], a[20:23], v[112:127]
    ds_read_b64_tr_b16 a[228:229], v2 offset:8192
    ds_read_b64_tr_b16 a[230:231], v2 offset:8448
    s_waitcnt lgkmcnt(8)
    v_mfma_f32_16x16x32_bf16 v[248:251], v[220:223], a[248:251], v[248:251]
    s_waitcnt lgkmcnt(6)
    v_mfma_f32_32x32x16_bf16 v[96:111], a[236:239], a[24:27], v[96:111]
    ds_read_b64_tr_b16 a[232:233], v2 offset:9216
    ds_read_b64_tr_b16 a[234:235], v2 offset:9472
    ds_read_b64_tr_b16 v[220:221], v5 offset:6144
    ds_read_b64_tr_b16 v[222:223], v5 offset:6400
    s_waitcnt lgkmcnt(8)
    v_mfma_f32_32x32x16_bf16 v[112:127], a[240:243], a[28:31], v[112:127]
    ds_read_b64_tr_b16 a[236:237], v2 offset:10240
    ds_read_b64_tr_b16 a[238:239], v2 offset:10496
    s_waitcnt lgkmcnt(8)
    v_mfma_f32_16x16x32_bf16 v[248:251], v[216:219], a[248:251], v[248:251]
    s_waitcnt lgkmcnt(6)
    v_mfma_f32_32x32x16_bf16 v[96:111], a[228:231], a[32:35], v[96:111]
    ds_read_b64_tr_b16 a[240:241], v2 offset:11264
    ds_read_b64_tr_b16 a[242:243], v2 offset:11520
    ds_read_b64_tr_b16 v[216:217], v5 offset:8192
    ds_read_b64_tr_b16 v[218:219], v5 offset:8448
Lpair_25:
    buffer_load_dwordx4 v[156:159], v1, s[52:55], s14 offen sc1
    s_waitcnt vmcnt(1)
    v_cmp_ne_u32 vcc, s15, v155
    s_cbranch_vccz Lpaird_27
    buffer_load_dwordx4 v[152:155], v1, s[52:55], s14 offen sc1
    s_waitcnt vmcnt(1)
    v_cmp_ne_u32 vcc, s15, v159
    s_cbranch_vccz Lpairb_26
    s_sub_u32 s11, s11, 1
    s_cbranch_scc0 Lpair_25
    s_mov_b32 s11, 0
Lpairb_26:
    v_mov_b64 v[148:149], v[156:157]
    s_branch Lpaird_27_j
Lpaird_27:
    v_mov_b64 v[148:149], v[152:153]
Lpaird_27_j:
    v_lshlrev_b32 v160, 16, v148
    v_and_b32 v161, 0xffff0000, v148
    v_lshlrev_b32_e64 v162, 16, v149
    v_and_b32 v163, 0xffff0000, v149
    s_lshl_b32 s13, s4, 10
    s_add_u32 s13, s13, s56
    v_pk_add_f32 v[244:245], v[244:245], v[160:161]
    v_pk_add_f32 v[246:247], v[246:247], v[162:163]
    v_cvt_pk_bf16_f32 v164, v244, v245
    v_cvt_pk_bf16_f32 v165, v246, v247
    v_cvt_pk_bf16_f32 v166, v244, v245
    v_cvt_pk_bf16_f32 v167, v246, v247
    s_nop 0
    v_permlane16_swap_b32 v164, v166
    v_permlane16_swap_b32 v165, v167
    v_mov_b32_sdwa v167, v241 dst_sel:WORD_1 dst_unused:UNUSED_PRESERVE src0_sel:WORD_0
    s_nop 0
    buffer_store_dwordx4 v[164:167], v80, s[52:55], s13 offen sc1
    v_lshlrev_b32 v241, 16, v241
    v_lshrrev_b32 v240, 4, v0
    v_and_b32 v252, 0xf0, v1
    v_lshl_add_u32 v252, v240, 10, v252
    v_mov_b32 v253, v252
    s_waitcnt lgkmcnt(8)
    v_mfma_f32_32x32x16_bf16 v[112:127], a[232:235], a[36:39], v[112:127]
    ds_read_b64_tr_b16 a[228:229], v2 offset:12288
    ds_read_b64_tr_b16 a[230:231], v2 offset:12544
    ds_read_b128 a[112:115], v254 offset:28672
    ds_write_b128 v254, a[144:147] offset:28672
    s_waitcnt lgkmcnt(10)
    v_mfma_f32_16x16x32_bf16 v[248:251], v[220:223], a[248:251], v[248:251]
    s_waitcnt lgkmcnt(8)
    v_mfma_f32_32x32x16_bf16 v[96:111], a[236:239], a[40:43], v[96:111]
    ds_read_b64_tr_b16 a[232:233], v2 offset:13312
    ds_read_b64_tr_b16 a[234:235], v2 offset:13568
    ds_read_b128 a[144:147], v254 offset:32768
    ds_write_b128 v254, a[148:151] offset:32768
    ds_read_b64_tr_b16 v[220:221], v5 offset:10240
    ds_read_b64_tr_b16 v[222:223], v5 offset:10496
    s_waitcnt lgkmcnt(12)
    v_mfma_f32_32x32x16_bf16 v[112:127], a[240:243], a[44:47], v[112:127]
    ds_read_b64_tr_b16 a[236:237], v2 offset:14336
    ds_read_b64_tr_b16 a[238:239], v2 offset:14592
    s_waitcnt lgkmcnt(12)
    v_mfma_f32_16x16x32_bf16 v[248:251], v[216:219], a[248:251], v[248:251]
    s_waitcnt lgkmcnt(10)
    v_mfma_f32_32x32x16_bf16 v[96:111], a[228:231], a[48:51], v[96:111]
    ds_read_b64_tr_b16 a[240:241], v2 offset:15360
    ds_read_b64_tr_b16 a[242:243], v2 offset:15616
    ds_read_b128 a[148:151], v254 offset:36864
    ds_write_b128 v254, a[152:155] offset:36864
    ds_read_b64_tr_b16 v[216:217], v5 offset:12288
    ds_read_b64_tr_b16 v[218:219], v5 offset:12544
    s_waitcnt lgkmcnt(12)
    v_mfma_f32_32x32x16_bf16 v[112:127], a[232:235], a[52:55], v[112:127]
    ds_read_b64_tr_b16 a[228:229], v2 offset:16384
    ds_read_b64_tr_b16 a[230:231], v2 offset:16640
    ds_read_b128 a[152:155], v254 offset:40960
    ds_write_b128 v254, a[156:159] offset:40960
    s_waitcnt lgkmcnt(12)
    v_mfma_f32_16x16x32_bf16 v[248:251], v[220:223], a[248:251], v[248:251]
    s_waitcnt lgkmcnt(10)
    v_mfma_f32_32x32x16_bf16 v[96:111], a[236:239], a[56:59], v[96:111]
    ds_read_b64_tr_b16 a[232:233], v2 offset:17408
    ds_read_b64_tr_b16 a[234:235], v2 offset:17664
    ds_read_b128 a[156:159], v254 offset:45056
    ds_write_b128 v254, a[160:163] offset:45056
    ds_read_b64_tr_b16 v[220:221], v5 offset:14336
    ds_read_b64_tr_b16 v[222:223], v5 offset:14592
    s_waitcnt lgkmcnt(14)
    v_mfma_f32_32x32x16_bf16 v[112:127], a[240:243], a[60:63], v[112:127]
    ds_read_b64_tr_b16 a[236:237], v2 offset:18432
    ds_read_b64_tr_b16 a[238:239], v2 offset:18688
    s_waitcnt lgkmcnt(12)
    v_mfma_f32_16x16x32_bf16 v[248:251], v[216:219], a[248:251], v[248:251]
    s_waitcnt lgkmcnt(10)
    v_mfma_f32_32x32x16_bf16 v[96:111], a[228:231], a[64:67], v[96:111]
    ds_read_b64_tr_b16 a[240:241], v2 offset:19456
    ds_read_b64_tr_b16 a[242:243], v2 offset:19712
    ds_read_b128 a[160:163], v254 offset:49152
    ds_write_b128 v254, a[164:167] offset:49152
    ds_read_b64_tr_b16 v[216:217], v5 offset:16384
    ds_read_b64_tr_b16 v[218:219], v5 offset:16640
    s_waitcnt lgkmcnt(12)
    v_mfma_f32_32x32x16_bf16 v[112:127], a[232:235], a[68:71], v[112:127]
    ds_read_b64_tr_b16 a[228:229], v2 offset:20480
    ds_read_b64_tr_b16 a[230:231], v2 offset:20736
    ds_read_b128 a[164:167], v254 offset:53248
    ds_write_b128 v254, a[168:171] offset:53248
    s_waitcnt lgkmcnt(12)
    v_mfma_f32_16x16x32_bf16 v[248:251], v[220:223], a[248:251], v[248:251]
    s_waitcnt lgkmcnt(10)
    v_mfma_f32_32x32x16_bf16 v[96:111], a[236:239], a[72:75], v[96:111]
    ds_read_b64_tr_b16 a[232:233], v2 offset:21504
    ds_read_b64_tr_b16 a[234:235], v2 offset:21760
    ds_read_b128 a[168:171], v255 offset:0
    ds_write_b128 v255, a[172:175] offset:0
    ds_read_b64_tr_b16 v[220:221], v5 offset:18432
    ds_read_b64_tr_b16 v[222:223], v5 offset:18688
    s_waitcnt lgkmcnt(14)
    v_mfma_f32_32x32x16_bf16 v[112:127], a[240:243], a[76:79], v[112:127]
    ds_read_b64_tr_b16 a[236:237], v2 offset:22528
    ds_read_b64_tr_b16 a[238:239], v2 offset:22784
    s_waitcnt lgkmcnt(12)
    v_mfma_f32_16x16x32_bf16 v[248:251], v[216:219], a[248:251], v[248:251]
    s_waitcnt lgkmcnt(10)
    v_mfma_f32_32x32x16_bf16 v[96:111], a[228:231], a[80:83], v[96:111]
    ds_read_b64_tr_b16 a[240:241], v2 offset:23552
    ds_read_b64_tr_b16 a[242:243], v2 offset:23808
    ds_read_b128 a[172:175], v255 offset:4096
    ds_write_b128 v255, a[176:179] offset:4096
    ds_read_b64_tr_b16 v[216:217], v5 offset:20480
    ds_read_b64_tr_b16 v[218:219], v5 offset:20736
    s_waitcnt lgkmcnt(12)
    v_mfma_f32_32x32x16_bf16 v[112:127], a[232:235], a[84:87], v[112:127]
    ds_read_b64_tr_b16 a[228:229], v2 offset:24576
    ds_read_b64_tr_b16 a[230:231], v2 offset:24832
    ds_read_b128 a[176:179], v255 offset:8192
    ds_write_b128 v255, a[180:183] offset:8192
    s_waitcnt lgkmcnt(12)
    v_mfma_f32_16x16x32_bf16 v[248:251], v[220:223], a[248:251], v[248:251]
    s_waitcnt lgkmcnt(10)
    v_mfma_f32_32x32x16_bf16 v[96:111], a[236:239], a[88:91], v[96:111]
    s_add_u32 s13, s56, 0
    buffer_load_dwordx4 v[184:187], v252, s[52:55], s13 offen offset:0 sc1
    ds_read_b64_tr_b16 a[232:233], v2 offset:25600
    ds_read_b64_tr_b16 a[234:235], v2 offset:25856
    ds_read_b128 a[180:183], v255 offset:12288
    ds_write_b128 v255, a[184:187] offset:12288
    ds_read_b64_tr_b16 v[220:221], v5 offset:22528
    ds_read_b64_tr_b16 v[222:223], v5 offset:22784
    s_waitcnt lgkmcnt(14)
    v_mfma_f32_32x32x16_bf16 v[112:127], a[240:243], a[92:95], v[112:127]
    buffer_load_dwordx4 v[188:191], v252, s[52:55], s13 offen offset:256 sc1
    ds_read_b64_tr_b16 a[236:237], v2 offset:26624
    ds_read_b64_tr_b16 a[238:239], v2 offset:26880
    s_waitcnt lgkmcnt(12)
    v_mfma_f32_16x16x32_bf16 v[248:251], v[216:219], a[248:251], v[248:251]
    s_waitcnt lgkmcnt(10)
    v_mfma_f32_32x32x16_bf16 v[96:111], a[228:231], a[96:99], v[96:111]
    buffer_load_dwordx4 v[192:195], v252, s[52:55], s13 offen offset:512 sc1
    ds_read_b64_tr_b16 a[240:241], v2 offset:27648
    ds_read_b64_tr_b16 a[242:243], v2 offset:27904
    ds_read_b128 a[184:187], v255 offset:16384
    ds_write_b128 v255, a[188:191] offset:16384
    ds_read_b64_tr_b16 v[216:217], v5 offset:24576
    ds_read_b64_tr_b16 v[218:219], v5 offset:24832
    s_waitcnt lgkmcnt(12)
    v_mfma_f32_32x32x16_bf16 v[112:127], a[232:235], a[100:103], v[112:127]
    buffer_load_dwordx4 v[196:199], v252, s[52:55], s13 offen offset:768 sc1
    s_waitcnt lgkmcnt(8)
    v_mfma_f32_16x16x32_bf16 v[248:251], v[220:223], a[248:251], v[248:251]
    s_waitcnt lgkmcnt(6)
    v_mfma_f32_32x32x16_bf16 v[96:111], a[236:239], a[104:107], v[96:111]
    s_add_u32 s13, s56, 4096
    buffer_load_dwordx4 v[200:203], v253, s[52:55], s13 offen offset:0 sc1
    ds_read_b64_tr_b16 v[220:221], v5 offset:26624
    ds_read_b64_tr_b16 v[222:223], v5 offset:26880
    s_waitcnt lgkmcnt(6)
    v_mfma_f32_32x32x16_bf16 v[112:127], a[240:243], a[108:111], v[112:127]
    buffer_load_dwordx4 v[204:207], v253, s[52:55], s13 offen offset:256 sc1
    s_waitcnt lgkmcnt(2)
    v_mfma_f32_16x16x32_bf16 v[248:251], v[216:219], a[248:251], v[248:251]
    buffer_load_dwordx4 v[208:211], v253, s[52:55], s13 offen offset:512 sc1
    s_waitcnt lgkmcnt(0)
    v_mfma_f32_16x16x32_bf16 v[248:251], v[220:223], a[248:251], v[248:251]
    s_lshr_b32 s14, s7, 1
    s_add_u32 s14, s14, 1
    s_lshl_b32 s14, s14, 7
    buffer_load_dwordx4 v[212:215], v253, s[52:55], s13 offen offset:768 sc1
    v_subrev_u32_e64 v232, s14, v94
    s_mov_b64 exec, s[20:21]
    s_nop 1
    ds_write_b128 v232, v[248:251] offset:384
    s_mov_b64 exec, -1
    s_waitcnt lgkmcnt(0)
    s_barrier
    ds_read_b128 v[168:171], v27 offset:384
    ds_read_b128 v[172:175], v27 offset:416
    ds_read_b128 v[176:179], v27 offset:448
    ds_read_b128 v[180:183], v27 offset:480
    v_pk_add_f32 v[96:97], v[96:97], v[112:113]
    v_pk_add_f32 v[98:99], v[98:99], v[114:115]
    v_pk_add_f32 v[100:101], v[100:101], v[116:117]
    v_pk_add_f32 v[102:103], v[102:103], v[118:119]
    v_pk_add_f32 v[104:105], v[104:105], v[120:121]
    v_pk_add_f32 v[106:107], v[106:107], v[122:123]
    v_pk_add_f32 v[108:109], v[108:109], v[124:125]
    v_pk_add_f32 v[110:111], v[110:111], v[126:127]
    s_waitcnt lgkmcnt(3)
    v_pk_mul_f32 v[168:169], v[168:169], v[234:235] op_sel:[0,1]
    v_pk_mul_f32 v[170:171], v[170:171], v[234:235] op_sel:[0,1]
    s_waitcnt lgkmcnt(2)
    v_pk_mul_f32 v[172:173], v[172:173], v[234:235] op_sel:[0,1]
    v_pk_mul_f32 v[174:175], v[174:175], v[234:235] op_sel:[0,1]
    s_waitcnt lgkmcnt(1)
    v_pk_mul_f32 v[176:177], v[176:177], v[234:235] op_sel:[0,1]
    v_pk_mul_f32 v[178:179], v[178:179], v[234:235] op_sel:[0,1]
    s_waitcnt lgkmcnt(0)
    v_pk_mul_f32 v[180:181], v[180:181], v[234:235] op_sel:[0,1]
    v_pk_mul_f32 v[182:183], v[182:183], v[234:235] op_sel:[0,1]
    v_pk_fma_f32 v[96:97], v[96:97], v[234:235], v[168:169] op_sel_hi:[1,0,1] neg_lo:[0,0,1] neg_hi:[0,0,1]
    v_pk_fma_f32 v[98:99], v[98:99], v[234:235], v[170:171] op_sel_hi:[1,0,1] neg_lo:[0,0,1] neg_hi:[0,0,1]
    v_pk_fma_f32 v[100:101], v[100:101], v[234:235], v[172:173] op_sel_hi:[1,0,1] neg_lo:[0,0,1] neg_hi:[0,0,1]
    v_pk_fma_f32 v[102:103], v[102:103], v[234:235], v[174:175] op_sel_hi:[1,0,1] neg_lo:[0,0,1] neg_hi:[0,0,1]
    v_pk_fma_f32 v[104:105], v[104:105], v[234:235], v[176:177] op_sel_hi:[1,0,1] neg_lo:[0,0,1] neg_hi:[0,0,1]
    v_pk_fma_f32 v[106:107], v[106:107], v[234:235], v[178:179] op_sel_hi:[1,0,1] neg_lo:[0,0,1] neg_hi:[0,0,1]
    v_pk_fma_f32 v[108:109], v[108:109], v[234:235], v[180:181] op_sel_hi:[1,0,1] neg_lo:[0,0,1] neg_hi:[0,0,1]
    v_pk_fma_f32 v[110:111], v[110:111], v[234:235], v[182:183] op_sel_hi:[1,0,1] neg_lo:[0,0,1] neg_hi:[0,0,1]
    v_cvt_pk_bf16_f32 v144, v96, v97
    v_cvt_pk_bf16_f32 v145, v98, v99
    v_cvt_pk_bf16_f32 v146, v100, v101
    v_cvt_pk_bf16_f32 v147, v102, v103
    v_cvt_pk_bf16_f32 v148, v104, v105
    v_cvt_pk_bf16_f32 v149, v106, v107
    v_cvt_pk_bf16_f32 v150, v108, v109
    v_cvt_pk_bf16_f32 v151, v110, v111
    v_mfma_f32_32x32x16_bf16 v[96:111], v[68:71], v[144:147], 0
    s_nop 0
    v_mfma_f32_32x32x16_bf16 v[96:111], v[72:75], v[148:151], v[96:111]
    s_nop 11
    v_max3_f32 v232, v96, v97, v98
    v_min3_f32 v233, v96, v97, v98
    v_max3_f32 v232, v232, v99, v100
    v_min3_f32 v233, v233, v99, v100
    v_max3_f32 v232, v232, v101, v102
    v_min3_f32 v233, v233, v101, v102
    v_max3_f32 v232, v232, v104, v105
    v_min3_f32 v233, v233, v104, v105
    v_max3_f32 v232, v232, v106, v107
    v_min3_f32 v233, v233, v106, v107
    v_max3_f32 v232, v232, v108, v109
    v_min3_f32 v233, v233, v108, v109
    v_max_f32 v232, v232, v110
    v_min_f32 v233, v233, v110
    v_mov_b32 v242, v232
    v_mov_b32 v243, v233
    s_mov_b32 s64, 0x3fb8aa3b
    s_mov_b32 s65, 0x3fb8aa3b
    v_permlane32_swap_b32 v232, v242
    v_permlane32_swap_b32 v233, v243
    v_max_f32 v232, v232, v242
    v_min_f32 v233, v233, v243
    v_mul_f32 v232, s64, v232
    v_mul_f32 v233, s64, v233
    v_pk_fma_f32 v[168:169], v[96:97], s[64:65], v[232:233] op_sel:[0,0,1] neg_lo:[1,0,0] neg_hi:[1,0,0]
    v_pk_fma_f32 v[96:97], v[96:97], s[64:65], v[232:233] op_sel_hi:[1,1,0] neg_lo:[0,0,1] neg_hi:[0,0,1]
    v_pk_fma_f32 v[170:171], v[98:99], s[64:65], v[232:233] op_sel:[0,0,1] neg_lo:[1,0,0] neg_hi:[1,0,0]
    v_pk_fma_f32 v[98:99], v[98:99], s[64:65], v[232:233] op_sel_hi:[1,1,0] neg_lo:[0,0,1] neg_hi:[0,0,1]
    v_pk_fma_f32 v[172:173], v[100:101], s[64:65], v[232:233] op_sel:[0,0,1] neg_lo:[1,0,0] neg_hi:[1,0,0]
    v_pk_fma_f32 v[100:101], v[100:101], s[64:65], v[232:233] op_sel_hi:[1,1,0] neg_lo:[0,0,1] neg_hi:[0,0,1]
    v_pk_fma_f32 v[174:175], v[102:103], s[64:65], v[232:233] op_sel:[0,0,1] neg_lo:[1,0,0] neg_hi:[1,0,0]
    v_pk_fma_f32 v[102:103], v[102:103], s[64:65], v[232:233] op_sel_hi:[1,1,0] neg_lo:[0,0,1] neg_hi:[0,0,1]
    v_pk_fma_f32 v[176:177], v[104:105], s[64:65], v[232:233] op_sel:[0,0,1] neg_lo:[1,0,0] neg_hi:[1,0,0]
    v_pk_fma_f32 v[104:105], v[104:105], s[64:65], v[232:233] op_sel_hi:[1,1,0] neg_lo:[0,0,1] neg_hi:[0,0,1]
    v_pk_fma_f32 v[178:179], v[106:107], s[64:65], v[232:233] op_sel:[0,0,1] neg_lo:[1,0,0] neg_hi:[1,0,0]
    v_pk_fma_f32 v[106:107], v[106:107], s[64:65], v[232:233] op_sel_hi:[1,1,0] neg_lo:[0,0,1] neg_hi:[0,0,1]
    v_pk_fma_f32 v[180:181], v[108:109], s[64:65], v[232:233] op_sel:[0,0,1] neg_lo:[1,0,0] neg_hi:[1,0,0]
    v_pk_fma_f32 v[108:109], v[108:109], s[64:65], v[232:233] op_sel_hi:[1,1,0] neg_lo:[0,0,1] neg_hi:[0,0,1]
    v_pk_fma_f32 v[182:183], v[110:111], s[64:65], v[232:233] op_sel:[0,0,1] neg_lo:[1,0,0] neg_hi:[1,0,0]
    v_pk_fma_f32 v[110:111], v[110:111], s[64:65], v[232:233] op_sel_hi:[1,1,0] neg_lo:[0,0,1] neg_hi:[0,0,1]
    v_exp_f32 v96, v96
    v_exp_f32 v168, v168
    v_exp_f32 v97, v97
    v_exp_f32 v169, v169
    v_exp_f32 v98, v98
    v_exp_f32 v170, v170
    v_exp_f32 v99, v99
    v_exp_f32 v171, v171
    v_exp_f32 v100, v100
    v_exp_f32 v172, v172
    v_exp_f32 v101, v101
    v_exp_f32 v173, v173
    v_exp_f32 v102, v102
    v_exp_f32 v174, v174
    v_exp_f32 v104, v104
    v_exp_f32 v176, v176
    v_exp_f32 v105, v105
    v_exp_f32 v177, v177
    v_exp_f32 v106, v106
    v_exp_f32 v178, v178
    v_exp_f32 v107, v107
    v_exp_f32 v179, v179
    v_exp_f32 v108, v108
    v_exp_f32 v180, v180
    v_exp_f32 v109, v109
    v_exp_f32 v181, v181
    v_exp_f32 v110, v110
    v_exp_f32 v182, v182
    v_pk_add_f32 v[244:245], v[96:97], v[98:99]
    v_pk_add_f32 v[246:247], v[168:169], v[170:171]
    v_pk_add_f32 v[244:245], v[244:245], v[100:101]
    v_pk_add_f32 v[246:247], v[246:247], v[172:173]
    v_pk_add_f32 v[244:245], v[244:245], v[104:105]
    v_pk_add_f32 v[246:247], v[246:247], v[176:177]
    v_pk_add_f32 v[244:245], v[244:245], v[106:107]
    v_pk_add_f32 v[246:247], v[246:247], v[178:179]
    v_pk_add_f32 v[244:245], v[244:245], v[108:109]
    v_pk_add_f32 v[246:247], v[246:247], v[180:181]
    v_add_f32 v244, v244, v245
    v_add_f32 v246, v246, v247
    v_add_f32 v242, v102, v110
    v_add_f32 v243, v174, v182
    v_add_f32 v244, v244, v242
    v_add_f32 v246, v246, v243
    v_mov_b32 v242, v244
    v_mov_b32 v243, v246
    s_nop 0
    v_permlane32_swap_b32 v244, v242
    v_permlane32_swap_b32 v246, v243
    v_add_f32 v244, v244, v242
    v_add_f32 v246, v246, v243
    v_rcp_f32 v244, v244
    v_rcp_f32_e64 v246, v246
    v_pk_mul_f32 v[96:97], v[96:97], v[244:245] op_sel_hi:[1,0]
    v_pk_mul_f32 v[98:99], v[98:99], v[244:245] op_sel_hi:[1,0]
    v_pk_mul_f32 v[100:101], v[100:101], v[244:245] op_sel_hi:[1,0]
    v_pk_mul_f32 v[102:103], v[102:103], v[244:245] op_sel_hi:[1,0]
    v_pk_mul_f32 v[104:105], v[104:105], v[244:245] op_sel_hi:[1,0]
    v_pk_mul_f32 v[106:107], v[106:107], v[244:245] op_sel_hi:[1,0]
    v_pk_mul_f32 v[108:109], v[108:109], v[244:245] op_sel_hi:[1,0]
    v_pk_mul_f32 v[110:111], v[110:111], v[244:245] op_sel_hi:[1,0]
    s_waitcnt vmcnt(9)
    s_nop 0
    v_cvt_pk_bf16_f32 v152, v96, v97
    v_cvt_pk_bf16_f32 v153, v98, v99
    v_cvt_pk_bf16_f32 v154, v100, v101
    v_cvt_pk_bf16_f32 v155, v102, 0
    v_cvt_pk_bf16_f32 v156, v104, v105
    v_cvt_pk_bf16_f32 v157, v106, v107
    v_cvt_pk_bf16_f32 v158, v108, v109
    v_cvt_pk_bf16_f32 v159, v110, 0
    v_pk_mul_f32 v[168:169], v[168:169], v[246:247] op_sel_hi:[1,0]
    v_pk_mul_f32 v[170:171], v[170:171], v[246:247] op_sel_hi:[1,0]
    v_pk_mul_f32 v[172:173], v[172:173], v[246:247] op_sel_hi:[1,0]
    v_pk_mul_f32 v[174:175], v[174:175], v[246:247] op_sel_hi:[1,0]
    v_pk_mul_f32 v[176:177], v[176:177], v[246:247] op_sel_hi:[1,0]
    v_pk_mul_f32 v[178:179], v[178:179], v[246:247] op_sel_hi:[1,0]
    v_pk_mul_f32 v[180:181], v[180:181], v[246:247] op_sel_hi:[1,0]
    v_pk_mul_f32 v[182:183], v[182:183], v[246:247] op_sel_hi:[1,0]
    v_cvt_pk_bf16_f32 v160, v168, v169
    v_cvt_pk_bf16_f32 v161, v170, v171
    v_cvt_pk_bf16_f32 v162, v172, v173
    v_cvt_pk_bf16_f32 v163, v174, 0
    v_cvt_pk_bf16_f32 v164, v176, v177
    v_cvt_pk_bf16_f32 v165, v178, v179
    v_cvt_pk_bf16_f32 v166, v180, v181
    v_cvt_pk_bf16_f32 v167, v182, 0
    ds_read_b128 a[188:191], v255 offset:20480
    ds_write_b128 v255, a[192:195] offset:20480
    ds_read_b128 a[192:195], v255 offset:24576
    ds_write_b128 v255, a[196:199] offset:24576
    ds_read_b128 a[196:199], v254 offset:0
    ds_write_b128 v254, a[116:119] offset:0
    ds_read_b128 a[116:119], v254 offset:4096
    ds_write_b128 v254, a[120:123] offset:4096
    s_waitcnt vmcnt(7)
    v_mfma_f32_16x16x32_bf16 v[112:115], v[76:79], v[184:187], 0
    v_xor_b32 v240, v187, v241
    s_waitcnt vmcnt(6)
    v_mfma_f32_16x16x32_bf16 v[116:119], v[76:79], v[188:191], 0
    v_bitop3_b32 v240, v191, v241, v240 bitop3:0xbe
    s_waitcnt vmcnt(5)
    v_mfma_f32_16x16x32_bf16 v[120:123], v[76:79], v[192:195], 0
    v_bitop3_b32 v240, v195, v241, v240 bitop3:0xbe
    s_waitcnt vmcnt(4)
    v_mfma_f32_16x16x32_bf16 v[124:127], v[76:79], v[196:199], 0
    v_bitop3_b32 v240, v199, v241, v240 bitop3:0xbe
    s_waitcnt vmcnt(3)
    v_mfma_f32_16x16x32_bf16 v[112:115], v[76:79], v[200:203], v[112:115]
    v_bitop3_b32 v240, v203, v241, v240 bitop3:0xbe
    s_waitcnt vmcnt(2)
    v_mfma_f32_16x16x32_bf16 v[116:119], v[76:79], v[204:207], v[116:119]
    v_bitop3_b32 v240, v207, v241, v240 bitop3:0xbe
    s_waitcnt vmcnt(1)
    v_mfma_f32_16x16x32_bf16 v[120:123], v[76:79], v[208:211], v[120:123]
    v_bitop3_b32 v240, v211, v241, v240 bitop3:0xbe
    s_waitcnt vmcnt(0)
    v_mfma_f32_16x16x32_bf16 v[124:127], v[76:79], v[212:215], v[124:127]
    v_bitop3_b32 v240, v215, v241, v240 bitop3:0xbe
    v_cmp_lt_u32 vcc, 0xffff, v240
    s_cbranch_vccnz Lkvretry_28
Lkvback_29:
    s_add_u32 m0, s58, 3072
    s_add_u32 s69, s68, 21504
    buffer_load_dwordx4 v21, s[44:47], s69 offen lds
    v_cvt_pk_bf16_f32 v144, v112, v113
    v_cvt_pk_bf16_f32 v145, v114, v115
    s_add_u32 m0, s58, 4096
    s_add_u32 s69, s68, 28672
    buffer_load_dwordx4 v20, s[44:47], s69 offen lds
    v_cvt_pk_bf16_f32 v146, v116, v117
    v_cvt_pk_bf16_f32 v147, v118, v119
    s_add_u32 m0, s58, 5120
    s_add_u32 s69, s68, 35840
    buffer_load_dwordx4 v21, s[44:47], s69 offen lds
    v_cvt_pk_bf16_f32 v148, v120, v121
    v_cvt_pk_bf16_f32 v149, v122, v123
    s_add_u32 m0, s58, 6144
    s_add_u32 s69, s68, 43008
    buffer_load_dwordx4 v20, s[44:47], s69 offen lds
    v_cvt_pk_bf16_f32 v150, v124, v125
    v_cvt_pk_bf16_f32 v151, v126, v127
    s_add_u32 m0, s58, 7168
    s_add_u32 s69, s68, 50176
    buffer_load_dwordx4 v21, s[44:47], s69 offen lds
    s_mov_b32 exec_hi, 0
    ds_write_b64 v92, v[144:145] offset:0
    ds_write_b64 v92, v[146:147] offset:256
    ds_write_b64 v92, v[148:149] offset:512
    ds_write_b64 v92, v[150:151] offset:768
    s_mov_b64 exec, -1
    s_add_u32 m0, s58, 8192
    s_add_u32 s69, s68, 57344
    buffer_load_dwordx4 v20, s[44:47], s69 offen lds
    s_waitcnt lgkmcnt(0)
    s_barrier
    s_add_u32 m0, s58, 9216
    s_add_u32 s69, s68, 64512
    buffer_load_dwordx4 v21, s[44:47], s69 offen lds
    ds_read_b128 v[168:171], v93 offset:0
    ds_read_b128 v[172:175], v93 offset:1024
    s_add_u32 m0, s58, 10240
    s_add_u32 s69, s68, 71680
    buffer_load_dwordx4 v20, s[44:47], s69 offen lds
    ds_read_b128 v[176:179], v93 offset:2048
    ds_read_b128 v[180:183], v93 offset:3072
    s_add_u32 m0, s58, 11264
    s_add_u32 s69, s68, 78848
    buffer_load_dwordx4 v21, s[44:47], s69 offen lds
    s_waitcnt lgkmcnt(3)
    v_mfma_f32_32x32x16_bf16 v[128:143], v[168:171], v[152:155], 0
    s_waitcnt lgkmcnt(2)
    v_mfma_f32_32x32x16_bf16 v[128:143], v[172:175], v[156:159], v[128:143]
    s_add_u32 m0, s58, 12288
    s_add_u32 s69, s68, 86016
    buffer_load_dwordx4 v20, s[44:47], s69 offen lds
    s_waitcnt lgkmcnt(1)
    v_mfma_f32_32x32x16_bf16 v[128:143], v[176:179], v[160:163], v[128:143]
    s_waitcnt lgkmcnt(0)
    v_mfma_f32_32x32x16_bf16 v[128:143], v[180:183], v[164:167], v[128:143]
    s_add_u32 m0, s58, 13312
    s_add_u32 s69, s68, 93184
    buffer_load_dwordx4 v21, s[44:47], s69 offen lds
    s_nop 8
    v_mov_b32 v232, v140
    v_mov_b32 v233, v140
    s_mul_i32 s56, s8, 114688
    s_add_u32 s56, s56, 4194304
    v_permlane32_swap_b32 v232, v233
    v_add_f32 v233, 0x358637bd, v233
    v_rcp_f32 v233, v233
    s_nop 0
    v_pk_mul_f32 v[128:129], v[128:129], v[232:233] op_sel:[0,1]
    v_pk_mul_f32 v[130:131], v[130:131], v[232:233] op_sel:[0,1]
    v_pk_mul_f32 v[132:133], v[132:133], v[232:233] op_sel:[0,1]
    v_pk_mul_f32 v[134:135], v[134:135], v[232:233] op_sel:[0,1]
    v_pk_mul_f32 v[136:137], v[136:137], v[232:233] op_sel:[0,1]
    v_pk_mul_f32 v[138:139], v[138:139], v[232:233] op_sel:[0,1]
    v_pk_mul_f32 v[140:141], v[140:141], v[232:233] op_sel:[0,1]
    v_pk_mul_f32 v[142:143], v[142:143], v[232:233] op_sel:[0,1]
    v_cvt_pk_bf16_f32 v144, v128, v129
    v_cvt_pk_bf16_f32 v145, v130, v131
    v_cvt_pk_bf16_f32 v146, v132, v133
    v_cvt_pk_bf16_f32 v147, v134, v135
    v_cvt_pk_bf16_f32 v148, v136, v137
    v_cvt_pk_bf16_f32 v149, v138, v139
    v_cvt_pk_bf16_f32 v150, v140, v141
    v_cvt_pk_bf16_f32 v151, v142, v143
    s_cmp_lg_u32 s10, 0
    s_cbranch_scc1 Lslow_30
    buffer_store_dwordx2 v[144:145], v10, s[52:55], s56 offen offset:0
    buffer_store_dwordx2 v[146:147], v10, s[52:55], s56 offen offset:256
    buffer_store_dwordx2 v[148:149], v10, s[52:55], s56 offen offset:512
    buffer_store_dwordx2 v[150:151], v11, s[52:55], s56 offen offset:768
Ljoin_31:
    s_lshl_b32 s13, s8, 2
    s_add_u32 s13, s13, s7
    s_lshl_b32 s13, s13, 7
    s_lshl_b32 s14, s6, 2
    s_add_u32 s13, s13, s14
    s_add_u32 s56, s13, 16384
    s_lshl_b32 s90, s8, 2
    s_add_u32 s90, s90, s23
    s_lshl_b32 s90, s90, 7
    s_add_u32 s90, s90, 16384
    s_mul_i32 s91, s8, 114688
    s_mul_i32 s14, s23, 28672
    s_add_u32 s91, s91, s14
    s_and_b32 s14, s7, 1
    s_mul_i32 s14, s14, 14336
    s_add_u32 s91, s91, s14
    s_add_u32 s91, s91, 4194304
    ds_read_b128 a[120:123], v254 offset:8192
    ds_write_b128 v254, a[124:127] offset:8192
    ds_read_b128 a[124:127], v254 offset:12288
    ds_write_b128 v254, a[128:131] offset:12288
    ds_read_b128 a[128:131], v254 offset:16384
    ds_write_b128 v254, a[132:135] offset:16384
    ds_read_b128 a[132:135], v254 offset:20480
    ds_write_b128 v254, a[136:139] offset:20480
    ds_read_b128 a[136:139], v254 offset:24576
    ds_write_b128 v254, a[140:143] offset:24576
    s_waitcnt vmcnt(0)
    s_mov_b64 exec, 1
    s_cmp_lg_u32 s10, 0
    s_cbranch_scc1 Lslow_32
    buffer_store_dword v30, off, s[52:55], s56
Ljoin_33:
    s_mov_b64 exec, -1
    s_waitcnt lgkmcnt(0)
    s_barrier
    s_cmp_ge_u32 s6, 14
    s_cbranch_scc1 Lskipw_35
    buffer_load_dword v232, v18, s[52:55], s90 offen sc1
    ds_read_b64_tr_b16 v[96:97], v6 offset:0
    ds_read_b64_tr_b16 v[98:99], v6 offset:512
    ds_read_b64_tr_b16 v[100:101], v7 offset:0
    ds_read_b64_tr_b16 v[102:103], v7 offset:512
    ds_read_b64_tr_b16 v[104:105], v8 offset:0
    ds_read_b64_tr_b16 v[106:107], v8 offset:512
    ds_read_b64_tr_b16 v[108:109], v9 offset:0
    ds_read_b64_tr_b16 v[110:111], v9 offset:512
    ds_read_b64_tr_b16 v[112:113], v6 offset:4096
    ds_read_b64_tr_b16 v[114:115], v6 offset:4608
    ds_read_b64_tr_b16 v[116:117], v7 offset:4096
    ds_read_b64_tr_b16 v[118:119], v7 offset:4608
    ds_read_b64_tr_b16 v[120:121], v8 offset:4096
    ds_read_b64_tr_b16 v[122:123], v8 offset:4608
    ds_read_b64_tr_b16 v[124:125], v9 offset:4096
    ds_read_b64_tr_b16 v[126:127], v9 offset:4608
    ds_read_b64_tr_b16 v[128:129], v6 offset:8192
    ds_read_b64_tr_b16 v[130:131], v6 offset:8704
    ds_read_b64_tr_b16 v[132:133], v7 offset:8192
    ds_read_b64_tr_b16 v[134:135], v7 offset:8704
    ds_read_b64_tr_b16 v[136:137], v8 offset:8192
    ds_read_b64_tr_b16 v[138:139], v8 offset:8704
    ds_read_b64_tr_b16 v[140:141], v9 offset:8192
    ds_read_b64_tr_b16 v[142:143], v9 offset:8704
    ds_read_b64_tr_b16 v[144:145], v6 offset:12288
    ds_read_b64_tr_b16 v[146:147], v6 offset:12800
    ds_read_b64_tr_b16 v[148:149], v7 offset:12288
    ds_read_b64_tr_b16 v[150:151], v7 offset:12800
    ds_read_b64_tr_b16 v[152:153], v8 offset:12288
    ds_read_b64_tr_b16 v[154:155], v8 offset:12800
    ds_read_b64_tr_b16 v[156:157], v9 offset:12288
    ds_read_b64_tr_b16 v[158:159], v9 offset:12800
    ds_read_b64_tr_b16 v[160:161], v6 offset:16384
    ds_read_b64_tr_b16 v[162:163], v6 offset:16896
    ds_read_b64_tr_b16 v[164:165], v7 offset:16384
    ds_read_b64_tr_b16 v[166:167], v7 offset:16896
    ds_read_b64_tr_b16 v[168:169], v8 offset:16384
    ds_read_b64_tr_b16 v[170:171], v8 offset:16896
    ds_read_b64_tr_b16 v[172:173], v9 offset:16384
    ds_read_b64_tr_b16 v[174:175], v9 offset:16896
    ds_read_b64_tr_b16 v[176:177], v6 offset:20480
    ds_read_b64_tr_b16 v[178:179], v6 offset:20992
    ds_read_b64_tr_b16 v[180:181], v7 offset:20480
    ds_read_b64_tr_b16 v[182:183], v7 offset:20992
    ds_read_b64_tr_b16 v[184:185], v8 offset:20480
    ds_read_b64_tr_b16 v[186:187], v8 offset:20992
    ds_read_b64_tr_b16 v[188:189], v9 offset:20480
    ds_read_b64_tr_b16 v[190:191], v9 offset:20992
    ds_read_b64_tr_b16 v[192:193], v6 offset:24576
    ds_read_b64_tr_b16 v[194:195], v6 offset:25088
    ds_read_b64_tr_b16 v[196:197], v7 offset:24576
    ds_read_b64_tr_b16 v[198:199], v7 offset:25088
    ds_read_b64_tr_b16 v[200:201], v8 offset:24576
    ds_read_b64_tr_b16 v[202:203], v8 offset:25088
    ds_read_b64_tr_b16 v[204:205], v9 offset:24576
    ds_read_b64_tr_b16 v[206:207], v9 offset:25088
Lpoll_36:
    buffer_load_dword v233, v18, s[52:55], s90 offen sc1
    s_waitcnt vmcnt(1)
    v_cmp_ne_u32 vcc, s9, v232
    s_cbranch_vccz Ldone_37
    buffer_load_dword v232, v18, s[52:55], s90 offen sc1
    s_waitcnt vmcnt(1)
    v_cmp_ne_u32 vcc, s9, v233
    s_cbranch_vccz Ldone_37
    s_sub_u32 s11, s11, 1
    s_cbranch_scc0 Lpoll_36
    s_mov_b32 s11, 0
Ldone_37:
    buffer_load_dwordx4 a[0:3], v1, s[52:55], s91 offen offset:0 sc1
    buffer_load_dwordx4 a[4:7], v1, s[52:55], s91 offen offset:1024 sc1
    buffer_load_dwordx4 a[8:11], v1, s[52:55], s91 offen offset:2048 sc1
    buffer_load_dwordx4 a[12:15], v1, s[52:55], s91 offen offset:3072 sc1
    s_add_u32 s91, s91, 4096
    buffer_load_dwordx4 a[16:19], v1, s[52:55], s91 offen offset:0 sc1
    s_waitcnt vmcnt(4) lgkmcnt(15)
    v_mfma_f32_16x16x32_bf16 v[32:35], v[96:99], a[0:3], v[32:35]
    buffer_load_dwordx4 a[20:23], v1, s[52:55], s91 offen offset:1024 sc1
    ds_read_b64_tr_b16 v[208:209], v6 offset:28672
    ds_read_b64_tr_b16 v[210:211], v6 offset:29184
    v_mfma_f32_16x16x32_bf16 v[36:39], v[100:103], a[0:3], v[36:39]
    ds_read_b64_tr_b16 v[212:213], v7 offset:28672
    ds_read_b64_tr_b16 v[214:215], v7 offset:29184
    v_mfma_f32_16x16x32_bf16 v[40:43], v[104:107], a[0:3], v[40:43]
    ds_read_b64_tr_b16 v[216:217], v8 offset:28672
    ds_read_b64_tr_b16 v[218:219], v8 offset:29184
    v_mfma_f32_16x16x32_bf16 v[44:47], v[108:111], a[0:3], v[44:47]
    ds_read_b64_tr_b16 v[220:221], v9 offset:28672
    ds_read_b64_tr_b16 v[222:223], v9 offset:29184
    s_waitcnt vmcnt(4)
    v_mfma_f32_16x16x32_bf16 v[32:35], v[112:115], a[4:7], v[32:35]
    buffer_load_dwordx4 a[24:27], v1, s[52:55], s91 offen offset:2048 sc1
    ds_read_b64_tr_b16 v[96:97], v6 offset:32768
    ds_read_b64_tr_b16 v[98:99], v6 offset:33280
    v_mfma_f32_16x16x32_bf16 v[36:39], v[116:119], a[4:7], v[36:39]
    ds_read_b64_tr_b16 v[100:101], v7 offset:32768
    ds_read_b64_tr_b16 v[102:103], v7 offset:33280
    v_mfma_f32_16x16x32_bf16 v[40:43], v[120:123], a[4:7], v[40:43]
    ds_read_b64_tr_b16 v[104:105], v8 offset:32768
    ds_read_b64_tr_b16 v[106:107], v8 offset:33280
    v_mfma_f32_16x16x32_bf16 v[44:47], v[124:127], a[4:7], v[44:47]
    ds_read_b64_tr_b16 v[108:109], v9 offset:32768
    ds_read_b64_tr_b16 v[110:111], v9 offset:33280
    s_waitcnt vmcnt(4)
    v_mfma_f32_16x16x32_bf16 v[32:35], v[128:131], a[8:11], v[32:35]
    buffer_load_dwordx4 a[28:31], v1, s[52:55], s91 offen offset:3072 sc1
    ds_read_b64_tr_b16 v[112:113], v6 offset:36864
    ds_read_b64_tr_b16 v[114:115], v6 offset:37376
    v_mfma_f32_16x16x32_bf16 v[36:39], v[132:135], a[8:11], v[36:39]
    ds_read_b64_tr_b16 v[116:117], v7 offset:36864
    ds_read_b64_tr_b16 v[118:119], v7 offset:37376
    v_mfma_f32_16x16x32_bf16 v[40:43], v[136:139], a[8:11], v[40:43]
    ds_read_b64_tr_b16 v[120:121], v8 offset:36864
    ds_read_b64_tr_b16 v[122:123], v8 offset:37376
    v_mfma_f32_16x16x32_bf16 v[44:47], v[140:143], a[8:11], v[44:47]
    ds_read_b64_tr_b16 v[124:125], v9 offset:36864
    ds_read_b64_tr_b16 v[126:127], v9 offset:37376
    s_waitcnt vmcnt(4)
    v_mfma_f32_16x16x32_bf16 v[32:35], v[144:147], a[12:15], v[32:35]
    s_add_u32 s91, s91, 4096
    buffer_load_dwordx4 a[32:35], v1, s[52:55], s91 offen offset:0 sc1
    ds_read_b64_tr_b16 v[128:129], v6 offset:40960
    ds_read_b64_tr_b16 v[130:131], v6 offset:41472
    v_mfma_f32_16x16x32_bf16 v[36:39], v[148:151], a[12:15], v[36:39]
    ds_read_b64_tr_b16 v[132:133], v7 offset:40960
    ds_read_b64_tr_b16 v[134:135], v7 offset:41472
    v_mfma_f32_16x16x32_bf16 v[40:43], v[152:155], a[12:15], v[40:43]
    ds_read_b64_tr_b16 v[136:137], v8 offset:40960
    ds_read_b64_tr_b16 v[138:139], v8 offset:41472
    v_mfma_f32_16x16x32_bf16 v[44:47], v[156:159], a[12:15], v[44:47]
    ds_read_b64_tr_b16 v[140:141], v9 offset:40960
    ds_read_b64_tr_b16 v[142:143], v9 offset:41472
    s_waitcnt vmcnt(4)
    v_mfma_f32_16x16x32_bf16 v[32:35], v[160:163], a[16:19], v[32:35]
    buffer_load_dwordx4 a[36:39], v1, s[52:55], s91 offen offset:1024 sc1
    ds_read_b64_tr_b16 v[144:145], v6 offset:45056
    ds_read_b64_tr_b16 v[146:147], v6 offset:45568
    v_mfma_f32_16x16x32_bf16 v[36:39], v[164:167], a[16:19], v[36:39]
    ds_read_b64_tr_b16 v[148:149], v7 offset:45056
    ds_read_b64_tr_b16 v[150:151], v7 offset:45568
    v_mfma_f32_16x16x32_bf16 v[40:43], v[168:171], a[16:19], v[40:43]
    ds_read_b64_tr_b16 v[152:153], v8 offset:45056
    ds_read_b64_tr_b16 v[154:155], v8 offset:45568
    v_mfma_f32_16x16x32_bf16 v[44:47], v[172:175], a[16:19], v[44:47]
    ds_read_b64_tr_b16 v[156:157], v9 offset:45056
    ds_read_b64_tr_b16 v[158:159], v9 offset:45568
    s_waitcnt vmcnt(4) lgkmcnt(15)
    v_mfma_f32_16x16x32_bf16 v[32:35], v[176:179], a[20:23], v[32:35]
    buffer_load_dwordx4 a[40:43], v1, s[52:55], s91 offen offset:2048 sc1
    ds_read_b64_tr_b16 v[160:161], v6 offset:49152
    ds_read_b64_tr_b16 v[162:163], v6 offset:49664
    v_mfma_f32_16x16x32_bf16 v[36:39], v[180:183], a[20:23], v[36:39]
    ds_read_b64_tr_b16 v[164:165], v7 offset:49152
    ds_read_b64_tr_b16 v[166:167], v7 offset:49664
    v_mfma_f32_16x16x32_bf16 v[40:43], v[184:187], a[20:23], v[40:43]
    ds_read_b64_tr_b16 v[168:169], v8 offset:49152
    ds_read_b64_tr_b16 v[170:171], v8 offset:49664
    v_mfma_f32_16x16x32_bf16 v[44:47], v[188:191], a[20:23], v[44:47]
    ds_read_b64_tr_b16 v[172:173], v9 offset:49152
    ds_read_b64_tr_b16 v[174:175], v9 offset:49664
    s_waitcnt vmcnt(4)
    v_mfma_f32_16x16x32_bf16 v[32:35], v[192:195], a[24:27], v[32:35]
    buffer_load_dwordx4 a[44:47], v1, s[52:55], s91 offen offset:3072 sc1
    ds_read_b64_tr_b16 v[176:177], v6 offset:53248
    ds_read_b64_tr_b16 v[178:179], v6 offset:53760
    v_mfma_f32_16x16x32_bf16 v[36:39], v[196:199], a[24:27], v[36:39]
    ds_read_b64_tr_b16 v[180:181], v7 offset:53248
    ds_read_b64_tr_b16 v[182:183], v7 offset:53760
    v_mfma_f32_16x16x32_bf16 v[40:43], v[200:203], a[24:27], v[40:43]
    ds_read_b64_tr_b16 v[184:185], v8 offset:53248
    ds_read_b64_tr_b16 v[186:187], v8 offset:53760
    v_mfma_f32_16x16x32_bf16 v[44:47], v[204:207], a[24:27], v[44:47]
    ds_read_b64_tr_b16 v[188:189], v9 offset:53248
    ds_read_b64_tr_b16 v[190:191], v9 offset:53760
    s_waitcnt vmcnt(4)
    v_mfma_f32_16x16x32_bf16 v[32:35], v[208:211], a[28:31], v[32:35]
    s_add_u32 s91, s91, 4096
    buffer_load_dwordx4 a[48:51], v1, s[52:55], s91 offen offset:0 sc1
    v_mfma_f32_16x16x32_bf16 v[36:39], v[212:215], a[28:31], v[36:39]
    v_mfma_f32_16x16x32_bf16 v[40:43], v[216:219], a[28:31], v[40:43]
    v_mfma_f32_16x16x32_bf16 v[44:47], v[220:223], a[28:31], v[44:47]
    s_waitcnt vmcnt(4)
    v_mfma_f32_16x16x32_bf16 v[32:35], v[96:99], a[32:35], v[32:35]
    buffer_load_dwordx4 a[52:55], v1, s[52:55], s91 offen offset:1024 sc1
    v_mfma_f32_16x16x32_bf16 v[36:39], v[100:103], a[32:35], v[36:39]
    v_mfma_f32_16x16x32_bf16 v[40:43], v[104:107], a[32:35], v[40:43]
    v_mfma_f32_16x16x32_bf16 v[44:47], v[108:111], a[32:35], v[44:47]
    s_waitcnt vmcnt(4)
    v_mfma_f32_16x16x32_bf16 v[32:35], v[112:115], a[36:39], v[32:35]
    v_mfma_f32_16x16x32_bf16 v[36:39], v[116:119], a[36:39], v[36:39]
    v_mfma_f32_16x16x32_bf16 v[40:43], v[120:123], a[36:39], v[40:43]
    v_mfma_f32_16x16x32_bf16 v[44:47], v[124:127], a[36:39], v[44:47]
    s_waitcnt vmcnt(3) lgkmcnt(15)
    v_mfma_f32_16x16x32_bf16 v[32:35], v[128:131], a[40:43], v[32:35]
    v_mfma_f32_16x16x32_bf16 v[36:39], v[132:135], a[40:43], v[36:39]
    v_mfma_f32_16x16x32_bf16 v[40:43], v[136:139], a[40:43], v[40:43]
    v_mfma_f32_16x16x32_bf16 v[44:47], v[140:143], a[40:43], v[44:47]
    s_waitcnt vmcnt(2)
    v_mfma_f32_16x16x32_bf16 v[32:35], v[144:147], a[44:47], v[32:35]
    v_mfma_f32_16x16x32_bf16 v[36:39], v[148:151], a[44:47], v[36:39]
    v_mfma_f32_16x16x32_bf16 v[40:43], v[152:155], a[44:47], v[40:43]
    v_mfma_f32_16x16x32_bf16 v[44:47], v[156:159], a[44:47], v[44:47]
    s_waitcnt vmcnt(1) lgkmcnt(8)
    v_mfma_f32_16x16x32_bf16 v[32:35], v[160:163], a[48:51], v[32:35]
    v_mfma_f32_16x16x32_bf16 v[36:39], v[164:167], a[48:51], v[36:39]
    v_mfma_f32_16x16x32_bf16 v[40:43], v[168:171], a[48:51], v[40:43]
    v_mfma_f32_16x16x32_bf16 v[44:47], v[172:175], a[48:51], v[44:47]
    s_waitcnt vmcnt(0) lgkmcnt(0)
    v_mfma_f32_16x16x32_bf16 v[32:35], v[176:179], a[52:55], v[32:35]
    v_mfma_f32_16x16x32_bf16 v[36:39], v[180:183], a[52:55], v[36:39]
    v_mfma_f32_16x16x32_bf16 v[40:43], v[184:187], a[52:55], v[40:43]
    v_mfma_f32_16x16x32_bf16 v[44:47], v[188:191], a[52:55], v[44:47]
    s_nop 4
    v_cvt_pk_bf16_f32 v144, v32, v33
    v_cvt_pk_bf16_f32 v145, v34, v35
    v_cvt_pk_bf16_f32 v146, v36, v37
    v_cvt_pk_bf16_f32 v147, v38, v39
    v_cvt_pk_bf16_f32 v148, v40, v41
    v_cvt_pk_bf16_f32 v149, v42, v43
    v_cvt_pk_bf16_f32 v150, v44, v45
    v_cvt_pk_bf16_f32 v151, v46, v47
    v_permlane16_swap_b32 v144, v146
    v_permlane16_swap_b32 v145, v147
    v_permlane16_swap_b32 v148, v150
    v_permlane16_swap_b32 v149, v151
    s_cmp_lg_u32 s10, 0
    s_cbranch_scc1 Lslow_38
    buffer_store_dwordx4 v[144:147], v14, s[48:51], 0 offen
    buffer_store_dwordx4 v[148:151], v14, s[48:51], s88 offen
Ljoin_39:
    v_pk_add_f32 v[232:233], v[32:33], v[34:35]
    v_pk_mul_f32 v[234:235], v[32:33], v[32:33]
    v_pk_fma_f32 v[234:235], v[34:35], v[34:35], v[234:235]
    v_pk_add_f32 v[232:233], v[232:233], v[36:37]
    v_pk_fma_f32 v[234:235], v[36:37], v[36:37], v[234:235]
    v_pk_add_f32 v[232:233], v[232:233], v[38:39]
    v_pk_fma_f32 v[234:235], v[38:39], v[38:39], v[234:235]
    v_pk_add_f32 v[232:233], v[232:233], v[40:41]
    v_pk_fma_f32 v[234:235], v[40:41], v[40:41], v[234:235]
    v_pk_add_f32 v[232:233], v[232:233], v[42:43]
    v_pk_fma_f32 v[234:235], v[42:43], v[42:43], v[234:235]
    v_pk_add_f32 v[232:233], v[232:233], v[44:45]
    v_pk_fma_f32 v[234:235], v[44:45], v[44:45], v[234:235]
    v_pk_add_f32 v[232:233], v[232:233], v[46:47]
    v_pk_fma_f32 v[234:235], v[46:47], v[46:47], v[234:235]
    v_add_f32_e64 v232, v232, v233
    v_add_f32 v234, v234, v235
    s_lshl_b32 s14, s8, 13
    s_add_u32 s14, s14, 262144
    v_permlane32_swap_b32 v232, v234
    v_add_f32 v232, v232, v234
    v_mov_b32 v234, v232
    s_nop 1
    v_permlane16_swap_b32 v232, v234
    v_add_f32 v232, v232, v234
    s_cmp_lg_u32 s10, 0
    s_cbranch_scc1 Lslow_40
    buffer_store_dword v232, v15, s[52:55], s14 offen
Ljoin_41:
    s_lshl_b32 s13, s8, 2
    s_add_u32 s13, s13, s23
    s_lshl_b32 s13, s13, 7
    s_lshl_b32 s14, s57, 1
    s_and_b32 s15, s7, 1
    s_add_u32 s14, s14, s15
    s_lshl_b32 s14, s14, 2
    s_add_u32 s13, s13, s14
    s_add_u32 s13, s13, 49152
    s_waitcnt vmcnt(0)
    s_mov_b64 exec, 1
    s_cmp_lg_u32 s10, 0
    s_cbranch_scc1 Lslow_42
    buffer_store_dword v30, off, s[52:55], s13
Ljoin_43:
    s_mov_b64 exec, -1
    v_mov_b32 v152, v232
Lskip_34:
    v_lshrrev_b32 v236, 4, v0
    v_and_b32 v5, 7, v0
    v_lshlrev_b32_e64 v5, 4, v5
    v_lshl_add_u32 v5, v236, 7, v5
    v_add_u32 v5, 150288, v5
    ds_read_b64_tr_b16 a[56:57], v2 offset:0
    ds_read_b64_tr_b16 a[58:59], v2 offset:256
    ds_read_b64_tr_b16 a[60:61], v2 offset:28672
    ds_read_b64_tr_b16 a[62:63], v2 offset:28928
    ds_read_b64_tr_b16 a[64:65], v3 offset:0
    ds_read_b64_tr_b16 a[66:67], v3 offset:256
    ds_read_b64_tr_b16 a[68:69], v2 offset:1024
    ds_read_b64_tr_b16 a[70:71], v2 offset:1280
    ds_read_b64_tr_b16 a[72:73], v2 offset:29696
    ds_read_b64_tr_b16 a[74:75], v2 offset:29952
    ds_read_b64_tr_b16 a[76:77], v3 offset:1024
    ds_read_b64_tr_b16 a[78:79], v3 offset:1280
    s_lshl_b32 s13, s8, 2
    s_add_u32 s13, s13, s7
    s_lshl_b32 s13, s13, 7
    s_add_u32 s13, s13, 49152
    s_mul_i32 s56, s8, 114688
    s_mul_i32 s14, s7, 28672
    s_add_u32 s56, s56, s14
    s_add_u32 s56, s56, 12582912
    s_lshl_b32 s14, s8, 13
    s_add_u32 s14, s14, 262144
    buffer_load_dword v232, v19, s[52:55], s13 offen sc1
Lpoll_44:
    buffer_load_dword v233, v19, s[52:55], s13 offen sc1
    s_waitcnt vmcnt(1)
    v_cmp_ne_u32 vcc, s9, v232
    s_cbranch_vccz Ldone_45
    buffer_load_dword v232, v19, s[52:55], s13 offen sc1
    s_waitcnt vmcnt(1)
    v_cmp_ne_u32 vcc, s9, v233
    s_cbranch_vccz Ldone_45
    s_sub_u32 s11, s11, 1
    s_cbranch_scc0 Lpoll_44
    s_mov_b32 s11, 0
Ldone_45:
    buffer_load_dwordx4 a[0:3], v29, s[48:51], s84 offen offset:0 sc1
    buffer_load_dwordx4 a[4:7], v29, s[48:51], s85 offen offset:0 sc1
    buffer_load_dwordx4 a[8:11], v29, s[48:51], s86 offen offset:0 sc1
    buffer_load_dwordx4 a[12:15], v29, s[48:51], s87 offen offset:0 sc1
    buffer_load_dwordx4 a[16:19], v29, s[48:51], s84 offen offset:128 sc1
    s_waitcnt vmcnt(4) lgkmcnt(6)
    v_mfma_f32_32x32x16_bf16 v[96:111], a[56:59], a[0:3], 0
    buffer_load_dwordx2 v[200:201], v16, s[52:55], s14 offen offset:0 sc1
    ds_read_b64_tr_b16 a[80:81], v2 offset:2048
    ds_read_b64_tr_b16 a[82:83], v2 offset:2304
    ds_read_b128 v[184:187], v27 offset:128
    v_mfma_f32_32x32x16_bf16 v[112:127], a[60:63], a[0:3], 0
    buffer_load_dwordx2 v[202:203], v16, s[52:55], s14 offen offset:512 sc1
    ds_read_b64_tr_b16 a[84:85], v2 offset:30720
    ds_read_b64_tr_b16 a[86:87], v2 offset:30976
    ds_read_b128 v[188:191], v27 offset:160
    v_mfma_f32_32x32x16_bf16 v[128:143], a[0:3], a[64:67], 0
    buffer_load_dwordx4 a[20:23], v29, s[48:51], s85 offen offset:128 sc1
    ds_read_b64_tr_b16 a[88:89], v3 offset:2048
    ds_read_b64_tr_b16 a[90:91], v3 offset:2304
    ds_read_b128 v[192:195], v27 offset:192
    s_waitcnt vmcnt(6) lgkmcnt(9)
    v_mfma_f32_32x32x16_bf16 v[96:111], a[68:71], a[4:7], v[96:111]
    buffer_load_dwordx2 v[204:205], v16, s[52:55], s14 offen offset:1024 sc1
    ds_read_b64_tr_b16 a[56:57], v2 offset:3072
    ds_read_b64_tr_b16 a[58:59], v2 offset:3328
    ds_read_b128 v[196:199], v27 offset:224
    v_mfma_f32_32x32x16_bf16 v[112:127], a[72:75], a[4:7], v[112:127]
    buffer_load_dwordx2 v[206:207], v17, s[52:55], s14 offen offset:1536 sc1
    ds_read_b64_tr_b16 a[60:61], v2 offset:31744
    ds_read_b64_tr_b16 a[62:63], v2 offset:32000
    ds_read_b32 v239, v28 offset:0
    v_mfma_f32_32x32x16_bf16 v[128:143], a[4:7], a[76:79], v[128:143]
    buffer_load_dwordx4 a[24:27], v29, s[48:51], s86 offen offset:128 sc1
    ds_read_b64_tr_b16 a[64:65], v3 offset:3072
    ds_read_b64_tr_b16 a[66:67], v3 offset:3328
    ds_read_b128 v[168:171], v27 offset:0
    s_waitcnt vmcnt(8) lgkmcnt(10)
    v_mfma_f32_32x32x16_bf16 v[96:111], a[80:83], a[8:11], v[96:111]
    buffer_load_dwordx4 a[28:31], v29, s[48:51], s87 offen offset:128 sc1
    ds_read_b64_tr_b16 a[68:69], v2 offset:4096
    ds_read_b64_tr_b16 a[70:71], v2 offset:4352
    ds_read_b128 v[172:175], v27 offset:32
    v_mfma_f32_32x32x16_bf16 v[112:127], a[84:87], a[8:11], v[112:127]
    buffer_load_dwordx4 a[32:35], v29, s[48:51], s84 offen offset:256 sc1
    ds_read_b64_tr_b16 a[72:73], v2 offset:32768
    ds_read_b64_tr_b16 a[74:75], v2 offset:33024
    ds_read_b128 v[176:179], v27 offset:64
    v_mfma_f32_32x32x16_bf16 v[128:143], a[8:11], a[88:91], v[128:143]
    ds_read_b64_tr_b16 a[76:77], v3 offset:4096
    ds_read_b64_tr_b16 a[78:79], v3 offset:4352
    ds_read_b128 v[180:183], v27 offset:96
    s_waitcnt vmcnt(9) lgkmcnt(10)
    v_mfma_f32_32x32x16_bf16 v[96:111], a[56:59], a[12:15], v[96:111]
    buffer_load_dwordx4 a[36:39], v29, s[48:51], s85 offen offset:256 sc1
    ds_read_b64_tr_b16 a[80:81], v2 offset:5120
    ds_read_b64_tr_b16 a[82:83], v2 offset:5376
    ds_read_b128 v[248:251], v94
    v_mfma_f32_32x32x16_bf16 v[112:127], a[60:63], a[12:15], v[112:127]
    ds_read_b64_tr_b16 a[84:85], v2 offset:33792
    ds_read_b64_tr_b16 a[86:87], v2 offset:34048
    s_lshl_b32 s3, s7, 11
    v_mfma_f32_32x32x16_bf16 v[128:143], a[12:15], a[64:67], v[128:143]
    ds_read_b64_tr_b16 a[88:89], v3 offset:5120
    ds_read_b64_tr_b16 a[90:91], v3 offset:5376
    s_waitcnt vmcnt(9) lgkmcnt(8)
    v_mfma_f32_32x32x16_bf16 v[96:111], a[68:71], a[16:19], v[96:111]
    buffer_load_dwordx4 a[40:43], v29, s[48:51], s86 offen offset:256 sc1
    ds_read_b64_tr_b16 a[56:57], v2 offset:6144
    ds_read_b64_tr_b16 a[58:59], v2 offset:6400
    v_mfma_f32_32x32x16_bf16 v[112:127], a[72:75], a[16:19], v[112:127]
    buffer_load_dwordx4 a[44:47], v29, s[48:51], s87 offen offset:256 sc1
    ds_read_b64_tr_b16 a[60:61], v2 offset:34816
    ds_read_b64_tr_b16 a[62:63], v2 offset:35072
    v_mfma_f32_32x32x16_bf16 v[128:143], a[16:19], a[76:79], v[128:143]
    ds_read_b64_tr_b16 a[64:65], v3 offset:6144
    ds_read_b64_tr_b16 a[66:67], v3 offset:6400
    s_waitcnt vmcnt(8) lgkmcnt(6)
    v_mfma_f32_32x32x16_bf16 v[96:111], a[80:83], a[20:23], v[96:111]
    buffer_load_dwordx4 a[48:51], v29, s[48:51], s84 offen offset:384 sc1
    ds_read_b64_tr_b16 a[68:69], v2 offset:7168
    ds_read_b64_tr_b16 a[70:71], v2 offset:7424
    v_add_f32 v242, v200, v202
    v_add_f32_e64 v243, v201, v203
    v_mfma_f32_32x32x16_bf16 v[112:127], a[84:87], a[20:23], v[112:127]
    buffer_store_dwordx4 v[144:147], v84, s[52:55], 0 offen sc1
    ds_read_b64_tr_b16 a[72:73], v2 offset:35840
    ds_read_b64_tr_b16 a[74:75], v2 offset:36096
    s_waitcnt vmcnt(8)
    v_add_f32 v204, v204, v206
    v_mfma_f32_32x32x16_bf16 v[128:143], a[20:23], a[88:91], v[128:143]
    buffer_store_dwordx4 v[148:151], v84, s[52:55], 0 offen offset:512 sc1
    ds_read_b64_tr_b16 a[76:77], v3 offset:7168
    ds_read_b64_tr_b16 a[78:79], v3 offset:7424
    v_add_f32 v205, v205, v207
    s_waitcnt vmcnt(8) lgkmcnt(6)
    v_mfma_f32_32x32x16_bf16 v[96:111], a[56:59], a[24:27], v[96:111]
    buffer_load_dwordx4 a[52:55], v29, s[48:51], s85 offen offset:384 sc1
    ds_read_b64_tr_b16 a[80:81], v2 offset:8192
    ds_read_b64_tr_b16 a[82:83], v2 offset:8448
    v_add_f32 v242, v242, v204
    v_add_f32 v243, v243, v205
    v_mfma_f32_32x32x16_bf16 v[112:127], a[60:63], a[24:27], v[112:127]
    buffer_load_dwordx4 a[0:3], v29, s[48:51], s86 offen offset:384 sc1
    ds_read_b64_tr_b16 a[84:85], v2 offset:36864
    ds_read_b64_tr_b16 a[86:87], v2 offset:37120
    v_mov_b32_e64 v232, v242
    v_mfma_f32_32x32x16_bf16 v[128:143], a[24:27], a[64:67], v[128:143]
    buffer_store_dword v152, v87, s[52:55], 0 offen sc1
    ds_read_b64_tr_b16 a[88:89], v3 offset:8192
    ds_read_b64_tr_b16 a[90:91], v3 offset:8448
    v_mov_b32 v233, v243
    s_waitcnt vmcnt(10) lgkmcnt(6)
    v_mfma_f32_32x32x16_bf16 v[96:111], a[68:71], a[28:31], v[96:111]
    buffer_load_dwordx4 a[4:7], v29, s[48:51], s87 offen offset:384 sc1
    ds_read_b64_tr_b16 a[56:57], v2 offset:9216
    ds_read_b64_tr_b16 a[58:59], v2 offset:9472
    v_permlane32_swap_b32 v242, v232
    v_permlane32_swap_b32 v243, v233
    v_mfma_f32_32x32x16_bf16 v[112:127], a[72:75], a[28:31], v[112:127]
    ds_read_b64_tr_b16 a[60:61], v2 offset:37888
    ds_read_b64_tr_b16 a[62:63], v2 offset:38144
    v_add_f32_e64 v242, v242, v232
    v_mfma_f32_32x32x16_bf16 v[128:143], a[28:31], a[76:79], v[128:143]
    ds_read_b64_tr_b16 a[64:65], v3 offset:9216
    ds_read_b64_tr_b16 a[66:67], v3 offset:9472
    v_add_f32 v243, v243, v233
    s_waitcnt vmcnt(10) lgkmcnt(6)
    v_mfma_f32_32x32x16_bf16 v[96:111], a[80:83], a[32:35], v[96:111]
    buffer_load_dwordx4 a[8:11], v29, s[48:51], s84 offen offset:512 sc1
    ds_read_b64_tr_b16 a[68:69], v2 offset:10240
    ds_read_b64_tr_b16 a[70:71], v2 offset:10496
    v_mul_f32 v242, 0x3b124925, v242
    v_mul_f32 v243, 0x3b124925, v243
    v_mfma_f32_32x32x16_bf16 v[112:127], a[84:87], a[32:35], v[112:127]
    buffer_load_dwordx4 a[12:15], v29, s[48:51], s85 offen offset:512 sc1
    ds_read_b64_tr_b16 a[72:73], v2 offset:38912
    ds_read_b64_tr_b16 a[74:75], v2 offset:39168
    v_fma_f32 v243, -v242, v242, v243
    v_mfma_f32_32x32x16_bf16 v[128:143], a[32:35], a[88:91], v[128:143]
    ds_read_b64_tr_b16 a[76:77], v3 offset:10240
    ds_read_b64_tr_b16 a[78:79], v3 offset:10496
    v_max_f32 v243, 0, v243
    s_waitcnt vmcnt(11) lgkmcnt(6)
    v_mfma_f32_32x32x16_bf16 v[96:111], a[56:59], a[36:39], v[96:111]
    buffer_load_dwordx4 a[16:19], v29, s[48:51], s86 offen offset:512 sc1
    ds_read_b64_tr_b16 a[80:81], v2 offset:11264
    ds_read_b64_tr_b16 a[82:83], v2 offset:11520
    v_add_f32 v243, 0x3727c5ac, v243
    v_mfma_f32_32x32x16_bf16 v[112:127], a[60:63], a[36:39], v[112:127]
    ds_read_b64_tr_b16 a[84:85], v2 offset:39936
    ds_read_b64_tr_b16 a[86:87], v2 offset:40192
    v_rsq_f32 v234, v243
    v_mfma_f32_32x32x16_bf16 v[128:143], a[36:39], a[64:67], v[128:143]
    ds_read_b64_tr_b16 a[88:89], v3 offset:11264
    ds_read_b64_tr_b16 a[90:91], v3 offset:11520
    s_waitcnt vmcnt(11) lgkmcnt(6)
    v_mfma_f32_32x32x16_bf16 v[96:111], a[68:71], a[40:43], v[96:111]
    buffer_load_dwordx4 a[20:23], v29, s[48:51], s87 offen offset:512 sc1
    ds_read_b64_tr_b16 a[56:57], v2 offset:12288
    ds_read_b64_tr_b16 a[58:59], v2 offset:12544
    v_mul_f32 v235, v234, v242
    v_mfma_f32_32x32x16_bf16 v[112:127], a[72:75], a[40:43], v[112:127]
    buffer_load_dwordx4 a[24:27], v29, s[48:51], s84 offen offset:640 sc1
    ds_read_b64_tr_b16 a[60:61], v2 offset:40960
    ds_read_b64_tr_b16 a[62:63], v2 offset:41216
    v_cndmask_b32_e64 v232, v234, v235, s[62:63]
    v_mfma_f32_32x32x16_bf16 v[128:143], a[40:43], a[76:79], v[128:143]
    ds_read_b64_tr_b16 a[64:65], v3 offset:12288
    ds_read_b64_tr_b16 a[66:67], v3 offset:12544
    ds_write_b32 v25, v232
    s_waitcnt vmcnt(12) lgkmcnt(7)
    v_mfma_f32_32x32x16_bf16 v[96:111], a[80:83], a[44:47], v[96:111]
    buffer_load_dwordx4 a[28:31], v29, s[48:51], s85 offen offset:640 sc1
    ds_read_b64_tr_b16 a[68:69], v2 offset:13312
    ds_read_b64_tr_b16 a[70:71], v2 offset:13568
    ds_read_b128 v[200:203], v26 offset:0
    ds_read_b128 v[204:207], v26 offset:32
    v_mfma_f32_32x32x16_bf16 v[112:127], a[84:87], a[44:47], v[112:127]
    ds_read_b64_tr_b16 a[72:73], v2 offset:41984
    ds_read_b64_tr_b16 a[74:75], v2 offset:42240
    ds_read_b128 v[208:211], v26 offset:64
    v_mfma_f32_32x32x16_bf16 v[128:143], a[44:47], a[88:91], v[128:143]
    ds_read_b64_tr_b16 a[76:77], v3 offset:13312
    ds_read_b64_tr_b16 a[78:79], v3 offset:13568
    ds_read_b128 v[212:215], v26 offset:96
    s_waitcnt vmcnt(12) lgkmcnt(11)
    v_mfma_f32_32x32x16_bf16 v[96:111], a[56:59], a[48:51], v[96:111]
    buffer_load_dwordx4 a[32:35], v29, s[48:51], s86 offen offset:640 sc1
    ds_read_b64_tr_b16 a[80:81], v2 offset:14336
    ds_read_b64_tr_b16 a[82:83], v2 offset:14592
    ds_read_b128 v[216:219], v26 offset:128
    ds_read_b128 v[220:223], v26 offset:160
    v_mfma_f32_32x32x16_bf16 v[112:127], a[60:63], a[48:51], v[112:127]
    buffer_load_dwordx4 a[36:39], v29, s[48:51], s87 offen offset:640 sc1
    ds_read_b64_tr_b16 a[84:85], v2 offset:43008
    ds_read_b64_tr_b16 a[86:87], v2 offset:43264
    ds_read_b128 v[224:227], v26 offset:192
    v_mfma_f32_32x32x16_bf16 v[128:143], a[48:51], a[64:67], v[128:143]
    ds_read_b64_tr_b16 a[88:89], v3 offset:14336
    ds_read_b64_tr_b16 a[90:91], v3 offset:14592
    ds_read_b128 v[228:231], v26 offset:224
    s_waitcnt vmcnt(11) lgkmcnt(11)
    v_mfma_f32_32x32x16_bf16 v[96:111], a[68:71], a[52:55], v[96:111]
    buffer_load_dwordx4 a[40:43], v29, s[48:51], s84 offen offset:768 sc1
    ds_read_b64_tr_b16 a[56:57], v2 offset:15360
    ds_read_b64_tr_b16 a[58:59], v2 offset:15616
    v_mul_f32 v236, 0x3e8b97f6, v234
    v_mul_f32 v237, 0x3e8b97f6, v235
    v_mfma_f32_32x32x16_bf16 v[112:127], a[72:75], a[52:55], v[112:127]
    ds_read_b64_tr_b16 a[60:61], v2 offset:44032
    ds_read_b64_tr_b16 a[62:63], v2 offset:44288
    v_cndmask_b32_e64 v238, v236, 0, s[62:63]
    v_mfma_f32_32x32x16_bf16 v[128:143], a[52:55], a[76:79], v[128:143]
    ds_read_b64_tr_b16 a[64:65], v3 offset:15360
    ds_read_b64_tr_b16 a[66:67], v3 offset:15616
    v_mul_f32_e64 v184, v235, v184
    s_barrier
    s_waitcnt vmcnt(11) lgkmcnt(7)
    v_mfma_f32_32x32x16_bf16 v[96:111], a[80:83], a[0:3], v[96:111]
    buffer_load_dwordx4 a[44:47], v29, s[48:51], s85 offen offset:768 sc1
    ds_read_b64_tr_b16 a[68:69], v2 offset:16384
    ds_read_b64_tr_b16 a[70:71], v2 offset:16640
    v_mul_f32 v185, v235, v185
    v_mul_f32 v186, v235, v186
    v_mfma_f32_32x32x16_bf16 v[112:127], a[84:87], a[0:3], v[112:127]
    buffer_load_dwordx4 a[48:51], v29, s[48:51], s86 offen offset:768 sc1
    ds_read_b64_tr_b16 a[72:73], v2 offset:45056
    ds_read_b64_tr_b16 a[74:75], v2 offset:45312
    v_mul_f32_e64 v187, v235, v187
    v_mfma_f32_32x32x16_bf16 v[128:143], a[0:3], a[88:91], v[128:143]
    ds_read_b64_tr_b16 a[76:77], v3 offset:16384
    ds_read_b64_tr_b16 a[78:79], v3 offset:16640
    v_mul_f32 v188, v235, v188
    s_waitcnt vmcnt(11) lgkmcnt(6)
    v_mfma_f32_32x32x16_bf16 v[96:111], a[56:59], a[4:7], v[96:111]
    buffer_load_dwordx4 a[52:55], v29, s[48:51], s87 offen offset:768 sc1
    ds_read_b64_tr_b16 a[80:81], v2 offset:17408
    ds_read_b64_tr_b16 a[82:83], v2 offset:17664
    v_mul_f32 v189, v235, v189
    v_mul_f32 v190, v235, v190
    v_mfma_f32_32x32x16_bf16 v[112:127], a[60:63], a[4:7], v[112:127]
    ds_read_b64_tr_b16 a[84:85], v2 offset:46080
    ds_read_b64_tr_b16 a[86:87], v2 offset:46336
    v_mul_f32_e64 v191, v235, v191
    v_mfma_f32_32x32x16_bf16 v[128:143], a[4:7], a[64:67], v[128:143]
    ds_read_b64_tr_b16 a[88:89], v3 offset:17408
    ds_read_b64_tr_b16 a[90:91], v3 offset:17664
    v_mul_f32 v192, v235, v192
    s_waitcnt vmcnt(11) lgkmcnt(6)
    v_mfma_f32_32x32x16_bf16 v[96:111], a[68:71], a[8:11], v[96:111]
    s_add_u32 m0, s58, 0
    s_add_u32 s69, s68, 0
    buffer_load_dwordx4 v20, s[32:35], s69 offen lds
    ds_read_b64_tr_b16 a[56:57], v2 offset:18432
    ds_read_b64_tr_b16 a[58:59], v2 offset:18688
    v_mul_f32 v193, v235, v193
    v_mul_f32 v194, v235, v194
    v_mfma_f32_32x32x16_bf16 v[112:127], a[72:75], a[8:11], v[112:127]
    s_add_u32 m0, s58, 1024
    s_add_u32 s69, s68, 7168
    buffer_load_dwordx4 v21, s[32:35], s69 offen lds
    ds_read_b64_tr_b16 a[60:61], v2 offset:47104
    ds_read_b64_tr_b16 a[62:63], v2 offset:47360
    v_mul_f32_e64 v195, v235, v195
    v_mfma_f32_32x32x16_bf16 v[128:143], a[8:11], a[76:79], v[128:143]
    ds_read_b64_tr_b16 a[64:65], v3 offset:18432
    ds_read_b64_tr_b16 a[66:67], v3 offset:18688
    v_mul_f32 v196, v235, v196
    s_waitcnt vmcnt(12) lgkmcnt(6)
    v_mfma_f32_32x32x16_bf16 v[96:111], a[80:83], a[12:15], v[96:111]
    s_add_u32 m0, s58, 2048
    s_add_u32 s69, s68, 14336
    buffer_load_dwordx4 v20, s[32:35], s69 offen lds
    ds_read_b64_tr_b16 a[68:69], v2 offset:19456
    ds_read_b64_tr_b16 a[70:71], v2 offset:19712
    v_mul_f32 v197, v235, v197
    v_mul_f32 v198, v235, v198
    v_mul_f32_e64 v199, v235, v199
    v_mfma_f32_32x32x16_bf16 v[112:127], a[84:87], a[12:15], v[112:127]
    s_add_u32 m0, s58, 3072
    s_add_u32 s69, s68, 21504
    buffer_load_dwordx4 v21, s[32:35], s69 offen lds
    ds_read_b64_tr_b16 a[72:73], v2 offset:48128
    ds_read_b64_tr_b16 a[74:75], v2 offset:48384
    v_mul_f32_e64 v168, v237, v168
    ds_read_b64_tr_b16 a[92:93], v4 offset:0
    ds_read_b64_tr_b16 a[94:95], v4 offset:256
    v_mfma_f32_32x32x16_bf16 v[128:143], a[12:15], a[88:91], v[128:143]
    ds_read_b64_tr_b16 a[76:77], v3 offset:19456
    ds_read_b64_tr_b16 a[78:79], v3 offset:19712
    ds_read_b64_tr_b16 a[96:97], v4 offset:2048
    ds_read_b64_tr_b16 a[98:99], v4 offset:2304
    s_waitcnt vmcnt(13) lgkmcnt(10)
    v_mfma_f32_32x32x16_bf16 v[96:111], a[56:59], a[16:19], v[96:111]
    s_add_u32 m0, s58, 4096
    s_add_u32 s69, s68, 28672
    buffer_load_dwordx4 v20, s[32:35], s69 offen lds
    ds_read_b64_tr_b16 a[80:81], v2 offset:20480
    ds_read_b64_tr_b16 a[82:83], v2 offset:20736
    v_mul_f32 v169, v237, v169
    v_mul_f32 v170, v237, v170
    v_mul_f32 v171, v237, v171
    v_mfma_f32_32x32x16_bf16 v[112:127], a[60:63], a[16:19], v[112:127]
    s_add_u32 m0, s58, 5120
    s_add_u32 s69, s68, 35840
    buffer_load_dwordx4 v21, s[32:35], s69 offen lds
    ds_read_b64_tr_b16 a[84:85], v2 offset:49152
    ds_read_b64_tr_b16 a[86:87], v2 offset:49408
    v_mul_f32_e64 v172, v237, v172
    ds_read_b64_tr_b16 a[100:101], v4 offset:4096
    ds_read_b64_tr_b16 a[102:103], v4 offset:4352
    v_mfma_f32_32x32x16_bf16 v[128:143], a[16:19], a[64:67], v[128:143]
    ds_read_b64_tr_b16 a[88:89], v3 offset:20480
    ds_read_b64_tr_b16 a[90:91], v3 offset:20736
    ds_read_b64_tr_b16 a[104:105], v4 offset:6144
    ds_read_b64_tr_b16 a[106:107], v4 offset:6400
    s_waitcnt vmcnt(14) lgkmcnt(12)
    v_mfma_f32_32x32x16_bf16 v[96:111], a[68:71], a[20:23], v[96:111]
    s_add_u32 m0, s58, 6144
    s_add_u32 s69, s68, 43008
    buffer_load_dwordx4 v20, s[32:35], s69 offen lds
    ds_read_b64_tr_b16 a[56:57], v2 offset:21504
    ds_read_b64_tr_b16 a[58:59], v2 offset:21760
    v_mul_f32 v173, v237, v173
    v_mul_f32 v174, v237, v174
    v_mul_f32 v175, v237, v175
    v_mfma_f32_32x32x16_bf16 v[112:127], a[72:75], a[20:23], v[112:127]
    ds_read_b64_tr_b16 a[60:61], v2 offset:50176
    ds_read_b64_tr_b16 a[62:63], v2 offset:50432
    v_mul_f32_e64 v176, v237, v176
    ds_read_b64_tr_b16 a[108:109], v4 offset:8192
    ds_read_b64_tr_b16 a[110:111], v4 offset:8448
    v_mfma_f32_32x32x16_bf16 v[128:143], a[20:23], a[76:79], v[128:143]
    ds_read_b64_tr_b16 a[64:65], v3 offset:21504
    ds_read_b64_tr_b16 a[66:67], v3 offset:21760
    ds_read_b64_tr_b16 a[0:1], v4 offset:10240
    ds_read_b64_tr_b16 a[2:3], v4 offset:10496
    s_waitcnt vmcnt(14) lgkmcnt(12)
    v_mfma_f32_32x32x16_bf16 v[96:111], a[80:83], a[24:27], v[96:111]
    s_add_u32 m0, s58, 7168
    s_add_u32 s69, s68, 50176
    buffer_load_dwordx4 v21, s[32:35], s69 offen lds
    ds_read_b64_tr_b16 a[68:69], v2 offset:22528
    ds_read_b64_tr_b16 a[70:71], v2 offset:22784
    v_mul_f32 v177, v237, v177
    v_mul_f32 v178, v237, v178
    v_mul_f32 v179, v237, v179
    v_mfma_f32_32x32x16_bf16 v[112:127], a[84:87], a[24:27], v[112:127]
    s_add_u32 m0, s58, 8192
    s_add_u32 s69, s68, 57344
    buffer_load_dwordx4 v20, s[32:35], s69 offen lds
    ds_read_b64_tr_b16 a[72:73], v2 offset:51200
    ds_read_b64_tr_b16 a[74:75], v2 offset:51456
    v_mul_f32_e64 v180, v237, v180
    ds_read_b64_tr_b16 a[4:5], v4 offset:12288
    ds_read_b64_tr_b16 a[6:7], v4 offset:12544
    v_mfma_f32_32x32x16_bf16 v[128:143], a[24:27], a[88:91], v[128:143]
    ds_read_b64_tr_b16 a[76:77], v3 offset:22528
    ds_read_b64_tr_b16 a[78:79], v3 offset:22784
    ds_read_b64_tr_b16 a[8:9], v4 offset:14336
    ds_read_b64_tr_b16 a[10:11], v4 offset:14592
    s_waitcnt vmcnt(15) lgkmcnt(12)
    v_mfma_f32_32x32x16_bf16 v[96:111], a[56:59], a[28:31], v[96:111]
    s_add_u32 m0, s58, 9216
    s_add_u32 s69, s68, 64512
    buffer_load_dwordx4 v21, s[32:35], s69 offen lds
    ds_read_b64_tr_b16 a[80:81], v2 offset:23552
    ds_read_b64_tr_b16 a[82:83], v2 offset:23808
    v_mul_f32 v181, v237, v181
    v_mul_f32 v182, v237, v182
    v_mul_f32 v183, v237, v183
    v_mfma_f32_32x32x16_bf16 v[112:127], a[60:63], a[28:31], v[112:127]
    s_add_u32 m0, s58, 10240
    s_add_u32 s69, s68, 71680
    buffer_load_dwordx4 v20, s[32:35], s69 offen lds
    ds_read_b64_tr_b16 a[84:85], v2 offset:52224
    ds_read_b64_tr_b16 a[86:87], v2 offset:52480
    v_mul_f32_e64 v216, v239, v216
    ds_read_b64_tr_b16 a[12:13], v4 offset:16384
    ds_read_b64_tr_b16 a[14:15], v4 offset:16640
    v_mfma_f32_32x32x16_bf16 v[128:143], a[28:31], a[64:67], v[128:143]
    ds_read_b64_tr_b16 a[88:89], v3 offset:23552
    ds_read_b64_tr_b16 a[90:91], v3 offset:23808
    ds_read_b64_tr_b16 a[16:17], v4 offset:18432
    ds_read_b64_tr_b16 a[18:19], v4 offset:18688
    s_waitcnt vmcnt(16) lgkmcnt(12)
    v_mfma_f32_32x32x16_bf16 v[96:111], a[68:71], a[32:35], v[96:111]
    s_add_u32 m0, s58, 11264
    s_add_u32 s69, s68, 78848
    buffer_load_dwordx4 v21, s[32:35], s69 offen lds
    ds_read_b64_tr_b16 a[56:57], v2 offset:24576
    ds_read_b64_tr_b16 a[58:59], v2 offset:24832
    v_mul_f32 v217, v239, v217
    v_mul_f32 v218, v239, v218
    v_mul_f32 v219, v239, v219
    v_mfma_f32_32x32x16_bf16 v[112:127], a[72:75], a[32:35], v[112:127]
    s_add_u32 m0, s58, 12288
    s_add_u32 s69, s68, 86016
    buffer_load_dwordx4 v20, s[32:35], s69 offen lds
    ds_read_b64_tr_b16 a[60:61], v2 offset:53248
    ds_read_b64_tr_b16 a[62:63], v2 offset:53504
    v_mul_f32_e64 v220, v239, v220
    ds_read_b64_tr_b16 a[20:21], v4 offset:20480
    ds_read_b64_tr_b16 a[22:23], v4 offset:20736
    v_mfma_f32_32x32x16_bf16 v[128:143], a[32:35], a[76:79], v[128:143]
    ds_read_b64_tr_b16 a[64:65], v3 offset:24576
    ds_read_b64_tr_b16 a[66:67], v3 offset:24832
    ds_read_b64_tr_b16 a[24:25], v4 offset:22528
    ds_read_b64_tr_b16 a[26:27], v4 offset:22784
    s_waitcnt vmcnt(17) lgkmcnt(12)
    v_mfma_f32_32x32x16_bf16 v[96:111], a[80:83], a[36:39], v[96:111]
    buffer_load_dwordx2 v[252:253], v86, s[52:55], 0 offen sc1
    ds_read_b64_tr_b16 a[68:69], v2 offset:25600
    ds_read_b64_tr_b16 a[70:71], v2 offset:25856
    v_mul_f32 v221, v239, v221
    v_mul_f32 v222, v239, v222
    v_mul_f32 v223, v239, v223
    v_mfma_f32_32x32x16_bf16 v[112:127], a[84:87], a[36:39], v[112:127]
    buffer_load_dwordx2 v[254:255], v12, s[52:55], 0 offen offset:256 sc1
    ds_read_b64_tr_b16 a[72:73], v2 offset:54272
    ds_read_b64_tr_b16 a[74:75], v2 offset:54528
    v_mul_f32_e64 v224, v239, v224
    ds_read_b64_tr_b16 a[28:29], v4 offset:24576
    ds_read_b64_tr_b16 a[30:31], v4 offset:24832
    v_mfma_f32_32x32x16_bf16 v[128:143], a[36:39], a[88:91], v[128:143]
    s_add_u32 m0, s58, 13312
    s_add_u32 s69, s68, 93184
    buffer_load_dwordx4 v21, s[32:35], s69 offen lds
    ds_read_b64_tr_b16 a[76:77], v3 offset:25600
    ds_read_b64_tr_b16 a[78:79], v3 offset:25856
    ds_read_b64_tr_b16 a[32:33], v4 offset:26624
    ds_read_b64_tr_b16 a[34:35], v4 offset:26880
    s_waitcnt vmcnt(19) lgkmcnt(12)
    v_mfma_f32_32x32x16_bf16 v[96:111], a[56:59], a[40:43], v[96:111]
    s_add_u32 m0, s3, 150288
    s_mov_b32 s69, 0
    buffer_load_dwordx4 v13, s[52:55], s69 offen sc1 lds
    ds_read_b64_tr_b16 a[80:81], v2 offset:26624
    ds_read_b64_tr_b16 a[82:83], v2 offset:26880
    v_mul_f32 v225, v239, v225
    v_mul_f32 v226, v239, v226
    v_mfma_f32_32x32x16_bf16 v[112:127], a[60:63], a[40:43], v[112:127]
    s_add_u32 m0, s3, 151312
    s_mov_b32 s69, 1024
    buffer_load_dwordx4 v13, s[52:55], s69 offen sc1 lds
    ds_read_b64_tr_b16 a[84:85], v2 offset:55296
    ds_read_b64_tr_b16 a[86:87], v2 offset:55552
    v_mul_f32_e64 v227, v239, v227
    v_mfma_f32_32x32x16_bf16 v[128:143], a[40:43], a[64:67], v[128:143]
    ds_read_b64_tr_b16 a[88:89], v3 offset:26624
    ds_read_b64_tr_b16 a[90:91], v3 offset:26880
    v_mul_f32 v228, v239, v228
    s_waitcnt vmcnt(20) lgkmcnt(8)
    v_mfma_f32_32x32x16_bf16 v[96:111], a[68:71], a[44:47], v[96:111]
    ds_read_b64_tr_b16 a[56:57], v2 offset:27648
    ds_read_b64_tr_b16 a[58:59], v2 offset:27904
    v_mul_f32_e64 v229, v239, v229
    v_mfma_f32_32x32x16_bf16 v[112:127], a[72:75], a[44:47], v[112:127]
    ds_read_b64_tr_b16 a[60:61], v2 offset:56320
    ds_read_b64_tr_b16 a[62:63], v2 offset:56576
    v_mul_f32_e64 v230, v239, v230
    v_mfma_f32_32x32x16_bf16 v[128:143], a[44:47], a[76:79], v[128:143]
    ds_read_b64_tr_b16 a[64:65], v3 offset:27648
    ds_read_b64_tr_b16 a[66:67], v3 offset:27904
    v_mul_f32 v231, v239, v231
    s_waitcnt vmcnt(19) lgkmcnt(6)
    v_mfma_f32_32x32x16_bf16 v[96:111], a[80:83], a[48:51], v[96:111]
    v_mfma_f32_32x32x16_bf16 v[112:127], a[84:87], a[48:51], v[112:127]
    v_mfma_f32_32x32x16_bf16 v[128:143], a[48:51], a[88:91], v[128:143]
    s_waitcnt vmcnt(18) lgkmcnt(0)
    v_mfma_f32_32x32x16_bf16 v[112:127], a[60:63], a[52:55], v[112:127]
    v_mfma_f32_32x32x16_bf16 v[96:111], a[56:59], a[52:55], v[96:111]
    v_mfma_f32_32x32x16_bf16 v[128:143], a[52:55], a[64:67], v[128:143]
    s_nop 9
    v_pk_fma_f32 v[112:113], v[112:113], v[234:235], v[184:185] op_sel_hi:[1,0,1] neg_lo:[0,0,1] neg_hi:[0,0,1]
    v_pk_fma_f32 v[114:115], v[114:115], v[234:235], v[186:187] op_sel_hi:[1,0,1] neg_lo:[0,0,1] neg_hi:[0,0,1]
    v_pk_fma_f32 v[116:117], v[116:117], v[234:235], v[188:189] op_sel_hi:[1,0,1] neg_lo:[0,0,1] neg_hi:[0,0,1]
    v_pk_fma_f32 v[118:119], v[118:119], v[234:235], v[190:191] op_sel_hi:[1,0,1] neg_lo:[0,0,1] neg_hi:[0,0,1]
    v_pk_fma_f32 v[120:121], v[120:121], v[234:235], v[192:193] op_sel_hi:[1,0,1] neg_lo:[0,0,1] neg_hi:[0,0,1]
    v_pk_fma_f32 v[122:123], v[122:123], v[234:235], v[194:195] op_sel_hi:[1,0,1] neg_lo:[0,0,1] neg_hi:[0,0,1]
    v_pk_fma_f32 v[124:125], v[124:125], v[234:235], v[196:197] op_sel_hi:[1,0,1] neg_lo:[0,0,1] neg_hi:[0,0,1]
    v_pk_fma_f32 v[126:127], v[126:127], v[234:235], v[198:199] op_sel_hi:[1,0,1] neg_lo:[0,0,1] neg_hi:[0,0,1]
    v_cvt_pk_bf16_f32 v144, v112, v113
    v_cvt_pk_bf16_f32 v145, v114, v115
    v_cvt_pk_bf16_f32 v146, v116, v117
    v_cvt_pk_bf16_f32 v147, v118, v119
    v_cvt_pk_bf16_f32 v148, v120, v121
    v_cvt_pk_bf16_f32 v149, v122, v123
    v_cvt_pk_bf16_f32 v150, v124, v125
    v_cvt_pk_bf16_f32 v151, v126, v127
    s_mov_b32 exec_lo, 0xff000000
    s_mov_b32 exec_hi, 0xff000000
    ds_write_b128 v23, v[144:147] offset:1024
    ds_write_b128 v23, v[148:151] offset:1280
    s_mov_b64 exec, -1
    s_nop 0
    v_pk_fma_f32 v[96:97], v[96:97], v[236:237], v[168:169] op_sel_hi:[1,0,1] neg_lo:[0,0,1] neg_hi:[0,0,1]
    v_pk_fma_f32 v[98:99], v[98:99], v[236:237], v[170:171] op_sel_hi:[1,0,1] neg_lo:[0,0,1] neg_hi:[0,0,1]
    v_pk_fma_f32 v[100:101], v[100:101], v[236:237], v[172:173] op_sel_hi:[1,0,1] neg_lo:[0,0,1] neg_hi:[0,0,1]
    v_pk_fma_f32 v[102:103], v[102:103], v[236:237], v[174:175] op_sel_hi:[1,0,1] neg_lo:[0,0,1] neg_hi:[0,0,1]
    v_pk_fma_f32 v[104:105], v[104:105], v[236:237], v[176:177] op_sel_hi:[1,0,1] neg_lo:[0,0,1] neg_hi:[0,0,1]
    v_pk_fma_f32 v[106:107], v[106:107], v[236:237], v[178:179] op_sel_hi:[1,0,1] neg_lo:[0,0,1] neg_hi:[0,0,1]
    v_pk_fma_f32 v[108:109], v[108:109], v[238:239], v[180:181] op_sel_hi:[1,0,1] neg_lo:[0,0,1] neg_hi:[0,0,1]
    v_pk_fma_f32 v[110:111], v[110:111], v[238:239], v[182:183] op_sel_hi:[1,0,1] neg_lo:[0,0,1] neg_hi:[0,0,1]
    v_cvt_pk_bf16_f32 v160, v96, v97
    v_cvt_pk_bf16_f32 v161, v98, v99
    v_cvt_pk_bf16_f32 v162, v100, v101
    v_cvt_pk_bf16_f32 v163, v102, v103
    v_cvt_pk_bf16_f32 v164, v104, v105
    v_cvt_pk_bf16_f32 v165, v106, v107
    v_cvt_pk_bf16_f32 v166, v108, v109
    v_cvt_pk_bf16_f32 v167, v110, v111
    v_mfma_f32_32x32x16_bf16 v[112:127], v[144:147], v[160:163], v[48:63]
    s_nop 0
    s_nop 0
    v_mfma_f32_32x32x16_bf16 v[112:127], v[148:151], v[164:167], v[112:127]
    v_pk_fma_f32 v[128:129], v[128:129], v[200:201], v[216:217] neg_lo:[0,0,1] neg_hi:[0,0,1]
    v_pk_fma_f32 v[130:131], v[130:131], v[202:203], v[218:219] neg_lo:[0,0,1] neg_hi:[0,0,1]
    v_pk_fma_f32 v[132:133], v[132:133], v[204:205], v[220:221] neg_lo:[0,0,1] neg_hi:[0,0,1]
    v_pk_fma_f32 v[134:135], v[134:135], v[206:207], v[222:223] neg_lo:[0,0,1] neg_hi:[0,0,1]
    v_pk_fma_f32 v[136:137], v[136:137], v[208:209], v[224:225] neg_lo:[0,0,1] neg_hi:[0,0,1]
    v_pk_fma_f32 v[138:139], v[138:139], v[210:211], v[226:227] neg_lo:[0,0,1] neg_hi:[0,0,1]
    v_pk_fma_f32 v[140:141], v[140:141], v[212:213], v[228:229] neg_lo:[0,0,1] neg_hi:[0,0,1]
    v_pk_fma_f32 v[142:143], v[142:143], v[214:215], v[230:231] neg_lo:[0,0,1] neg_hi:[0,0,1]
    v_cvt_pk_bf16_f32 v152, v128, v129
    v_cvt_pk_bf16_f32 v153, v130, v131
    v_cvt_pk_bf16_f32 v154, v132, v133
    v_cvt_pk_bf16_f32 v155, v134, v135
    v_cvt_pk_bf16_f32 v156, v136, v137
    v_cvt_pk_bf16_f32 v157, v138, v139
    v_cvt_pk_bf16_f32 v158, v140, v141
    v_cvt_pk_bf16_f32 v159, v142, v143
    v_cndmask_b32_e64 v152, v152, v82, s[18:19]
    v_cndmask_b32_e64 v153, v153, v82, s[18:19]
    v_cndmask_b32_e64 v154, v154, v82, s[18:19]
    v_cndmask_b32_e64 v155, v155, v82, s[18:19]
    v_cndmask_b32_e64 v156, v156, v82, s[18:19]
    v_cndmask_b32_e64 v157, v157, v82, s[18:19]
    v_cndmask_b32_e64 v158, v158, v82, s[18:19]
    v_cndmask_b32_e64 v159, v159, v82, s[18:19]
    ds_write_b64 v24, v[158:159] offset:1024
    v_max3_f32 v239, v112, v113, v114
    v_max3_f32 v233, v115, v116, v117
    v_max3_f32 v239, v239, v118, v119
    v_max3_f32 v233, v233, v120, v121
    v_max3_f32 v239, v239, v122, v123
    v_max3_f32 v233, v233, v124, v125
    v_max3_f32 v233, v233, v126, v127
    v_max_f32 v239, v239, v233
    v_mov_b32 v233, v239
    s_nop 1
    v_permlane32_swap_b32 v239, v233
    v_max_f32_e64 v239, v239, v233
    v_pk_add_f32 v[112:113], v[112:113], v[238:239] op_sel:[0,1] neg_lo:[0,1] neg_hi:[0,1]
    v_pk_add_f32 v[114:115], v[114:115], v[238:239] op_sel:[0,1] neg_lo:[0,1] neg_hi:[0,1]
    v_pk_add_f32 v[116:117], v[116:117], v[238:239] op_sel:[0,1] neg_lo:[0,1] neg_hi:[0,1]
    v_pk_add_f32 v[118:119], v[118:119], v[238:239] op_sel:[0,1] neg_lo:[0,1] neg_hi:[0,1]
    v_pk_add_f32 v[120:121], v[120:121], v[238:239] op_sel:[0,1] neg_lo:[0,1] neg_hi:[0,1]
    v_pk_add_f32 v[122:123], v[122:123], v[238:239] op_sel:[0,1] neg_lo:[0,1] neg_hi:[0,1]
    v_pk_add_f32 v[124:125], v[124:125], v[238:239] op_sel:[0,1] neg_lo:[0,1] neg_hi:[0,1]
    v_pk_add_f32 v[126:127], v[126:127], v[238:239] op_sel:[0,1] neg_lo:[0,1] neg_hi:[0,1]
    v_exp_f32 v112, v112
    v_exp_f32 v113, v113
    v_exp_f32 v114, v114
    v_exp_f32 v115, v115
    v_exp_f32 v116, v116
    v_exp_f32 v117, v117
    v_exp_f32 v118, v118
    v_exp_f32 v119, v119
    v_cvt_pk_bf16_f32 v184, v112, v113
    v_cvt_pk_bf16_f32 v185, v114, v115
    v_cvt_pk_bf16_f32 v186, v116, v117
    v_cvt_pk_bf16_f32 v187, v118, v119
    v_exp_f32 v120, v120
    v_exp_f32 v121, v121
    v_exp_f32 v122, v122
    v_exp_f32 v123, v123
    v_exp_f32 v124, v124
    v_exp_f32 v125, v125
    v_exp_f32 v126, v126
    v_exp_f32 v127, v127
    v_mfma_f32_32x32x16_bf16 v[128:143], v[152:155], v[184:187], 0
    v_cvt_pk_bf16_f32 v188, v120, v121
    v_cvt_pk_bf16_f32 v189, v122, v123
    v_cvt_pk_bf16_f32 v190, v124, v125
    v_cvt_pk_bf16_f32 v191, v126, v127
    s_nop 1
    v_mfma_f32_32x32x16_bf16 v[128:143], v[156:159], v[188:191], v[128:143]
    s_waitcnt vmcnt(0)
    s_barrier
    ds_read_b128 v[200:203], v5 offset:0
    ds_read_b128 v[204:207], v5 offset:512
    ds_read_b128 v[208:211], v5 offset:1024
    ds_read_b128 v[212:215], v5 offset:1536
    ds_read_b128 v[216:219], v5 offset:2048
    ds_read_b128 v[220:223], v5 offset:2560
    ds_read_b128 v[224:227], v5 offset:3072
    ds_read_b128 v[228:231], v5 offset:3584
    ds_read_b128 v[96:99], v5 offset:4096
    ds_read_b128 v[100:103], v5 offset:4608
    ds_read_b128 v[104:107], v5 offset:5120
    ds_read_b128 v[108:111], v5 offset:5632
    ds_read_b128 v[192:195], v5 offset:6144
    ds_read_b128 v[196:199], v5 offset:6656
    v_add_f32 v242, v252, v254
    v_add_f32_e64 v243, v253, v255
    v_max3_u32 v232, v252, v253, v254
    v_max_u32 v232, v232, v255
    v_permlane32_swap_b32 v242, v243
    v_add_f32 v242, v242, v243
    v_mov_b32 v243, v242
    s_nop 1
    v_permlane16_swap_b32 v242, v243
    v_add_f32 v242, v242, v243
    v_mov_b32 v243, v242
    s_nop 1
    v_permlane32_swap_b32 v242, v243
    v_mul_f32 v242, 0x3b124925, v242
    v_mul_f32 v243, 0x3b124925, v243
    v_fma_f32 v243, -v242, v242, v243
    v_max_f32_e64 v243, 0, v243
    v_add_f32 v243, 0x3727c5ac, v243
    v_rsq_f32 v240, v243
    s_nop 0
    v_mul_f32_e64 v241, v240, v242
    s_waitcnt lgkmcnt(13)
    v_mfma_f32_16x16x32_bf16 v[244:247], a[92:95], v[200:203], 0
    s_waitcnt lgkmcnt(12)
    v_mfma_f32_16x16x32_bf16 v[168:171], a[96:99], v[204:207], 0
    v_max3_u32 v232, v232, v203, v207
    s_waitcnt lgkmcnt(11)
    v_mfma_f32_16x16x32_bf16 v[244:247], a[100:103], v[208:211], v[244:247]
    s_waitcnt lgkmcnt(10)
    v_mfma_f32_16x16x32_bf16 v[168:171], a[104:107], v[212:215], v[168:171]
    v_max3_u32 v232, v232, v211, v215
    s_waitcnt lgkmcnt(9)
    v_mfma_f32_16x16x32_bf16 v[244:247], a[108:111], v[216:219], v[244:247]
    s_waitcnt lgkmcnt(8)
    v_mfma_f32_16x16x32_bf16 v[168:171], a[0:3], v[220:223], v[168:171]
    v_max3_u32 v232, v232, v219, v223
    s_waitcnt lgkmcnt(7)
    v_mfma_f32_16x16x32_bf16 v[244:247], a[4:7], v[224:227], v[244:247]
    s_waitcnt lgkmcnt(6)
    v_mfma_f32_16x16x32_bf16 v[168:171], a[8:11], v[228:231], v[168:171]
    v_max3_u32 v232, v232, v227, v231
    s_waitcnt lgkmcnt(5)
    v_mfma_f32_16x16x32_bf16 v[244:247], a[12:15], v[96:99], v[244:247]
    s_waitcnt lgkmcnt(4)
    v_mfma_f32_16x16x32_bf16 v[168:171], a[16:19], v[100:103], v[168:171]
    v_max3_u32 v232, v232, v99, v103
    s_waitcnt lgkmcnt(3)
    v_mfma_f32_16x16x32_bf16 v[244:247], a[20:23], v[104:107], v[244:247]
    s_waitcnt lgkmcnt(2)
    v_mfma_f32_16x16x32_bf16 v[168:171], a[24:27], v[108:111], v[168:171]
    v_max3_u32 v232, v232, v107, v111
    s_waitcnt lgkmcnt(1)
    v_mfma_f32_16x16x32_bf16 v[244:247], a[28:31], v[192:195], v[244:247]
    s_waitcnt lgkmcnt(0)
    v_mfma_f32_16x16x32_bf16 v[168:171], a[32:35], v[196:199], v[168:171]
    v_max3_u32 v232, v232, v195, v199
    s_nop 6
    v_add_f32 v244, v244, v168
    v_add_f32 v245, v245, v169
    v_add_f32 v246, v246, v170
    v_add_f32_e64 v247, v247, v171
    v_cmp_eq_u32 vcc, -1, v232
    s_cbranch_vccnz Lhaloretry_46
Lhalook_47:
    v_pk_mul_f32 v[248:249], v[248:249], v[240:241] op_sel:[0,1]
    v_pk_fma_f32 v[244:245], v[244:245], v[240:241], v[248:249] op_sel_hi:[1,0,1] neg_lo:[0,0,1] neg_hi:[0,0,1]
    v_pk_mul_f32 v[250:251], v[250:251], v[240:241] op_sel:[0,1]
    v_pk_fma_f32 v[246:247], v[246:247], v[240:241], v[250:251] op_sel_hi:[1,0,1] neg_lo:[0,0,1] neg_hi:[0,0,1]
    v_cvt_pk_bf16_f32 v244, v244, v245
    v_cvt_pk_bf16_f32 v245, v246, v247
    s_mov_b32 exec_lo, 0xff00ff00
    s_mov_b32 exec_hi, 0xff00ff00
    s_cmp_ge_u32 s7, 2
    s_cbranch_scc1 Lhv_48
    ds_write_b64 v31, v[244:245]
Lhj_49:
    s_mov_b64 exec, -1
    s_waitcnt lgkmcnt(0)
    s_barrier
    ds_read_b128 v[168:171], v23
    ds_read_b128 v[172:175], v23 offset:256
    ds_read_b64 v[178:179], v24
    v_mov_b32 v176, 0
    v_mov_b32 v177, 0
    v_mov_b32 v192, 0
    v_mov_b32 v193, 0
    s_waitcnt lgkmcnt(2)
    v_mfma_f32_32x32x16_bf16 v[96:111], v[168:171], v[160:163], v[52:67]
    s_waitcnt lgkmcnt(1)
    v_mfma_f32_32x32x16_bf16 v[96:111], v[172:175], v[164:167], v[96:111]
    s_nop 11
    v_max3_f32 v232, v239, v108, v109
    v_max3_f32 v232, v232, v110, v111
    v_mov_b32 v233, v232
    s_nop 1
    v_permlane32_swap_b32 v232, v233
    v_max_f32 v232, v232, v233
    v_sub_f32_e64 v239, v239, v232
    v_pk_add_f32 v[108:109], v[108:109], v[232:233] op_sel_hi:[1,0] neg_lo:[0,1] neg_hi:[0,1]
    v_pk_add_f32 v[110:111], v[110:111], v[232:233] op_sel_hi:[1,0] neg_lo:[0,1] neg_hi:[0,1]
    v_exp_f32 v239, v239
    v_exp_f32 v108, v108
    v_exp_f32 v109, v109
    v_exp_f32 v110, v110
    v_exp_f32_e64 v111, v111
    v_pk_mul_f32 v[128:129], v[128:129], v[238:239] op_sel:[0,1]
    v_pk_mul_f32 v[130:131], v[130:131], v[238:239] op_sel:[0,1]
    v_pk_mul_f32 v[132:133], v[132:133], v[238:239] op_sel:[0,1]
    v_pk_mul_f32 v[134:135], v[134:135], v[238:239] op_sel:[0,1]
    v_pk_mul_f32 v[136:137], v[136:137], v[238:239] op_sel:[0,1]
    v_pk_mul_f32 v[138:139], v[138:139], v[238:239] op_sel:[0,1]
    v_pk_mul_f32 v[140:141], v[140:141], v[238:239] op_sel:[0,1]
    v_pk_mul_f32 v[142:143], v[142:143], v[238:239] op_sel:[0,1]
    v_cvt_pk_bf16_f32 v194, v108, v109
    v_cvt_pk_bf16_f32 v195, v110, v111
    s_waitcnt lgkmcnt(0)
    s_nop 0
    v_mfma_f32_32x32x16_bf16 v[128:143], v[176:179], v[192:195], v[128:143]
    s_nop 11
    v_mov_b32 v232, v140
    v_mov_b32 v233, v140
    s_mul_i32 s56, s8, 114688
    s_add_u32 s56, s56, 4194304
    v_permlane32_swap_b32 v232, v233
    v_rcp_f32 v233, v233
    s_nop 0
    v_pk_mul_f32 v[128:129], v[128:129], v[232:233] op_sel:[0,1]
    v_pk_mul_f32 v[130:131], v[130:131], v[232:233] op_sel:[0,1]
    v_pk_mul_f32 v[132:133], v[132:133], v[232:233] op_sel:[0,1]
    v_pk_mul_f32 v[134:135], v[134:135], v[232:233] op_sel:[0,1]
    v_pk_mul_f32 v[136:137], v[136:137], v[232:233] op_sel:[0,1]
    v_pk_mul_f32 v[138:139], v[138:139], v[232:233] op_sel:[0,1]
    v_pk_mul_f32 v[140:141], v[140:141], v[232:233] op_sel:[0,1]
    v_pk_mul_f32 v[142:143], v[142:143], v[232:233] op_sel:[0,1]
    v_cvt_pk_bf16_f32 v144, v128, v129
    v_cvt_pk_bf16_f32 v145, v130, v131
    v_cvt_pk_bf16_f32 v146, v132, v133
    v_cvt_pk_bf16_f32 v147, v134, v135
    v_cvt_pk_bf16_f32 v148, v136, v137
    v_cvt_pk_bf16_f32 v149, v138, v139
    v_cvt_pk_bf16_f32 v150, v140, v141
    v_cvt_pk_bf16_f32 v151, v142, v143
    s_cmp_lg_u32 s10, 0
    s_cbranch_scc1 Lslow_50
    buffer_store_dwordx2 v[144:145], v10, s[52:55], s56 offen offset:0
    buffer_store_dwordx2 v[146:147], v10, s[52:55], s56 offen offset:256
    buffer_store_dwordx2 v[148:149], v10, s[52:55], s56 offen offset:512
    buffer_store_dwordx2 v[150:151], v11, s[52:55], s56 offen offset:768
Ljoin_51:
    s_lshl_b32 s13, s8, 2
    s_add_u32 s13, s13, s7
    s_lshl_b32 s13, s13, 7
    s_lshl_b32 s14, s6, 2
    s_add_u32 s13, s13, s14
    s_add_u32 s56, s13, 24576
    s_lshl_b32 s90, s8, 2
    s_add_u32 s90, s90, s23
    s_lshl_b32 s90, s90, 7
    s_add_u32 s90, s90, 24576
    s_mul_i32 s91, s8, 114688
    s_mul_i32 s14, s23, 28672
    s_add_u32 s91, s91, s14
    s_and_b32 s14, s7, 1
    s_mul_i32 s14, s14, 14336
    s_add_u32 s91, s91, s14
    s_nop 0
    s_add_u32 s91, s91, 4194304
    ds_read_b64_tr_b16 v[96:97], v6 offset:0
    ds_read_b64_tr_b16 v[98:99], v6 offset:512
    ds_read_b64_tr_b16 v[100:101], v7 offset:0
    ds_read_b64_tr_b16 v[102:103], v7 offset:512
    ds_read_b64_tr_b16 v[104:105], v8 offset:0
    ds_read_b64_tr_b16 v[106:107], v8 offset:512
    ds_read_b64_tr_b16 v[108:109], v9 offset:0
    ds_read_b64_tr_b16 v[110:111], v9 offset:512
    ds_read_b64_tr_b16 v[112:113], v6 offset:4096
    ds_read_b64_tr_b16 v[114:115], v6 offset:4608
    ds_read_b64_tr_b16 v[116:117], v7 offset:4096
    ds_read_b64_tr_b16 v[118:119], v7 offset:4608
    ds_read_b64_tr_b16 v[120:121], v8 offset:4096
    ds_read_b64_tr_b16 v[122:123], v8 offset:4608
    ds_read_b64_tr_b16 v[124:125], v9 offset:4096
    ds_read_b64_tr_b16 v[126:127], v9 offset:4608
    ds_read_b64_tr_b16 v[128:129], v6 offset:8192
    ds_read_b64_tr_b16 v[130:131], v6 offset:8704
    ds_read_b64_tr_b16 v[132:133], v7 offset:8192
    ds_read_b64_tr_b16 v[134:135], v7 offset:8704
    ds_read_b64_tr_b16 v[136:137], v8 offset:8192
    ds_read_b64_tr_b16 v[138:139], v8 offset:8704
    ds_read_b64_tr_b16 v[140:141], v9 offset:8192
    ds_read_b64_tr_b16 v[142:143], v9 offset:8704
    v_add_u32 v254, s59, v1
    v_add_u32 v255, 57344, v254
    ds_write_b128 v254, a[112:115] offset:28672
    ds_write_b128 v254, a[144:147] offset:32768
    ds_write_b128 v254, a[148:151] offset:36864
    ds_write_b128 v254, a[152:155] offset:40960
    ds_write_b128 v254, a[156:159] offset:45056
    s_waitcnt vmcnt(0)
    s_mov_b64 exec, 1
    s_cmp_lg_u32 s10, 0
    s_cbranch_scc1 Lslow_52
    buffer_store_dword v30, off, s[52:55], s56
Ljoin_53:
    s_mov_b64 exec, -1
    ds_write_b128 v254, a[160:163] offset:49152
    s_cmp_ge_u32 s6, 14
    s_cbranch_scc1 Lskipw_55
    buffer_load_dword v232, v18, s[52:55], s90 offen sc1
    ds_read_b64_tr_b16 v[144:145], v6 offset:12288
    ds_read_b64_tr_b16 v[146:147], v6 offset:12800
    ds_read_b64_tr_b16 v[148:149], v7 offset:12288
    ds_read_b64_tr_b16 v[150:151], v7 offset:12800
    ds_read_b64_tr_b16 v[152:153], v8 offset:12288
    ds_read_b64_tr_b16 v[154:155], v8 offset:12800
    ds_read_b64_tr_b16 v[156:157], v9 offset:12288
    ds_read_b64_tr_b16 v[158:159], v9 offset:12800
    ds_read_b64_tr_b16 v[160:161], v6 offset:16384
    ds_read_b64_tr_b16 v[162:163], v6 offset:16896
    ds_read_b64_tr_b16 v[164:165], v7 offset:16384
    ds_read_b64_tr_b16 v[166:167], v7 offset:16896
    ds_read_b64_tr_b16 v[168:169], v8 offset:16384
    ds_read_b64_tr_b16 v[170:171], v8 offset:16896
    ds_read_b64_tr_b16 v[172:173], v9 offset:16384
    ds_read_b64_tr_b16 v[174:175], v9 offset:16896
    ds_read_b64_tr_b16 v[176:177], v6 offset:20480
    ds_read_b64_tr_b16 v[178:179], v6 offset:20992
    ds_read_b64_tr_b16 v[180:181], v7 offset:20480
    ds_read_b64_tr_b16 v[182:183], v7 offset:20992
    ds_read_b64_tr_b16 v[184:185], v8 offset:20480
    ds_read_b64_tr_b16 v[186:187], v8 offset:20992
    ds_read_b64_tr_b16 v[188:189], v9 offset:20480
    ds_read_b64_tr_b16 v[190:191], v9 offset:20992
    ds_read_b64_tr_b16 v[192:193], v6 offset:24576
    ds_read_b64_tr_b16 v[194:195], v6 offset:25088
    ds_read_b64_tr_b16 v[196:197], v7 offset:24576
    ds_read_b64_tr_b16 v[198:199], v7 offset:25088
    ds_read_b64_tr_b16 v[200:201], v8 offset:24576
    ds_read_b64_tr_b16 v[202:203], v8 offset:25088
    ds_read_b64_tr_b16 v[204:205], v9 offset:24576
    ds_read_b64_tr_b16 v[206:207], v9 offset:25088
Lpoll_56:
    buffer_load_dword v233, v18, s[52:55], s90 offen sc1
    s_waitcnt vmcnt(1)
    v_cmp_ne_u32 vcc, s9, v232
    s_cbranch_vccz Ldone_57
    buffer_load_dword v232, v18, s[52:55], s90 offen sc1
    s_waitcnt vmcnt(1)
    v_cmp_ne_u32 vcc, s9, v233
    s_cbranch_vccz Ldone_57
    s_sub_u32 s11, s11, 1
    s_cbranch_scc0 Lpoll_56
    s_mov_b32 s11, 0
Ldone_57:
    buffer_load_dwordx4 a[0:3], v1, s[52:55], s91 offen offset:0 sc1
    buffer_load_dwordx4 a[4:7], v1, s[52:55], s91 offen offset:1024 sc1
    buffer_load_dwordx4 a[8:11], v1, s[52:55], s91 offen offset:2048 sc1
    buffer_load_dwordx4 a[12:15], v1, s[52:55], s91 offen offset:3072 sc1
    s_add_u32 s91, s91, 4096
    buffer_load_dwordx4 a[16:19], v1, s[52:55], s91 offen offset:0 sc1
    s_waitcnt vmcnt(4) lgkmcnt(15)
    v_mfma_f32_16x16x32_bf16 v[32:35], v[96:99], a[0:3], v[32:35]
    buffer_load_dwordx4 a[20:23], v1, s[52:55], s91 offen offset:1024 sc1
    ds_read_b64_tr_b16 v[208:209], v6 offset:28672
    ds_read_b64_tr_b16 v[210:211], v6 offset:29184
    v_mfma_f32_16x16x32_bf16 v[36:39], v[100:103], a[0:3], v[36:39]
    ds_read_b64_tr_b16 v[212:213], v7 offset:28672
    ds_read_b64_tr_b16 v[214:215], v7 offset:29184
    v_mfma_f32_16x16x32_bf16 v[40:43], v[104:107], a[0:3], v[40:43]
    ds_read_b64_tr_b16 v[216:217], v8 offset:28672
    ds_read_b64_tr_b16 v[218:219], v8 offset:29184
    v_mfma_f32_16x16x32_bf16 v[44:47], v[108:111], a[0:3], v[44:47]
    ds_read_b64_tr_b16 v[220:221], v9 offset:28672
    ds_read_b64_tr_b16 v[222:223], v9 offset:29184
    s_waitcnt vmcnt(4)
    v_mfma_f32_16x16x32_bf16 v[32:35], v[112:115], a[4:7], v[32:35]
    buffer_load_dwordx4 a[24:27], v1, s[52:55], s91 offen offset:2048 sc1
    ds_read_b64_tr_b16 v[96:97], v6 offset:32768
    ds_read_b64_tr_b16 v[98:99], v6 offset:33280
    v_mfma_f32_16x16x32_bf16 v[36:39], v[116:119], a[4:7], v[36:39]
    ds_read_b64_tr_b16 v[100:101], v7 offset:32768
    ds_read_b64_tr_b16 v[102:103], v7 offset:33280
    v_mfma_f32_16x16x32_bf16 v[40:43], v[120:123], a[4:7], v[40:43]
    ds_read_b64_tr_b16 v[104:105], v8 offset:32768
    ds_read_b64_tr_b16 v[106:107], v8 offset:33280
    v_mfma_f32_16x16x32_bf16 v[44:47], v[124:127], a[4:7], v[44:47]
    ds_read_b64_tr_b16 v[108:109], v9 offset:32768
    ds_read_b64_tr_b16 v[110:111], v9 offset:33280
    s_waitcnt vmcnt(4)
    v_mfma_f32_16x16x32_bf16 v[32:35], v[128:131], a[8:11], v[32:35]
    buffer_load_dwordx4 a[28:31], v1, s[52:55], s91 offen offset:3072 sc1
    ds_read_b64_tr_b16 v[112:113], v6 offset:36864
    ds_read_b64_tr_b16 v[114:115], v6 offset:37376
    v_mfma_f32_16x16x32_bf16 v[36:39], v[132:135], a[8:11], v[36:39]
    ds_read_b64_tr_b16 v[116:117], v7 offset:36864
    ds_read_b64_tr_b16 v[118:119], v7 offset:37376
    v_mfma_f32_16x16x32_bf16 v[40:43], v[136:139], a[8:11], v[40:43]
    ds_read_b64_tr_b16 v[120:121], v8 offset:36864
    ds_read_b64_tr_b16 v[122:123], v8 offset:37376
    v_mfma_f32_16x16x32_bf16 v[44:47], v[140:143], a[8:11], v[44:47]
    ds_read_b64_tr_b16 v[124:125], v9 offset:36864
    ds_read_b64_tr_b16 v[126:127], v9 offset:37376
    s_waitcnt vmcnt(4)
    v_mfma_f32_16x16x32_bf16 v[32:35], v[144:147], a[12:15], v[32:35]
    s_add_u32 s91, s91, 4096
    buffer_load_dwordx4 a[32:35], v1, s[52:55], s91 offen offset:0 sc1
    ds_read_b64_tr_b16 v[128:129], v6 offset:40960
    ds_read_b64_tr_b16 v[130:131], v6 offset:41472
    v_mfma_f32_16x16x32_bf16 v[36:39], v[148:151], a[12:15], v[36:39]
    ds_read_b64_tr_b16 v[132:133], v7 offset:40960
    ds_read_b64_tr_b16 v[134:135], v7 offset:41472
    v_mfma_f32_16x16x32_bf16 v[40:43], v[152:155], a[12:15], v[40:43]
    ds_read_b64_tr_b16 v[136:137], v8 offset:40960
    ds_read_b64_tr_b16 v[138:139], v8 offset:41472
    v_mfma_f32_16x16x32_bf16 v[44:47], v[156:159], a[12:15], v[44:47]
    ds_read_b64_tr_b16 v[140:141], v9 offset:40960
    ds_read_b64_tr_b16 v[142:143], v9 offset:41472
    s_waitcnt vmcnt(4)
    v_mfma_f32_16x16x32_bf16 v[32:35], v[160:163], a[16:19], v[32:35]
    buffer_load_dwordx4 a[36:39], v1, s[52:55], s91 offen offset:1024 sc1
    ds_read_b64_tr_b16 v[144:145], v6 offset:45056
    ds_read_b64_tr_b16 v[146:147], v6 offset:45568
    v_mfma_f32_16x16x32_bf16 v[36:39], v[164:167], a[16:19], v[36:39]
    ds_read_b64_tr_b16 v[148:149], v7 offset:45056
    ds_read_b64_tr_b16 v[150:151], v7 offset:45568
    v_mfma_f32_16x16x32_bf16 v[40:43], v[168:171], a[16:19], v[40:43]
    ds_read_b64_tr_b16 v[152:153], v8 offset:45056
    ds_read_b64_tr_b16 v[154:155], v8 offset:45568
    v_mfma_f32_16x16x32_bf16 v[44:47], v[172:175], a[16:19], v[44:47]
    ds_read_b64_tr_b16 v[156:157], v9 offset:45056
    ds_read_b64_tr_b16 v[158:159], v9 offset:45568
    s_waitcnt vmcnt(4) lgkmcnt(15)
    v_mfma_f32_16x16x32_bf16 v[32:35], v[176:179], a[20:23], v[32:35]
    buffer_load_dwordx4 a[40:43], v1, s[52:55], s91 offen offset:2048 sc1
    ds_read_b64_tr_b16 v[160:161], v6 offset:49152
    ds_read_b64_tr_b16 v[162:163], v6 offset:49664
    v_mfma_f32_16x16x32_bf16 v[36:39], v[180:183], a[20:23], v[36:39]
    ds_read_b64_tr_b16 v[164:165], v7 offset:49152
    ds_read_b64_tr_b16 v[166:167], v7 offset:49664
    v_mfma_f32_16x16x32_bf16 v[40:43], v[184:187], a[20:23], v[40:43]
    ds_read_b64_tr_b16 v[168:169], v8 offset:49152
    ds_read_b64_tr_b16 v[170:171], v8 offset:49664
    v_mfma_f32_16x16x32_bf16 v[44:47], v[188:191], a[20:23], v[44:47]
    ds_read_b64_tr_b16 v[172:173], v9 offset:49152
    ds_read_b64_tr_b16 v[174:175], v9 offset:49664
    s_waitcnt vmcnt(4)
    v_mfma_f32_16x16x32_bf16 v[32:35], v[192:195], a[24:27], v[32:35]
    buffer_load_dwordx4 a[44:47], v1, s[52:55], s91 offen offset:3072 sc1
    ds_read_b64_tr_b16 v[176:177], v6 offset:53248
    ds_read_b64_tr_b16 v[178:179], v6 offset:53760
    v_mfma_f32_16x16x32_bf16 v[36:39], v[196:199], a[24:27], v[36:39]
    ds_read_b64_tr_b16 v[180:181], v7 offset:53248
    ds_read_b64_tr_b16 v[182:183], v7 offset:53760
    v_mfma_f32_16x16x32_bf16 v[40:43], v[200:203], a[24:27], v[40:43]
    ds_read_b64_tr_b16 v[184:185], v8 offset:53248
    ds_read_b64_tr_b16 v[186:187], v8 offset:53760
    v_mfma_f32_16x16x32_bf16 v[44:47], v[204:207], a[24:27], v[44:47]
    ds_read_b64_tr_b16 v[188:189], v9 offset:53248
    ds_read_b64_tr_b16 v[190:191], v9 offset:53760
    s_waitcnt vmcnt(4)
    v_mfma_f32_16x16x32_bf16 v[32:35], v[208:211], a[28:31], v[32:35]
    s_add_u32 s91, s91, 4096
    buffer_load_dwordx4 a[48:51], v1, s[52:55], s91 offen offset:0 sc1
    v_mfma_f32_16x16x32_bf16 v[36:39], v[212:215], a[28:31], v[36:39]
    ds_write_b128 v254, a[164:167] offset:53248
    v_mfma_f32_16x16x32_bf16 v[40:43], v[216:219], a[28:31], v[40:43]
    v_mfma_f32_16x16x32_bf16 v[44:47], v[220:223], a[28:31], v[44:47]
    ds_write_b128 v255, a[168:171] offset:0
    s_waitcnt vmcnt(4)
    v_mfma_f32_16x16x32_bf16 v[32:35], v[96:99], a[32:35], v[32:35]
    buffer_load_dwordx4 a[52:55], v1, s[52:55], s91 offen offset:1024 sc1
    v_mfma_f32_16x16x32_bf16 v[36:39], v[100:103], a[32:35], v[36:39]
    ds_write_b128 v255, a[172:175] offset:4096
    v_mfma_f32_16x16x32_bf16 v[40:43], v[104:107], a[32:35], v[40:43]
    v_mfma_f32_16x16x32_bf16 v[44:47], v[108:111], a[32:35], v[44:47]
    ds_write_b128 v255, a[176:179] offset:8192
    s_waitcnt vmcnt(4)
    v_mfma_f32_16x16x32_bf16 v[32:35], v[112:115], a[36:39], v[32:35]
    v_mfma_f32_16x16x32_bf16 v[36:39], v[116:119], a[36:39], v[36:39]
    ds_write_b128 v255, a[180:183] offset:12288
    v_mfma_f32_16x16x32_bf16 v[40:43], v[120:123], a[36:39], v[40:43]
    v_mfma_f32_16x16x32_bf16 v[44:47], v[124:127], a[36:39], v[44:47]
    ds_write_b128 v255, a[184:187] offset:16384
    s_waitcnt vmcnt(3) lgkmcnt(15)
    v_mfma_f32_16x16x32_bf16 v[32:35], v[128:131], a[40:43], v[32:35]
    v_mfma_f32_16x16x32_bf16 v[36:39], v[132:135], a[40:43], v[36:39]
    ds_write_b128 v255, a[188:191] offset:20480
    v_mfma_f32_16x16x32_bf16 v[40:43], v[136:139], a[40:43], v[40:43]
    v_mfma_f32_16x16x32_bf16 v[44:47], v[140:143], a[40:43], v[44:47]
    ds_write_b128 v255, a[192:195] offset:24576
    s_waitcnt vmcnt(2)
    v_mfma_f32_16x16x32_bf16 v[32:35], v[144:147], a[44:47], v[32:35]
    v_mfma_f32_16x16x32_bf16 v[36:39], v[148:151], a[44:47], v[36:39]
    v_mfma_f32_16x16x32_bf16 v[40:43], v[152:155], a[44:47], v[40:43]
    v_mfma_f32_16x16x32_bf16 v[44:47], v[156:159], a[44:47], v[44:47]
    s_waitcnt vmcnt(1) lgkmcnt(15)
    v_mfma_f32_16x16x32_bf16 v[32:35], v[160:163], a[48:51], v[32:35]
    v_mfma_f32_16x16x32_bf16 v[36:39], v[164:167], a[48:51], v[36:39]
    v_mfma_f32_16x16x32_bf16 v[40:43], v[168:171], a[48:51], v[40:43]
    v_mfma_f32_16x16x32_bf16 v[44:47], v[172:175], a[48:51], v[44:47]
    s_waitcnt vmcnt(0) lgkmcnt(8)
    v_mfma_f32_16x16x32_bf16 v[32:35], v[176:179], a[52:55], v[32:35]
    v_mfma_f32_16x16x32_bf16 v[36:39], v[180:183], a[52:55], v[36:39]
    v_mfma_f32_16x16x32_bf16 v[40:43], v[184:187], a[52:55], v[40:43]
    v_mfma_f32_16x16x32_bf16 v[44:47], v[188:191], a[52:55], v[44:47]
    s_nop 4
    v_cvt_pk_bf16_f32 v144, v32, v33
    v_cvt_pk_bf16_f32 v145, v34, v35
    v_cvt_pk_bf16_f32 v146, v36, v37
    v_cvt_pk_bf16_f32 v147, v38, v39
    v_cvt_pk_bf16_f32 v148, v40, v41
    v_cvt_pk_bf16_f32 v149, v42, v43
    v_cvt_pk_bf16_f32 v150, v44, v45
    v_cvt_pk_bf16_f32 v151, v46, v47
    v_permlane16_swap_b32 v144, v146
    v_permlane16_swap_b32 v145, v147
    v_permlane16_swap_b32 v148, v150
    v_permlane16_swap_b32 v149, v151
    s_cmp_lg_u32 s10, 0
    s_cbranch_scc1 Lslow_58
    buffer_store_dwordx4 v[144:147], v14, s[48:51], 0 offen
    buffer_store_dwordx4 v[148:151], v14, s[48:51], s88 offen
Ljoin_59:
    v_pk_add_f32 v[232:233], v[32:33], v[34:35]
    v_pk_mul_f32 v[234:235], v[32:33], v[32:33]
    v_pk_fma_f32 v[234:235], v[34:35], v[34:35], v[234:235]
    v_pk_add_f32 v[232:233], v[232:233], v[36:37]
    v_pk_fma_f32 v[234:235], v[36:37], v[36:37], v[234:235]
    v_pk_add_f32 v[232:233], v[232:233], v[38:39]
    v_pk_fma_f32 v[234:235], v[38:39], v[38:39], v[234:235]
    v_pk_add_f32 v[232:233], v[232:233], v[40:41]
    v_pk_fma_f32 v[234:235], v[40:41], v[40:41], v[234:235]
    v_pk_add_f32 v[232:233], v[232:233], v[42:43]
    v_pk_fma_f32 v[234:235], v[42:43], v[42:43], v[234:235]
    v_pk_add_f32 v[232:233], v[232:233], v[44:45]
    v_pk_fma_f32 v[234:235], v[44:45], v[44:45], v[234:235]
    v_pk_add_f32 v[232:233], v[232:233], v[46:47]
    v_pk_fma_f32 v[234:235], v[46:47], v[46:47], v[234:235]
    v_add_f32_e64 v232, v232, v233
    v_add_f32 v234, v234, v235
    s_lshl_b32 s14, s8, 13
    s_add_u32 s14, s14, 393216
    v_permlane32_swap_b32 v232, v234
    v_add_f32 v232, v232, v234
    v_mov_b32_e64 v234, v232
    s_nop 1
    v_permlane16_swap_b32 v232, v234
    v_add_f32 v232, v232, v234
    s_cmp_lg_u32 s10, 0
    s_cbranch_scc1 Lslow_60
    buffer_store_dword v232, v15, s[52:55], s14 offen
Ljoin_61:
    s_lshl_b32 s13, s8, 2
    s_add_u32 s13, s13, s23
    s_lshl_b32 s13, s13, 7
    s_lshl_b32 s14, s57, 1
    s_and_b32 s15, s7, 1
    s_add_u32 s14, s14, s15
    s_lshl_b32 s14, s14, 2
    s_add_u32 s13, s13, s14
    s_add_u32 s13, s13, 57344
    ds_write_b128 v254, a[196:199] offset:0
    ds_write_b128 v254, a[116:119] offset:4096
    ds_write_b128 v254, a[120:123] offset:8192
    ds_write_b128 v254, a[124:127] offset:12288
    ds_write_b128 v254, a[128:131] offset:16384
    ds_write_b128 v254, a[132:135] offset:20480
    ds_write_b128 v254, a[136:139] offset:24576
    s_waitcnt vmcnt(0)
    s_mov_b64 exec, 1
    s_cmp_lg_u32 s10, 0
    s_cbranch_scc1 Lslow_62
    buffer_store_dword v30, off, s[52:55], s13
Ljoin_63:
    s_mov_b64 exec, -1
Lskip_54:
    v_add_u32 v88, 86016, v88
    v_add_u32 v89, 86016, v89
    v_add_u32 v90, 86016, v90
    v_add_u32 v91, 86016, v91
    s_lshl_b32 s13, s8, 2
    s_add_u32 s13, s13, s7
    s_lshl_b32 s13, s13, 7
    s_add_u32 s13, s13, 57344
    s_mul_i32 s56, s8, 114688
    s_mul_i32 s14, s7, 28672
    s_add_u32 s56, s56, s14
    s_add_u32 s56, s56, 12582912
    s_lshl_b32 s14, s8, 13
    s_add_u32 s14, s14, 393216
    buffer_load_dword v232, v19, s[52:55], s13 offen sc1
Lpoll_64:
    buffer_load_dword v233, v19, s[52:55], s13 offen sc1
    s_waitcnt vmcnt(1)
    v_cmp_ne_u32 vcc, s9, v232
    s_cbranch_vccz Ldone_65
    buffer_load_dword v232, v19, s[52:55], s13 offen sc1
    s_waitcnt vmcnt(1)
    v_cmp_ne_u32 vcc, s9, v233
    s_cbranch_vccz Ldone_65
    s_sub_u32 s11, s11, 1
    s_cbranch_scc0 Lpoll_64
    s_mov_b32 s11, 0
Ldone_65:
    buffer_load_dwordx4 a[0:3], v29, s[48:51], s84 offen offset:0 sc1
    buffer_load_dwordx4 a[4:7], v29, s[48:51], s85 offen offset:0 sc1
    buffer_load_dwordx4 a[8:11], v29, s[48:51], s86 offen offset:0 sc1
    buffer_load_dwordx4 a[12:15], v29, s[48:51], s87 offen offset:0 sc1
    buffer_load_dwordx4 a[16:19], v29, s[48:51], s84 offen offset:128 sc1
    s_waitcnt lgkmcnt(0)
    s_barrier
    ds_read_b64_tr_b16 a[200:201], v2 offset:28672
    ds_read_b64_tr_b16 a[202:203], v2 offset:28928
    ds_read_b64_tr_b16 a[204:205], v3 offset:0
    ds_read_b64_tr_b16 a[206:207], v3 offset:256
    ds_read_b64_tr_b16 a[208:209], v2 offset:29696
    ds_read_b64_tr_b16 a[210:211], v2 offset:29952
    ds_read_b64_tr_b16 a[212:213], v3 offset:1024
    ds_read_b64_tr_b16 a[214:215], v3 offset:1280
    s_waitcnt vmcnt(4) lgkmcnt(4)
    v_mfma_f32_32x32x16_bf16 v[112:127], a[200:203], a[0:3], 0
    buffer_load_dwordx2 v[200:201], v16, s[52:55], s14 offen offset:0 sc1
    buffer_load_dwordx2 v[202:203], v16, s[52:55], s14 offen offset:512 sc1
    ds_read_b64_tr_b16 a[216:217], v2 offset:30720
    ds_read_b64_tr_b16 a[218:219], v2 offset:30976
    ds_read_b128 v[184:187], v27 offset:512
    ds_read_b128 v[188:191], v27 offset:544
    v_mfma_f32_32x32x16_bf16 v[128:143], a[0:3], a[204:207], 0
    buffer_load_dwordx4 a[20:23], v29, s[48:51], s85 offen offset:128 sc1
    ds_read_b64_tr_b16 a[220:221], v3 offset:2048
    ds_read_b64_tr_b16 a[222:223], v3 offset:2304
    ds_read_b128 v[192:195], v27 offset:576
    s_waitcnt vmcnt(6) lgkmcnt(7)
    v_mfma_f32_32x32x16_bf16 v[112:127], a[208:211], a[4:7], v[112:127]
    buffer_load_dwordx2 v[204:205], v16, s[52:55], s14 offen offset:1024 sc1
    buffer_load_dwordx2 v[206:207], v17, s[52:55], s14 offen offset:1536 sc1
    ds_read_b64_tr_b16 a[200:201], v2 offset:31744
    ds_read_b64_tr_b16 a[202:203], v2 offset:32000
    ds_read_b128 v[196:199], v27 offset:608
    v_mfma_f32_32x32x16_bf16 v[128:143], a[4:7], a[212:215], v[128:143]
    buffer_load_dwordx4 a[24:27], v29, s[48:51], s86 offen offset:128 sc1
    ds_read_b64_tr_b16 a[204:205], v3 offset:3072
    ds_read_b64_tr_b16 a[206:207], v3 offset:3328
    ds_read_b32 v239, v28 offset:384
    s_waitcnt vmcnt(8) lgkmcnt(7)
    v_mfma_f32_32x32x16_bf16 v[112:127], a[216:219], a[8:11], v[112:127]
    buffer_load_dwordx4 a[28:31], v29, s[48:51], s87 offen offset:128 sc1
    ds_read_b64_tr_b16 a[208:209], v2 offset:32768
    ds_read_b64_tr_b16 a[210:211], v2 offset:33024
    v_mfma_f32_32x32x16_bf16 v[128:143], a[8:11], a[220:223], v[128:143]
    buffer_load_dwordx4 a[32:35], v29, s[48:51], s84 offen offset:256 sc1
    ds_read_b64_tr_b16 a[212:213], v3 offset:4096
    ds_read_b64_tr_b16 a[214:215], v3 offset:4352
    s_waitcnt vmcnt(9) lgkmcnt(5)
    v_mfma_f32_32x32x16_bf16 v[112:127], a[200:203], a[12:15], v[112:127]
    buffer_load_dwordx4 a[36:39], v29, s[48:51], s85 offen offset:256 sc1
    ds_read_b64_tr_b16 a[216:217], v2 offset:33792
    ds_read_b64_tr_b16 a[218:219], v2 offset:34048
    v_mfma_f32_32x32x16_bf16 v[128:143], a[12:15], a[204:207], v[128:143]
    ds_read_b64_tr_b16 a[220:221], v3 offset:5120
    ds_read_b64_tr_b16 a[222:223], v3 offset:5376
    s_waitcnt vmcnt(9) lgkmcnt(4)
    v_mfma_f32_32x32x16_bf16 v[112:127], a[208:211], a[16:19], v[112:127]
    buffer_load_dwordx4 a[40:43], v29, s[48:51], s86 offen offset:256 sc1
    ds_read_b64_tr_b16 a[200:201], v2 offset:34816
    ds_read_b64_tr_b16 a[202:203], v2 offset:35072
    v_mfma_f32_32x32x16_bf16 v[128:143], a[16:19], a[212:215], v[128:143]
    buffer_load_dwordx4 a[44:47], v29, s[48:51], s87 offen offset:256 sc1
    ds_read_b64_tr_b16 a[204:205], v3 offset:6144
    ds_read_b64_tr_b16 a[206:207], v3 offset:6400
    s_waitcnt vmcnt(8) lgkmcnt(4)
    v_mfma_f32_32x32x16_bf16 v[112:127], a[216:219], a[20:23], v[112:127]
    buffer_load_dwordx4 a[48:51], v29, s[48:51], s84 offen offset:384 sc1
    ds_read_b64_tr_b16 a[208:209], v2 offset:35840
    ds_read_b64_tr_b16 a[210:211], v2 offset:36096
    v_add_f32 v242, v200, v202
    v_add_f32 v243, v201, v203
    v_mfma_f32_32x32x16_bf16 v[128:143], a[20:23], a[220:223], v[128:143]
    ds_read_b64_tr_b16 a[212:213], v3 offset:7168
    ds_read_b64_tr_b16 a[214:215], v3 offset:7424
    s_waitcnt vmcnt(7)
    v_add_f32 v204, v204, v206
    v_add_f32 v205, v205, v207
    s_waitcnt vmcnt(6) lgkmcnt(4)
    v_mfma_f32_32x32x16_bf16 v[112:127], a[200:203], a[24:27], v[112:127]
    buffer_load_dwordx4 a[52:55], v29, s[48:51], s85 offen offset:384 sc1
    ds_read_b64_tr_b16 a[216:217], v2 offset:36864
    ds_read_b64_tr_b16 a[218:219], v2 offset:37120
    v_add_f32 v242, v242, v204
    v_add_f32 v243, v243, v205
    v_mfma_f32_32x32x16_bf16 v[128:143], a[24:27], a[204:207], v[128:143]
    buffer_load_dwordx4 a[56:59], v29, s[48:51], s86 offen offset:384 sc1
    ds_read_b64_tr_b16 a[220:221], v3 offset:8192
    ds_read_b64_tr_b16 a[222:223], v3 offset:8448
    v_mov_b32_e64 v232, v242
    v_mov_b32 v233, v243
    s_waitcnt vmcnt(7) lgkmcnt(4)
    v_mfma_f32_32x32x16_bf16 v[112:127], a[208:211], a[28:31], v[112:127]
    buffer_load_dwordx4 a[60:63], v29, s[48:51], s87 offen offset:384 sc1
    ds_read_b64_tr_b16 a[200:201], v2 offset:37888
    ds_read_b64_tr_b16 a[202:203], v2 offset:38144
    v_permlane32_swap_b32 v242, v232
    v_permlane32_swap_b32 v243, v233
    v_mfma_f32_32x32x16_bf16 v[128:143], a[28:31], a[212:215], v[128:143]
    ds_read_b64_tr_b16 a[204:205], v3 offset:9216
    ds_read_b64_tr_b16 a[206:207], v3 offset:9472
    v_add_f32_e64 v242, v242, v232
    v_add_f32 v243, v243, v233
    s_waitcnt vmcnt(7) lgkmcnt(4)
    v_mfma_f32_32x32x16_bf16 v[112:127], a[216:219], a[32:35], v[112:127]
    buffer_load_dwordx4 a[64:67], v29, s[48:51], s84 offen offset:512 sc1
    ds_read_b64_tr_b16 a[208:209], v2 offset:38912
    ds_read_b64_tr_b16 a[210:211], v2 offset:39168
    v_mul_f32 v242, 0x3b124925, v242
    v_mul_f32 v243, 0x3b124925, v243
    v_mfma_f32_32x32x16_bf16 v[128:143], a[32:35], a[220:223], v[128:143]
    ds_read_b64_tr_b16 a[212:213], v3 offset:10240
    ds_read_b64_tr_b16 a[214:215], v3 offset:10496
    v_fma_f32 v243, -v242, v242, v243
    v_max_f32 v243, 0, v243
    s_waitcnt vmcnt(7) lgkmcnt(4)
    v_mfma_f32_32x32x16_bf16 v[112:127], a[200:203], a[36:39], v[112:127]
    buffer_load_dwordx4 a[68:71], v29, s[48:51], s85 offen offset:512 sc1
    ds_read_b64_tr_b16 a[216:217], v2 offset:39936
    ds_read_b64_tr_b16 a[218:219], v2 offset:40192
    v_add_f32 v243, 0x3727c5ac, v243
    v_mfma_f32_32x32x16_bf16 v[128:143], a[36:39], a[204:207], v[128:143]
    ds_read_b64_tr_b16 a[220:221], v3 offset:11264
    ds_read_b64_tr_b16 a[222:223], v3 offset:11520
    v_rsq_f32 v234, v243
    s_waitcnt vmcnt(7) lgkmcnt(4)
    v_mfma_f32_32x32x16_bf16 v[112:127], a[208:211], a[40:43], v[112:127]
    buffer_load_dwordx4 a[72:75], v29, s[48:51], s86 offen offset:512 sc1
    ds_read_b64_tr_b16 a[200:201], v2 offset:40960
    ds_read_b64_tr_b16 a[202:203], v2 offset:41216
    v_mul_f32_e64 v235, v234, v242
    v_cndmask_b32_e64 v232, v234, v235, s[62:63]
    v_mfma_f32_32x32x16_bf16 v[128:143], a[40:43], a[212:215], v[128:143]
    ds_read_b64_tr_b16 a[204:205], v3 offset:12288
    ds_read_b64_tr_b16 a[206:207], v3 offset:12544
    ds_write_b32 v25, v232
    s_waitcnt vmcnt(7) lgkmcnt(5)
    v_mfma_f32_32x32x16_bf16 v[112:127], a[216:219], a[44:47], v[112:127]
    buffer_load_dwordx4 a[76:79], v29, s[48:51], s87 offen offset:512 sc1
    ds_read_b64_tr_b16 a[208:209], v2 offset:41984
    ds_read_b64_tr_b16 a[210:211], v2 offset:42240
    ds_read_b128 v[200:203], v26 offset:0
    ds_read_b128 v[204:207], v26 offset:32
    v_mfma_f32_32x32x16_bf16 v[128:143], a[44:47], a[220:223], v[128:143]
    ds_read_b64_tr_b16 a[212:213], v3 offset:13312
    ds_read_b64_tr_b16 a[214:215], v3 offset:13568
    ds_read_b128 v[208:211], v26 offset:64
    ds_read_b128 v[212:215], v26 offset:96
    s_waitcnt vmcnt(7) lgkmcnt(9)
    v_mfma_f32_32x32x16_bf16 v[112:127], a[200:203], a[48:51], v[112:127]
    buffer_load_dwordx4 a[80:83], v29, s[48:51], s84 offen offset:640 sc1
    ds_read_b64_tr_b16 a[216:217], v2 offset:43008
    ds_read_b64_tr_b16 a[218:219], v2 offset:43264
    ds_read_b128 v[216:219], v26 offset:128
    ds_read_b128 v[220:223], v26 offset:160
    v_mfma_f32_32x32x16_bf16 v[128:143], a[48:51], a[204:207], v[128:143]
    ds_read_b64_tr_b16 a[220:221], v3 offset:14336
    ds_read_b64_tr_b16 a[222:223], v3 offset:14592
    ds_read_b128 v[224:227], v26 offset:192
    ds_read_b128 v[228:231], v26 offset:224
    s_waitcnt vmcnt(7) lgkmcnt(10)
    v_mfma_f32_32x32x16_bf16 v[112:127], a[208:211], a[52:55], v[112:127]
    buffer_load_dwordx4 a[84:87], v29, s[48:51], s85 offen offset:640 sc1
    ds_read_b64_tr_b16 a[200:201], v2 offset:44032
    ds_read_b64_tr_b16 a[202:203], v2 offset:44288
    v_mul_f32 v184, v235, v184
    v_mul_f32_e64 v185, v235, v185
    v_mfma_f32_32x32x16_bf16 v[128:143], a[52:55], a[212:215], v[128:143]
    ds_read_b64_tr_b16 a[204:205], v3 offset:15360
    ds_read_b64_tr_b16 a[206:207], v3 offset:15616
    v_mul_f32_e64 v186, v235, v186
    s_barrier
    s_waitcnt vmcnt(7) lgkmcnt(6)
    v_mfma_f32_32x32x16_bf16 v[112:127], a[216:219], a[56:59], v[112:127]
    buffer_load_dwordx4 a[88:91], v29, s[48:51], s86 offen offset:640 sc1
    ds_read_b64_tr_b16 a[208:209], v2 offset:45056
    ds_read_b64_tr_b16 a[210:211], v2 offset:45312
    v_mul_f32 v187, v235, v187
    v_mul_f32 v188, v235, v188
    v_mfma_f32_32x32x16_bf16 v[128:143], a[56:59], a[220:223], v[128:143]
    ds_read_b64_tr_b16 a[212:213], v3 offset:16384
    ds_read_b64_tr_b16 a[214:215], v3 offset:16640
    v_mul_f32 v189, v235, v189
    s_waitcnt vmcnt(7) lgkmcnt(4)
    v_mfma_f32_32x32x16_bf16 v[112:127], a[200:203], a[60:63], v[112:127]
    buffer_load_dwordx4 a[92:95], v29, s[48:51], s87 offen offset:640 sc1
    ds_read_b64_tr_b16 a[216:217], v2 offset:46080
    ds_read_b64_tr_b16 a[218:219], v2 offset:46336
    v_mul_f32 v190, v235, v190
    v_mul_f32 v191, v235, v191
    v_mfma_f32_32x32x16_bf16 v[128:143], a[60:63], a[204:207], v[128:143]
    ds_read_b64_tr_b16 a[220:221], v3 offset:17408
    ds_read_b64_tr_b16 a[222:223], v3 offset:17664
    v_mul_f32 v192, v235, v192
    s_waitcnt vmcnt(7) lgkmcnt(4)
    v_mfma_f32_32x32x16_bf16 v[112:127], a[208:211], a[64:67], v[112:127]
    buffer_load_dwordx4 a[96:99], v29, s[48:51], s84 offen offset:768 sc1
    ds_read_b64_tr_b16 a[200:201], v2 offset:47104
    ds_read_b64_tr_b16 a[202:203], v2 offset:47360
    v_mul_f32 v193, v235, v193
    v_mul_f32 v194, v235, v194
    v_mfma_f32_32x32x16_bf16 v[128:143], a[64:67], a[212:215], v[128:143]
    ds_read_b64_tr_b16 a[204:205], v3 offset:18432
    ds_read_b64_tr_b16 a[206:207], v3 offset:18688
    v_mul_f32 v195, v235, v195
    s_waitcnt vmcnt(7) lgkmcnt(4)
    v_mfma_f32_32x32x16_bf16 v[112:127], a[216:219], a[68:71], v[112:127]
    buffer_load_dwordx4 a[100:103], v29, s[48:51], s85 offen offset:768 sc1
    ds_read_b64_tr_b16 a[208:209], v2 offset:48128
    ds_read_b64_tr_b16 a[210:211], v2 offset:48384
    v_mul_f32 v196, v235, v196
    v_mul_f32 v197, v235, v197
    v_mfma_f32_32x32x16_bf16 v[128:143], a[68:71], a[220:223], v[128:143]
    ds_read_b64_tr_b16 a[212:213], v3 offset:19456
    ds_read_b64_tr_b16 a[214:215], v3 offset:19712
    v_mul_f32 v198, v235, v198
    s_waitcnt vmcnt(7) lgkmcnt(4)
    v_mfma_f32_32x32x16_bf16 v[112:127], a[200:203], a[72:75], v[112:127]
    buffer_load_dwordx4 a[104:107], v29, s[48:51], s86 offen offset:768 sc1
    ds_read_b64_tr_b16 a[216:217], v2 offset:49152
    ds_read_b64_tr_b16 a[218:219], v2 offset:49408
    v_mul_f32 v199, v235, v199
    v_mul_f32 v216, v239, v216
    v_mfma_f32_32x32x16_bf16 v[128:143], a[72:75], a[204:207], v[128:143]
    ds_read_b64_tr_b16 a[220:221], v3 offset:20480
    ds_read_b64_tr_b16 a[222:223], v3 offset:20736
    v_mul_f32 v217, v239, v217
    s_waitcnt vmcnt(7) lgkmcnt(4)
    v_mfma_f32_32x32x16_bf16 v[112:127], a[208:211], a[76:79], v[112:127]
    buffer_load_dwordx4 a[108:111], v29, s[48:51], s87 offen offset:768 sc1
    ds_read_b64_tr_b16 a[200:201], v2 offset:50176
    ds_read_b64_tr_b16 a[202:203], v2 offset:50432
    v_mul_f32 v218, v239, v218
    v_mul_f32 v219, v239, v219
    v_mfma_f32_32x32x16_bf16 v[128:143], a[76:79], a[212:215], v[128:143]
    ds_read_b64_tr_b16 a[204:205], v3 offset:21504
    ds_read_b64_tr_b16 a[206:207], v3 offset:21760
    v_mul_f32 v220, v239, v220
    s_waitcnt vmcnt(7) lgkmcnt(4)
    v_mfma_f32_32x32x16_bf16 v[112:127], a[216:219], a[80:83], v[112:127]
    s_add_u32 m0, s58, 0
    s_add_u32 s69, s68, 0
    buffer_load_dwordx4 v20, s[44:47], s69 offen lds
    ds_read_b64_tr_b16 a[208:209], v2 offset:51200
    ds_read_b64_tr_b16 a[210:211], v2 offset:51456
    v_mul_f32 v221, v239, v221
    v_mul_f32 v222, v239, v222
    v_mfma_f32_32x32x16_bf16 v[128:143], a[80:83], a[220:223], v[128:143]
    s_add_u32 m0, s58, 1024
    s_add_u32 s69, s68, 7168
    buffer_load_dwordx4 v21, s[44:47], s69 offen lds
    ds_read_b64_tr_b16 a[212:213], v3 offset:22528
    ds_read_b64_tr_b16 a[214:215], v3 offset:22784
    v_mul_f32 v223, v239, v223
    s_waitcnt vmcnt(8) lgkmcnt(4)
    v_mfma_f32_32x32x16_bf16 v[112:127], a[200:203], a[84:87], v[112:127]
    s_add_u32 m0, s58, 2048
    s_add_u32 s69, s68, 14336
    buffer_load_dwordx4 v20, s[44:47], s69 offen lds
    ds_read_b64_tr_b16 a[216:217], v2 offset:52224
    ds_read_b64_tr_b16 a[218:219], v2 offset:52480
    v_mul_f32 v224, v239, v224
    v_mul_f32 v225, v239, v225
    v_mfma_f32_32x32x16_bf16 v[128:143], a[84:87], a[204:207], v[128:143]
    s_add_u32 m0, s58, 3072
    s_add_u32 s69, s68, 21504
    buffer_load_dwordx4 v21, s[44:47], s69 offen lds
    ds_read_b64_tr_b16 a[220:221], v3 offset:23552
    ds_read_b64_tr_b16 a[222:223], v3 offset:23808
    v_mul_f32 v226, v239, v226
    s_waitcnt vmcnt(9) lgkmcnt(4)
    v_mfma_f32_32x32x16_bf16 v[112:127], a[208:211], a[88:91], v[112:127]
    s_add_u32 m0, s58, 4096
    s_add_u32 s69, s68, 28672
    buffer_load_dwordx4 v20, s[44:47], s69 offen lds
    ds_read_b64_tr_b16 a[200:201], v2 offset:53248
    ds_read_b64_tr_b16 a[202:203], v2 offset:53504
    v_mul_f32 v227, v239, v227
    v_mul_f32 v228, v239, v228
    v_mfma_f32_32x32x16_bf16 v[128:143], a[88:91], a[212:215], v[128:143]
    s_add_u32 m0, s58, 5120
    s_add_u32 s69, s68, 35840
    buffer_load_dwordx4 v21, s[44:47], s69 offen lds
    ds_read_b64_tr_b16 a[204:205], v3 offset:24576
    ds_read_b64_tr_b16 a[206:207], v3 offset:24832
    v_mul_f32 v229, v239, v229
    s_waitcnt vmcnt(10) lgkmcnt(4)
    v_mfma_f32_32x32x16_bf16 v[112:127], a[216:219], a[92:95], v[112:127]
    s_add_u32 m0, s58, 6144
    s_add_u32 s69, s68, 43008
    buffer_load_dwordx4 v20, s[44:47], s69 offen lds
    ds_read_b64_tr_b16 a[208:209], v2 offset:54272
    ds_read_b64_tr_b16 a[210:211], v2 offset:54528
    v_mul_f32_e64 v230, v239, v230
    v_mfma_f32_32x32x16_bf16 v[128:143], a[92:95], a[220:223], v[128:143]
    ds_read_b64_tr_b16 a[212:213], v3 offset:25600
    ds_read_b64_tr_b16 a[214:215], v3 offset:25856
    v_mul_f32 v231, v239, v231
    s_waitcnt vmcnt(10) lgkmcnt(4)
    v_mfma_f32_32x32x16_bf16 v[112:127], a[200:203], a[96:99], v[112:127]
    s_add_u32 m0, s58, 7168
    s_add_u32 s69, s68, 50176
    buffer_load_dwordx4 v21, s[44:47], s69 offen lds
    ds_read_b64_tr_b16 a[216:217], v2 offset:55296
    ds_read_b64_tr_b16 a[218:219], v2 offset:55552
    v_mfma_f32_32x32x16_bf16 v[128:143], a[96:99], a[204:207], v[128:143]
    s_add_u32 m0, s58, 8192
    s_add_u32 s69, s68, 57344
    buffer_load_dwordx4 v20, s[44:47], s69 offen lds
    ds_read_b64_tr_b16 a[220:221], v3 offset:26624
    ds_read_b64_tr_b16 a[222:223], v3 offset:26880
    s_waitcnt vmcnt(11) lgkmcnt(4)
    v_mfma_f32_32x32x16_bf16 v[112:127], a[208:211], a[100:103], v[112:127]
    s_add_u32 m0, s58, 9216
    s_add_u32 s69, s68, 64512
    buffer_load_dwordx4 v21, s[44:47], s69 offen lds
    ds_read_b64_tr_b16 a[200:201], v2 offset:56320
    ds_read_b64_tr_b16 a[202:203], v2 offset:56576
    v_mfma_f32_32x32x16_bf16 v[128:143], a[100:103], a[212:215], v[128:143]
    s_add_u32 m0, s58, 10240
    s_add_u32 s69, s68, 71680
    buffer_load_dwordx4 v20, s[44:47], s69 offen lds
    ds_read_b64_tr_b16 a[204:205], v3 offset:27648
    ds_read_b64_tr_b16 a[206:207], v3 offset:27904
    s_waitcnt vmcnt(12) lgkmcnt(4)
    v_mfma_f32_32x32x16_bf16 v[112:127], a[216:219], a[104:107], v[112:127]
    s_add_u32 m0, s58, 11264
    s_add_u32 s69, s68, 78848
    buffer_load_dwordx4 v21, s[44:47], s69 offen lds
    v_mfma_f32_32x32x16_bf16 v[128:143], a[104:107], a[220:223], v[128:143]
    s_add_u32 m0, s58, 12288
    s_add_u32 s69, s68, 86016
    buffer_load_dwordx4 v20, s[44:47], s69 offen lds
    s_waitcnt vmcnt(13) lgkmcnt(0)
    v_mfma_f32_32x32x16_bf16 v[112:127], a[200:203], a[108:111], v[112:127]
    s_add_u32 m0, s58, 13312
    s_add_u32 s69, s68, 93184
    buffer_load_dwordx4 v21, s[44:47], s69 offen lds
    v_mfma_f32_32x32x16_bf16 v[128:143], a[108:111], a[204:207], v[128:143]
    s_nop 7
    v_pk_fma_f32 v[112:113], v[112:113], v[234:235], v[184:185] op_sel_hi:[1,0,1] neg_lo:[0,0,1] neg_hi:[0,0,1]
    v_pk_fma_f32 v[114:115], v[114:115], v[234:235], v[186:187] op_sel_hi:[1,0,1] neg_lo:[0,0,1] neg_hi:[0,0,1]
    v_pk_fma_f32 v[116:117], v[116:117], v[234:235], v[188:189] op_sel_hi:[1,0,1] neg_lo:[0,0,1] neg_hi:[0,0,1]
    v_pk_fma_f32 v[118:119], v[118:119], v[234:235], v[190:191] op_sel_hi:[1,0,1] neg_lo:[0,0,1] neg_hi:[0,0,1]
    v_pk_fma_f32 v[120:121], v[120:121], v[234:235], v[192:193] op_sel_hi:[1,0,1] neg_lo:[0,0,1] neg_hi:[0,0,1]
    v_pk_fma_f32 v[122:123], v[122:123], v[234:235], v[194:195] op_sel_hi:[1,0,1] neg_lo:[0,0,1] neg_hi:[0,0,1]
    v_pk_fma_f32 v[124:125], v[124:125], v[234:235], v[196:197] op_sel_hi:[1,0,1] neg_lo:[0,0,1] neg_hi:[0,0,1]
    v_pk_fma_f32 v[126:127], v[126:127], v[234:235], v[198:199] op_sel_hi:[1,0,1] neg_lo:[0,0,1] neg_hi:[0,0,1]
    v_cvt_pk_bf16_f32 v144, v112, v113
    v_cvt_pk_bf16_f32 v145, v114, v115
    v_cvt_pk_bf16_f32 v146, v116, v117
    v_cvt_pk_bf16_f32 v147, v118, v119
    v_cvt_pk_bf16_f32 v148, v120, v121
    v_cvt_pk_bf16_f32 v149, v122, v123
    v_cvt_pk_bf16_f32 v150, v124, v125
    v_cvt_pk_bf16_f32 v151, v126, v127
    v_mfma_f32_32x32x16_bf16 v[112:127], v[68:71], v[144:147], 0
    s_nop 0
    s_nop 0
    v_mfma_f32_32x32x16_bf16 v[112:127], v[72:75], v[148:151], v[112:127]
    v_pk_fma_f32 v[128:129], v[128:129], v[200:201], v[216:217] neg_lo:[0,0,1] neg_hi:[0,0,1]
    v_pk_fma_f32 v[130:131], v[130:131], v[202:203], v[218:219] neg_lo:[0,0,1] neg_hi:[0,0,1]
    v_pk_fma_f32 v[132:133], v[132:133], v[204:205], v[220:221] neg_lo:[0,0,1] neg_hi:[0,0,1]
    v_pk_fma_f32 v[134:135], v[134:135], v[206:207], v[222:223] neg_lo:[0,0,1] neg_hi:[0,0,1]
    v_pk_fma_f32 v[136:137], v[136:137], v[208:209], v[224:225] neg_lo:[0,0,1] neg_hi:[0,0,1]
    v_pk_fma_f32 v[138:139], v[138:139], v[210:211], v[226:227] neg_lo:[0,0,1] neg_hi:[0,0,1]
    v_pk_fma_f32 v[140:141], v[140:141], v[212:213], v[228:229] neg_lo:[0,0,1] neg_hi:[0,0,1]
    v_pk_fma_f32 v[142:143], v[142:143], v[214:215], v[230:231] neg_lo:[0,0,1] neg_hi:[0,0,1]
    v_cvt_pk_bf16_f32 v152, v128, v129
    v_cvt_pk_bf16_f32 v153, v130, v131
    v_cvt_pk_bf16_f32 v154, v132, v133
    v_cvt_pk_bf16_f32 v155, v134, v135
    v_cvt_pk_bf16_f32 v156, v136, v137
    v_cvt_pk_bf16_f32 v157, v138, v139
    v_cvt_pk_bf16_f32 v158, v140, v141
    v_cvt_pk_bf16_f32 v159, v142, v143
    v_cndmask_b32_e64 v152, v152, v82, s[18:19]
    v_cndmask_b32_e64 v153, v153, v82, s[18:19]
    v_cndmask_b32_e64 v154, v154, v82, s[18:19]
    v_cndmask_b32_e64 v155, v155, v82, s[18:19]
    v_cndmask_b32_e64 v156, v156, v82, s[18:19]
    v_cndmask_b32_e64 v157, v157, v82, s[18:19]
    v_cndmask_b32_e64 v158, v158, v82, s[18:19]
    v_cndmask_b32_e64 v159, v159, v82, s[18:19]
    s_barrier
    s_nop 0
    ds_write_b128 v89, v[152:155]
    ds_write_b128 v89, v[156:159] offset:1024
    v_max3_f32 v232, v112, v113, v114
    v_min3_f32 v233, v112, v113, v114
    v_max3_f32 v232, v232, v115, v116
    v_min3_f32 v233, v233, v115, v116
    v_max3_f32 v232, v232, v117, v118
    v_min3_f32 v233, v233, v117, v118
    v_max3_f32 v232, v232, v120, v121
    v_min3_f32 v233, v233, v120, v121
    v_max3_f32 v232, v232, v122, v123
    v_min3_f32 v233, v233, v122, v123
    v_max3_f32 v232, v232, v124, v125
    v_min3_f32 v233, v233, v124, v125
    v_max_f32 v232, v232, v126
    v_min_f32 v233, v233, v126
    v_mov_b32 v242, v232
    v_mov_b32 v243, v233
    s_mov_b32 s64, 0x3fb8aa3b
    s_mov_b32 s65, 0x3fb8aa3b
    v_permlane32_swap_b32 v232, v242
    v_permlane32_swap_b32 v233, v243
    v_max_f32 v232, v232, v242
    v_min_f32 v233, v233, v243
    v_mul_f32 v232, s64, v232
    v_mul_f32 v233, s64, v233
    v_pk_fma_f32 v[184:185], v[112:113], s[64:65], v[232:233] op_sel:[0,0,1] neg_lo:[1,0,0] neg_hi:[1,0,0]
    v_pk_fma_f32 v[112:113], v[112:113], s[64:65], v[232:233] op_sel_hi:[1,1,0] neg_lo:[0,0,1] neg_hi:[0,0,1]
    v_pk_fma_f32 v[186:187], v[114:115], s[64:65], v[232:233] op_sel:[0,0,1] neg_lo:[1,0,0] neg_hi:[1,0,0]
    v_pk_fma_f32 v[114:115], v[114:115], s[64:65], v[232:233] op_sel_hi:[1,1,0] neg_lo:[0,0,1] neg_hi:[0,0,1]
    v_pk_fma_f32 v[188:189], v[116:117], s[64:65], v[232:233] op_sel:[0,0,1] neg_lo:[1,0,0] neg_hi:[1,0,0]
    v_pk_fma_f32 v[116:117], v[116:117], s[64:65], v[232:233] op_sel_hi:[1,1,0] neg_lo:[0,0,1] neg_hi:[0,0,1]
    v_pk_fma_f32 v[190:191], v[118:119], s[64:65], v[232:233] op_sel:[0,0,1] neg_lo:[1,0,0] neg_hi:[1,0,0]
    v_pk_fma_f32 v[118:119], v[118:119], s[64:65], v[232:233] op_sel_hi:[1,1,0] neg_lo:[0,0,1] neg_hi:[0,0,1]
    v_pk_fma_f32 v[192:193], v[120:121], s[64:65], v[232:233] op_sel:[0,0,1] neg_lo:[1,0,0] neg_hi:[1,0,0]
    v_pk_fma_f32 v[120:121], v[120:121], s[64:65], v[232:233] op_sel_hi:[1,1,0] neg_lo:[0,0,1] neg_hi:[0,0,1]
    v_pk_fma_f32 v[194:195], v[122:123], s[64:65], v[232:233] op_sel:[0,0,1] neg_lo:[1,0,0] neg_hi:[1,0,0]
    v_pk_fma_f32 v[122:123], v[122:123], s[64:65], v[232:233] op_sel_hi:[1,1,0] neg_lo:[0,0,1] neg_hi:[0,0,1]
    v_pk_fma_f32 v[196:197], v[124:125], s[64:65], v[232:233] op_sel:[0,0,1] neg_lo:[1,0,0] neg_hi:[1,0,0]
    v_pk_fma_f32 v[124:125], v[124:125], s[64:65], v[232:233] op_sel_hi:[1,1,0] neg_lo:[0,0,1] neg_hi:[0,0,1]
    v_pk_fma_f32 v[198:199], v[126:127], s[64:65], v[232:233] op_sel:[0,0,1] neg_lo:[1,0,0] neg_hi:[1,0,0]
    v_pk_fma_f32 v[126:127], v[126:127], s[64:65], v[232:233] op_sel_hi:[1,1,0] neg_lo:[0,0,1] neg_hi:[0,0,1]
    v_exp_f32 v112, v112
    v_exp_f32 v184, v184
    v_exp_f32 v113, v113
    v_exp_f32 v185, v185
    v_exp_f32 v114, v114
    v_exp_f32 v186, v186
    v_exp_f32 v115, v115
    v_exp_f32 v187, v187
    v_exp_f32 v116, v116
    v_exp_f32 v188, v188
    v_exp_f32 v117, v117
    v_exp_f32 v189, v189
    v_exp_f32 v118, v118
    v_exp_f32 v190, v190
    v_exp_f32 v120, v120
    v_exp_f32 v192, v192
    v_exp_f32 v121, v121
    v_exp_f32 v193, v193
    v_exp_f32 v122, v122
    v_exp_f32 v194, v194
    v_exp_f32 v123, v123
    v_exp_f32 v195, v195
    v_exp_f32 v124, v124
    v_exp_f32 v196, v196
    v_exp_f32 v125, v125
    v_exp_f32 v197, v197
    v_exp_f32 v126, v126
    v_exp_f32 v198, v198
    v_pk_add_f32 v[244:245], v[112:113], v[114:115]
    v_pk_add_f32 v[246:247], v[184:185], v[186:187]
    v_pk_add_f32 v[244:245], v[244:245], v[116:117]
    v_pk_add_f32 v[246:247], v[246:247], v[188:189]
    v_pk_add_f32 v[244:245], v[244:245], v[120:121]
    v_pk_add_f32 v[246:247], v[246:247], v[192:193]
    v_pk_add_f32 v[244:245], v[244:245], v[122:123]
    v_pk_add_f32 v[246:247], v[246:247], v[194:195]
    v_pk_add_f32 v[244:245], v[244:245], v[124:125]
    v_pk_add_f32 v[246:247], v[246:247], v[196:197]
    v_add_f32 v244, v244, v245
    v_add_f32 v246, v246, v247
    v_add_f32 v242, v118, v126
    v_add_f32 v243, v190, v198
    v_add_f32 v244, v244, v242
    v_add_f32 v246, v246, v243
    v_mov_b32 v242, v244
    v_mov_b32 v243, v246
    s_nop 0
    v_permlane32_swap_b32 v244, v242
    v_permlane32_swap_b32 v246, v243
    v_add_f32 v244, v244, v242
    v_add_f32 v246, v246, v243
    v_rcp_f32 v244, v244
    v_rcp_f32_e64 v246, v246
    v_pk_mul_f32 v[112:113], v[112:113], v[244:245] op_sel_hi:[1,0]
    v_pk_mul_f32 v[114:115], v[114:115], v[244:245] op_sel_hi:[1,0]
    v_pk_mul_f32 v[116:117], v[116:117], v[244:245] op_sel_hi:[1,0]
    v_pk_mul_f32 v[118:119], v[118:119], v[244:245] op_sel_hi:[1,0]
    v_pk_mul_f32 v[120:121], v[120:121], v[244:245] op_sel_hi:[1,0]
    v_pk_mul_f32 v[122:123], v[122:123], v[244:245] op_sel_hi:[1,0]
    v_pk_mul_f32 v[124:125], v[124:125], v[244:245] op_sel_hi:[1,0]
    v_pk_mul_f32 v[126:127], v[126:127], v[244:245] op_sel_hi:[1,0]
    v_cvt_pk_bf16_f32 v168, v112, v113
    v_cvt_pk_bf16_f32 v169, v114, v115
    v_cvt_pk_bf16_f32 v170, v116, v117
    v_cvt_pk_bf16_f32 v171, v118, 0
    v_cvt_pk_bf16_f32 v172, v120, v121
    v_cvt_pk_bf16_f32 v173, v122, v123
    v_cvt_pk_bf16_f32 v174, v124, v125
    v_cvt_pk_bf16_f32 v175, v126, 0
    ds_write_b128 v88, v[168:171] offset:0
    ds_write_b128 v88, v[172:175] offset:32
    v_pk_mul_f32 v[184:185], v[184:185], v[246:247] op_sel_hi:[1,0]
    v_pk_mul_f32 v[186:187], v[186:187], v[246:247] op_sel_hi:[1,0]
    v_pk_mul_f32 v[188:189], v[188:189], v[246:247] op_sel_hi:[1,0]
    v_pk_mul_f32 v[190:191], v[190:191], v[246:247] op_sel_hi:[1,0]
    v_pk_mul_f32 v[192:193], v[192:193], v[246:247] op_sel_hi:[1,0]
    v_pk_mul_f32 v[194:195], v[194:195], v[246:247] op_sel_hi:[1,0]
    v_pk_mul_f32 v[196:197], v[196:197], v[246:247] op_sel_hi:[1,0]
    v_pk_mul_f32 v[198:199], v[198:199], v[246:247] op_sel_hi:[1,0]
    v_cvt_pk_bf16_f32 v176, v184, v185
    v_cvt_pk_bf16_f32 v177, v186, v187
    v_cvt_pk_bf16_f32 v178, v188, v189
    v_cvt_pk_bf16_f32 v179, v190, 0
    v_cvt_pk_bf16_f32 v180, v192, v193
    v_cvt_pk_bf16_f32 v181, v194, v195
    v_cvt_pk_bf16_f32 v182, v196, v197
    v_cvt_pk_bf16_f32 v183, v198, 0
    ds_write_b128 v88, v[176:179] offset:64
    ds_write_b128 v88, v[180:183] offset:96
    s_waitcnt lgkmcnt(0)
    s_barrier
    v_xor_b32 v242, 256, v91
    ds_read_b64_tr_b16 v[200:201], v90 offset:0
    ds_read_b64_tr_b16 v[202:203], v90 offset:1152
    ds_read_b128 v[116:119], v242 offset:0
    ds_read_b64_tr_b16 v[204:205], v90 offset:4608
    ds_read_b64_tr_b16 v[206:207], v90 offset:5760
    ds_read_b128 v[124:127], v242 offset:2048
    ds_read_b64_tr_b16 v[208:209], v90 offset:9216
    ds_read_b64_tr_b16 v[210:211], v90 offset:10368
    ds_read_b128 v[132:135], v242 offset:4096
    ds_read_b64_tr_b16 v[212:213], v90 offset:13824
    ds_read_b64_tr_b16 v[214:215], v90 offset:14976
    ds_read_b128 v[140:143], v242 offset:6144
    ds_read_b128 v[112:115], v91 offset:0
    ds_read_b128 v[120:123], v91 offset:2048
    ds_read_b128 v[128:131], v91 offset:4096
    ds_read_b128 v[136:139], v91 offset:6144
    s_waitcnt lgkmcnt(13)
    v_mfma_f32_16x16x32_bf16 v[248:251], v[200:203], v[116:119], 0
    s_waitcnt lgkmcnt(10)
    v_mfma_f32_16x16x32_bf16 v[248:251], v[204:207], v[124:127], v[248:251]
    s_waitcnt lgkmcnt(7)
    v_mfma_f32_16x16x32_bf16 v[248:251], v[208:211], v[132:135], v[248:251]
    s_waitcnt lgkmcnt(4)
    v_mfma_f32_16x16x32_bf16 v[248:251], v[212:215], v[140:143], v[248:251]
    s_lshl_b32 s13, s6, 2
    s_add_u32 s13, s13, s7
    s_lshl_b32 s56, s13, 13
    s_add_u32 s56, s56, 2097152
    s_lshl_b32 s13, s13, 10
    s_lshl_b32 s14, s8, 16
    s_add_u32 s13, s13, s14
    s_add_u32 s13, s13, 3145728
    s_xor_b32 s14, s13, 0x10000
    s_add_u32 s15, s9, 3
    v_mov_b32 v146, s15
    v_mov_b32 v147, s15
    v_mov_b32 v241, s22
    v_or_b32 v241, 0x2000, v241
    v_cvt_pk_bf16_f32 v144, v248, v249
    v_cvt_pk_bf16_f32 v145, v250, v251
    s_cmp_lg_u32 s10, 0
    s_cbranch_scc1 Lslow_66
    buffer_store_dwordx4 v[144:147], v1, s[52:55], s13 offen
Ljoin_67:
    s_waitcnt lgkmcnt(3)
    v_mfma_f32_16x16x32_bf16 v[244:247], v[200:203], v[112:115], 0
    s_waitcnt lgkmcnt(2)
    v_mfma_f32_16x16x32_bf16 v[244:247], v[204:207], v[120:123], v[244:247]
    s_waitcnt lgkmcnt(1)
    v_mfma_f32_16x16x32_bf16 v[244:247], v[208:211], v[128:131], v[244:247]
    s_waitcnt lgkmcnt(0)
    v_mfma_f32_16x16x32_bf16 v[244:247], v[212:215], v[136:139], v[244:247]
    ds_read_b64_tr_b16 a[228:229], v2 offset:0
    ds_read_b64_tr_b16 a[230:231], v2 offset:256
    ds_read_b64_tr_b16 a[232:233], v2 offset:1024
    ds_read_b64_tr_b16 a[234:235], v2 offset:1280
    ds_read_b64_tr_b16 a[236:237], v2 offset:2048
    ds_read_b64_tr_b16 a[238:239], v2 offset:2304
    ds_read_b128 v[168:171], v27 offset:384
    ds_read_b128 v[172:175], v27 offset:416
    ds_read_b128 v[176:179], v27 offset:448
    ds_read_b128 v[180:183], v27 offset:480
    s_waitcnt lgkmcnt(8)
    v_mfma_f32_32x32x16_bf16 v[96:111], a[228:231], a[0:3], 0
    ds_read_b64_tr_b16 a[240:241], v2 offset:3072
    ds_read_b64_tr_b16 a[242:243], v2 offset:3328
    s_waitcnt lgkmcnt(8)
    v_mfma_f32_32x32x16_bf16 v[112:127], a[232:235], a[4:7], 0
    ds_read_b64_tr_b16 a[228:229], v2 offset:4096
    ds_read_b64_tr_b16 a[230:231], v2 offset:4352
    s_waitcnt lgkmcnt(8)
    v_mfma_f32_32x32x16_bf16 v[96:111], a[236:239], a[8:11], v[96:111]
    ds_read_b64_tr_b16 a[232:233], v2 offset:5120
    ds_read_b64_tr_b16 a[234:235], v2 offset:5376
    s_waitcnt lgkmcnt(4)
    v_mfma_f32_32x32x16_bf16 v[112:127], a[240:243], a[12:15], v[112:127]
    buffer_load_dwordx4 v[152:155], v1, s[52:55], s14 offen sc1
    ds_read_b64_tr_b16 a[236:237], v2 offset:6144
    ds_read_b64_tr_b16 a[238:239], v2 offset:6400
    s_waitcnt lgkmcnt(4)
    v_mfma_f32_32x32x16_bf16 v[96:111], a[228:231], a[16:19], v[96:111]
    ds_read_b64_tr_b16 a[240:241], v2 offset:7168
    ds_read_b64_tr_b16 a[242:243], v2 offset:7424
    s_waitcnt lgkmcnt(4)
    v_mfma_f32_32x32x16_bf16 v[112:127], a[232:235], a[20:23], v[112:127]
    ds_read_b64_tr_b16 a[228:229], v2 offset:8192
    ds_read_b64_tr_b16 a[230:231], v2 offset:8448
    s_waitcnt lgkmcnt(4)
    v_mfma_f32_32x32x16_bf16 v[96:111], a[236:239], a[24:27], v[96:111]
    ds_read_b64_tr_b16 a[232:233], v2 offset:9216
    ds_read_b64_tr_b16 a[234:235], v2 offset:9472
    s_waitcnt lgkmcnt(4)
    v_mfma_f32_32x32x16_bf16 v[112:127], a[240:243], a[28:31], v[112:127]
    ds_read_b64_tr_b16 a[236:237], v2 offset:10240
    ds_read_b64_tr_b16 a[238:239], v2 offset:10496
    s_waitcnt lgkmcnt(4)
    v_mfma_f32_32x32x16_bf16 v[96:111], a[228:231], a[32:35], v[96:111]
    ds_read_b64_tr_b16 a[240:241], v2 offset:11264
    ds_read_b64_tr_b16 a[242:243], v2 offset:11520
Lpair_68:
    buffer_load_dwordx4 v[156:159], v1, s[52:55], s14 offen sc1
    s_waitcnt vmcnt(1)
    v_cmp_ne_u32 vcc, s15, v155
    s_cbranch_vccz Lpaird_70
    buffer_load_dwordx4 v[152:155], v1, s[52:55], s14 offen sc1
    s_waitcnt vmcnt(1)
    v_cmp_ne_u32 vcc, s15, v159
    s_cbranch_vccz Lpairb_69
    s_sub_u32 s11, s11, 1
    s_cbranch_scc0 Lpair_68
    s_mov_b32 s11, 0
Lpairb_69:
    v_mov_b64 v[148:149], v[156:157]
    s_branch Lpaird_70_j
Lpaird_70:
    v_mov_b64 v[148:149], v[152:153]
Lpaird_70_j:
    v_lshlrev_b32 v160, 16, v148
    v_and_b32 v161, 0xffff0000, v148
    v_lshlrev_b32_e64 v162, 16, v149
    v_and_b32 v163, 0xffff0000, v149
    s_lshl_b32 s13, s4, 10
    s_add_u32 s13, s13, s56
    v_pk_add_f32 v[244:245], v[244:245], v[160:161]
    v_pk_add_f32 v[246:247], v[246:247], v[162:163]
    v_cvt_pk_bf16_f32 v164, v244, v245
    v_cvt_pk_bf16_f32 v165, v246, v247
    v_cvt_pk_bf16_f32 v166, v244, v245
    v_cvt_pk_bf16_f32 v167, v246, v247
    s_nop 0
    v_permlane16_swap_b32 v164, v166
    v_permlane16_swap_b32 v165, v167
    v_mov_b32_sdwa v167, v241 dst_sel:WORD_1 dst_unused:UNUSED_PRESERVE src0_sel:WORD_0
    s_nop 0
    buffer_store_dwordx4 v[164:167], v80, s[52:55], s13 offen sc1
    v_lshlrev_b32 v241, 16, v241
    v_lshrrev_b32 v240, 4, v0
    v_and_b32 v252, 0xf0, v1
    v_lshl_add_u32 v252, v240, 10, v252
    v_mov_b32_e64 v253, v252
    s_waitcnt lgkmcnt(4)
    v_mfma_f32_32x32x16_bf16 v[112:127], a[232:235], a[36:39], v[112:127]
    ds_read_b64_tr_b16 a[228:229], v2 offset:12288
    ds_read_b64_tr_b16 a[230:231], v2 offset:12544
    s_waitcnt lgkmcnt(4)
    v_mfma_f32_32x32x16_bf16 v[96:111], a[236:239], a[40:43], v[96:111]
    ds_read_b64_tr_b16 a[232:233], v2 offset:13312
    ds_read_b64_tr_b16 a[234:235], v2 offset:13568
    s_waitcnt lgkmcnt(4)
    v_mfma_f32_32x32x16_bf16 v[112:127], a[240:243], a[44:47], v[112:127]
    ds_read_b64_tr_b16 a[236:237], v2 offset:14336
    ds_read_b64_tr_b16 a[238:239], v2 offset:14592
    s_waitcnt lgkmcnt(4)
    v_mfma_f32_32x32x16_bf16 v[96:111], a[228:231], a[48:51], v[96:111]
    ds_read_b64_tr_b16 a[240:241], v2 offset:15360
    ds_read_b64_tr_b16 a[242:243], v2 offset:15616
    s_waitcnt lgkmcnt(4)
    v_mfma_f32_32x32x16_bf16 v[112:127], a[232:235], a[52:55], v[112:127]
    ds_read_b64_tr_b16 a[228:229], v2 offset:16384
    ds_read_b64_tr_b16 a[230:231], v2 offset:16640
    s_waitcnt lgkmcnt(4)
    v_mfma_f32_32x32x16_bf16 v[96:111], a[236:239], a[56:59], v[96:111]
    ds_read_b64_tr_b16 a[232:233], v2 offset:17408
    ds_read_b64_tr_b16 a[234:235], v2 offset:17664
    s_waitcnt lgkmcnt(4)
    v_mfma_f32_32x32x16_bf16 v[112:127], a[240:243], a[60:63], v[112:127]
    ds_read_b64_tr_b16 a[236:237], v2 offset:18432
    ds_read_b64_tr_b16 a[238:239], v2 offset:18688
    s_waitcnt lgkmcnt(4)
    v_mfma_f32_32x32x16_bf16 v[96:111], a[228:231], a[64:67], v[96:111]
    ds_read_b64_tr_b16 a[240:241], v2 offset:19456
    ds_read_b64_tr_b16 a[242:243], v2 offset:19712
    s_waitcnt lgkmcnt(4)
    v_mfma_f32_32x32x16_bf16 v[112:127], a[232:235], a[68:71], v[112:127]
    ds_read_b64_tr_b16 a[228:229], v2 offset:20480
    ds_read_b64_tr_b16 a[230:231], v2 offset:20736
    s_waitcnt lgkmcnt(4)
    v_mfma_f32_32x32x16_bf16 v[96:111], a[236:239], a[72:75], v[96:111]
    ds_read_b64_tr_b16 a[232:233], v2 offset:21504
    ds_read_b64_tr_b16 a[234:235], v2 offset:21760
    s_waitcnt lgkmcnt(4)
    v_mfma_f32_32x32x16_bf16 v[112:127], a[240:243], a[76:79], v[112:127]
    ds_read_b64_tr_b16 a[236:237], v2 offset:22528
    ds_read_b64_tr_b16 a[238:239], v2 offset:22784
    s_waitcnt lgkmcnt(4)
    v_mfma_f32_32x32x16_bf16 v[96:111], a[228:231], a[80:83], v[96:111]
    ds_read_b64_tr_b16 a[240:241], v2 offset:23552
    ds_read_b64_tr_b16 a[242:243], v2 offset:23808
    s_waitcnt lgkmcnt(4)
    v_mfma_f32_32x32x16_bf16 v[112:127], a[232:235], a[84:87], v[112:127]
    ds_read_b64_tr_b16 a[228:229], v2 offset:24576
    ds_read_b64_tr_b16 a[230:231], v2 offset:24832
    s_waitcnt lgkmcnt(4)
    v_mfma_f32_32x32x16_bf16 v[96:111], a[236:239], a[88:91], v[96:111]
    s_add_u32 s13, s56, 0
    buffer_load_dwordx4 v[184:187], v252, s[52:55], s13 offen offset:0 sc1
    ds_read_b64_tr_b16 a[232:233], v2 offset:25600
    ds_read_b64_tr_b16 a[234:235], v2 offset:25856
    s_waitcnt lgkmcnt(4)
    v_mfma_f32_32x32x16_bf16 v[112:127], a[240:243], a[92:95], v[112:127]
    buffer_load_dwordx4 v[188:191], v252, s[52:55], s13 offen offset:256 sc1
    ds_read_b64_tr_b16 a[236:237], v2 offset:26624
    ds_read_b64_tr_b16 a[238:239], v2 offset:26880
    s_waitcnt lgkmcnt(4)
    v_mfma_f32_32x32x16_bf16 v[96:111], a[228:231], a[96:99], v[96:111]
    buffer_load_dwordx4 v[192:195], v252, s[52:55], s13 offen offset:512 sc1
    ds_read_b64_tr_b16 a[240:241], v2 offset:27648
    ds_read_b64_tr_b16 a[242:243], v2 offset:27904
    s_waitcnt lgkmcnt(4)
    v_mfma_f32_32x32x16_bf16 v[112:127], a[232:235], a[100:103], v[112:127]
    buffer_load_dwordx4 v[196:199], v252, s[52:55], s13 offen offset:768 sc1
    s_waitcnt lgkmcnt(2)
    v_mfma_f32_32x32x16_bf16 v[96:111], a[236:239], a[104:107], v[96:111]
    s_add_u32 s13, s56, 4096
    buffer_load_dwordx4 v[200:203], v253, s[52:55], s13 offen offset:0 sc1
    s_waitcnt lgkmcnt(0)
    v_mfma_f32_32x32x16_bf16 v[112:127], a[240:243], a[108:111], v[112:127]
    buffer_load_dwordx4 v[204:207], v253, s[52:55], s13 offen offset:256 sc1
    buffer_load_dwordx4 v[208:211], v253, s[52:55], s13 offen offset:512 sc1
    v_pk_mul_f32 v[168:169], v[168:169], v[234:235] op_sel:[0,1]
    v_pk_mul_f32 v[170:171], v[170:171], v[234:235] op_sel:[0,1]
    v_pk_mul_f32 v[172:173], v[172:173], v[234:235] op_sel:[0,1]
    v_pk_mul_f32 v[174:175], v[174:175], v[234:235] op_sel:[0,1]
    buffer_load_dwordx4 v[212:215], v253, s[52:55], s13 offen offset:768 sc1
    v_pk_mul_f32 v[176:177], v[176:177], v[234:235] op_sel:[0,1]
    v_pk_mul_f32 v[178:179], v[178:179], v[234:235] op_sel:[0,1]
    v_pk_mul_f32 v[180:181], v[180:181], v[234:235] op_sel:[0,1]
    v_pk_mul_f32 v[182:183], v[182:183], v[234:235] op_sel:[0,1]
    s_nop 0
    s_nop 0
    v_pk_add_f32 v[96:97], v[96:97], v[112:113]
    v_pk_add_f32 v[98:99], v[98:99], v[114:115]
    v_pk_add_f32 v[100:101], v[100:101], v[116:117]
    v_pk_add_f32 v[102:103], v[102:103], v[118:119]
    v_pk_add_f32 v[104:105], v[104:105], v[120:121]
    v_pk_add_f32 v[106:107], v[106:107], v[122:123]
    v_pk_add_f32 v[108:109], v[108:109], v[124:125]
    v_pk_add_f32 v[110:111], v[110:111], v[126:127]
    v_pk_fma_f32 v[96:97], v[96:97], v[234:235], v[168:169] op_sel_hi:[1,0,1] neg_lo:[0,0,1] neg_hi:[0,0,1]
    v_pk_fma_f32 v[98:99], v[98:99], v[234:235], v[170:171] op_sel_hi:[1,0,1] neg_lo:[0,0,1] neg_hi:[0,0,1]
    v_pk_fma_f32 v[100:101], v[100:101], v[234:235], v[172:173] op_sel_hi:[1,0,1] neg_lo:[0,0,1] neg_hi:[0,0,1]
    v_pk_fma_f32 v[102:103], v[102:103], v[234:235], v[174:175] op_sel_hi:[1,0,1] neg_lo:[0,0,1] neg_hi:[0,0,1]
    v_pk_fma_f32 v[104:105], v[104:105], v[234:235], v[176:177] op_sel_hi:[1,0,1] neg_lo:[0,0,1] neg_hi:[0,0,1]
    v_pk_fma_f32 v[106:107], v[106:107], v[234:235], v[178:179] op_sel_hi:[1,0,1] neg_lo:[0,0,1] neg_hi:[0,0,1]
    v_pk_fma_f32 v[108:109], v[108:109], v[234:235], v[180:181] op_sel_hi:[1,0,1] neg_lo:[0,0,1] neg_hi:[0,0,1]
    v_pk_fma_f32 v[110:111], v[110:111], v[234:235], v[182:183] op_sel_hi:[1,0,1] neg_lo:[0,0,1] neg_hi:[0,0,1]
    v_cvt_pk_bf16_f32 v144, v96, v97
    v_cvt_pk_bf16_f32 v145, v98, v99
    v_cvt_pk_bf16_f32 v146, v100, v101
    v_cvt_pk_bf16_f32 v147, v102, v103
    v_cvt_pk_bf16_f32 v148, v104, v105
    v_cvt_pk_bf16_f32 v149, v106, v107
    v_cvt_pk_bf16_f32 v150, v108, v109
    v_cvt_pk_bf16_f32 v151, v110, v111
    v_mfma_f32_32x32x16_bf16 v[96:111], v[68:71], v[144:147], 0
    s_nop 0
    v_mfma_f32_32x32x16_bf16 v[96:111], v[72:75], v[148:151], v[96:111]
    s_nop 11
    v_max3_f32 v232, v96, v97, v98
    v_min3_f32 v233, v96, v97, v98
    v_max3_f32 v232, v232, v99, v100
    v_min3_f32 v233, v233, v99, v100
    v_max3_f32 v232, v232, v101, v102
    v_min3_f32 v233, v233, v101, v102
    v_max3_f32 v232, v232, v104, v105
    v_min3_f32 v233, v233, v104, v105
    v_max3_f32 v232, v232, v106, v107
    v_min3_f32 v233, v233, v106, v107
    v_max3_f32 v232, v232, v108, v109
    v_min3_f32 v233, v233, v108, v109
    v_max_f32 v232, v232, v110
    v_min_f32 v233, v233, v110
    v_mov_b32 v242, v232
    v_mov_b32 v243, v233
    s_mov_b32 s64, 0x3fb8aa3b
    s_mov_b32 s65, 0x3fb8aa3b
    v_permlane32_swap_b32 v232, v242
    v_permlane32_swap_b32 v233, v243
    v_max_f32 v232, v232, v242
    v_min_f32 v233, v233, v243
    v_mul_f32 v232, s64, v232
    v_mul_f32 v233, s64, v233
    v_pk_fma_f32 v[168:169], v[96:97], s[64:65], v[232:233] op_sel:[0,0,1] neg_lo:[1,0,0] neg_hi:[1,0,0]
    v_pk_fma_f32 v[96:97], v[96:97], s[64:65], v[232:233] op_sel_hi:[1,1,0] neg_lo:[0,0,1] neg_hi:[0,0,1]
    v_pk_fma_f32 v[170:171], v[98:99], s[64:65], v[232:233] op_sel:[0,0,1] neg_lo:[1,0,0] neg_hi:[1,0,0]
    v_pk_fma_f32 v[98:99], v[98:99], s[64:65], v[232:233] op_sel_hi:[1,1,0] neg_lo:[0,0,1] neg_hi:[0,0,1]
    v_pk_fma_f32 v[172:173], v[100:101], s[64:65], v[232:233] op_sel:[0,0,1] neg_lo:[1,0,0] neg_hi:[1,0,0]
    v_pk_fma_f32 v[100:101], v[100:101], s[64:65], v[232:233] op_sel_hi:[1,1,0] neg_lo:[0,0,1] neg_hi:[0,0,1]
    v_pk_fma_f32 v[174:175], v[102:103], s[64:65], v[232:233] op_sel:[0,0,1] neg_lo:[1,0,0] neg_hi:[1,0,0]
    v_pk_fma_f32 v[102:103], v[102:103], s[64:65], v[232:233] op_sel_hi:[1,1,0] neg_lo:[0,0,1] neg_hi:[0,0,1]
    v_pk_fma_f32 v[176:177], v[104:105], s[64:65], v[232:233] op_sel:[0,0,1] neg_lo:[1,0,0] neg_hi:[1,0,0]
    v_pk_fma_f32 v[104:105], v[104:105], s[64:65], v[232:233] op_sel_hi:[1,1,0] neg_lo:[0,0,1] neg_hi:[0,0,1]
    v_pk_fma_f32 v[178:179], v[106:107], s[64:65], v[232:233] op_sel:[0,0,1] neg_lo:[1,0,0] neg_hi:[1,0,0]
    v_pk_fma_f32 v[106:107], v[106:107], s[64:65], v[232:233] op_sel_hi:[1,1,0] neg_lo:[0,0,1] neg_hi:[0,0,1]
    v_pk_fma_f32 v[180:181], v[108:109], s[64:65], v[232:233] op_sel:[0,0,1] neg_lo:[1,0,0] neg_hi:[1,0,0]
    v_pk_fma_f32 v[108:109], v[108:109], s[64:65], v[232:233] op_sel_hi:[1,1,0] neg_lo:[0,0,1] neg_hi:[0,0,1]
    v_pk_fma_f32 v[182:183], v[110:111], s[64:65], v[232:233] op_sel:[0,0,1] neg_lo:[1,0,0] neg_hi:[1,0,0]
    v_pk_fma_f32 v[110:111], v[110:111], s[64:65], v[232:233] op_sel_hi:[1,1,0] neg_lo:[0,0,1] neg_hi:[0,0,1]
    v_exp_f32 v96, v96
    v_exp_f32 v168, v168
    v_exp_f32 v97, v97
    v_exp_f32 v169, v169
    v_exp_f32 v98, v98
    v_exp_f32 v170, v170
    v_exp_f32 v99, v99
    v_exp_f32 v171, v171
    v_exp_f32 v100, v100
    v_exp_f32 v172, v172
    v_exp_f32 v101, v101
    v_exp_f32 v173, v173
    v_exp_f32 v102, v102
    v_exp_f32 v174, v174
    v_exp_f32 v104, v104
    v_exp_f32 v176, v176
    v_exp_f32 v105, v105
    v_exp_f32 v177, v177
    v_exp_f32 v106, v106
    v_exp_f32 v178, v178
    v_exp_f32 v107, v107
    v_exp_f32 v179, v179
    v_exp_f32 v108, v108
    v_exp_f32 v180, v180
    v_exp_f32 v109, v109
    v_exp_f32 v181, v181
    v_exp_f32 v110, v110
    v_exp_f32 v182, v182
    v_pk_add_f32 v[244:245], v[96:97], v[98:99]
    v_pk_add_f32 v[246:247], v[168:169], v[170:171]
    v_pk_add_f32 v[244:245], v[244:245], v[100:101]
    v_pk_add_f32 v[246:247], v[246:247], v[172:173]
    v_pk_add_f32 v[244:245], v[244:245], v[104:105]
    v_pk_add_f32 v[246:247], v[246:247], v[176:177]
    v_pk_add_f32 v[244:245], v[244:245], v[106:107]
    v_pk_add_f32 v[246:247], v[246:247], v[178:179]
    v_pk_add_f32 v[244:245], v[244:245], v[108:109]
    v_pk_add_f32 v[246:247], v[246:247], v[180:181]
    v_add_f32 v244, v244, v245
    v_add_f32 v246, v246, v247
    v_add_f32 v242, v102, v110
    v_add_f32 v243, v174, v182
    v_add_f32 v244, v244, v242
    v_add_f32 v246, v246, v243
    v_mov_b32 v242, v244
    v_mov_b32 v243, v246
    s_nop 0
    v_permlane32_swap_b32 v244, v242
    v_permlane32_swap_b32 v246, v243
    v_add_f32 v244, v244, v242
    v_add_f32 v246, v246, v243
    v_rcp_f32 v244, v244
    v_rcp_f32_e64 v246, v246
    v_pk_mul_f32 v[96:97], v[96:97], v[244:245] op_sel_hi:[1,0]
    v_pk_mul_f32 v[98:99], v[98:99], v[244:245] op_sel_hi:[1,0]
    v_pk_mul_f32 v[100:101], v[100:101], v[244:245] op_sel_hi:[1,0]
    v_pk_mul_f32 v[102:103], v[102:103], v[244:245] op_sel_hi:[1,0]
    v_pk_mul_f32 v[104:105], v[104:105], v[244:245] op_sel_hi:[1,0]
    v_pk_mul_f32 v[106:107], v[106:107], v[244:245] op_sel_hi:[1,0]
    v_pk_mul_f32 v[108:109], v[108:109], v[244:245] op_sel_hi:[1,0]
    v_pk_mul_f32 v[110:111], v[110:111], v[244:245] op_sel_hi:[1,0]
    s_waitcnt vmcnt(9)
    s_nop 0
    v_cvt_pk_bf16_f32 v152, v96, v97
    v_cvt_pk_bf16_f32 v153, v98, v99
    v_cvt_pk_bf16_f32 v154, v100, v101
    v_cvt_pk_bf16_f32 v155, v102, 0
    v_cvt_pk_bf16_f32 v156, v104, v105
    v_cvt_pk_bf16_f32 v157, v106, v107
    v_cvt_pk_bf16_f32 v158, v108, v109
    v_cvt_pk_bf16_f32 v159, v110, 0
    v_pk_mul_f32 v[168:169], v[168:169], v[246:247] op_sel_hi:[1,0]
    v_pk_mul_f32 v[170:171], v[170:171], v[246:247] op_sel_hi:[1,0]
    v_pk_mul_f32 v[172:173], v[172:173], v[246:247] op_sel_hi:[1,0]
    v_pk_mul_f32 v[174:175], v[174:175], v[246:247] op_sel_hi:[1,0]
    v_pk_mul_f32 v[176:177], v[176:177], v[246:247] op_sel_hi:[1,0]
    v_pk_mul_f32 v[178:179], v[178:179], v[246:247] op_sel_hi:[1,0]
    v_pk_mul_f32 v[180:181], v[180:181], v[246:247] op_sel_hi:[1,0]
    v_pk_mul_f32 v[182:183], v[182:183], v[246:247] op_sel_hi:[1,0]
    v_cvt_pk_bf16_f32 v160, v168, v169
    v_cvt_pk_bf16_f32 v161, v170, v171
    v_cvt_pk_bf16_f32 v162, v172, v173
    v_cvt_pk_bf16_f32 v163, v174, 0
    v_cvt_pk_bf16_f32 v164, v176, v177
    v_cvt_pk_bf16_f32 v165, v178, v179
    v_cvt_pk_bf16_f32 v166, v180, v181
    v_cvt_pk_bf16_f32 v167, v182, 0
    s_waitcnt vmcnt(7)
    v_mfma_f32_16x16x32_bf16 v[112:115], v[76:79], v[184:187], 0
    v_xor_b32 v240, v187, v241
    s_waitcnt vmcnt(6)
    v_mfma_f32_16x16x32_bf16 v[116:119], v[76:79], v[188:191], 0
    v_bitop3_b32 v240, v191, v241, v240 bitop3:0xbe
    s_waitcnt vmcnt(5)
    v_mfma_f32_16x16x32_bf16 v[120:123], v[76:79], v[192:195], 0
    v_bitop3_b32 v240, v195, v241, v240 bitop3:0xbe
    s_waitcnt vmcnt(4)
    v_mfma_f32_16x16x32_bf16 v[124:127], v[76:79], v[196:199], 0
    v_bitop3_b32 v240, v199, v241, v240 bitop3:0xbe
    s_waitcnt vmcnt(3)
    v_mfma_f32_16x16x32_bf16 v[112:115], v[76:79], v[200:203], v[112:115]
    v_bitop3_b32 v240, v203, v241, v240 bitop3:0xbe
    s_waitcnt vmcnt(2)
    v_mfma_f32_16x16x32_bf16 v[116:119], v[76:79], v[204:207], v[116:119]
    v_bitop3_b32 v240, v207, v241, v240 bitop3:0xbe
    s_waitcnt vmcnt(1)
    v_mfma_f32_16x16x32_bf16 v[120:123], v[76:79], v[208:211], v[120:123]
    v_bitop3_b32 v240, v211, v241, v240 bitop3:0xbe
    s_waitcnt vmcnt(0)
    v_mfma_f32_16x16x32_bf16 v[124:127], v[76:79], v[212:215], v[124:127]
    v_bitop3_b32 v240, v215, v241, v240 bitop3:0xbe
    v_cmp_lt_u32 vcc, 0xffff, v240
    s_cbranch_vccnz Lkvretry_71
Lkvback_72:
    v_cvt_pk_bf16_f32 v144, v112, v113
    v_cvt_pk_bf16_f32 v145, v114, v115
    v_cvt_pk_bf16_f32 v146, v116, v117
    v_cvt_pk_bf16_f32 v147, v118, v119
    v_cvt_pk_bf16_f32 v148, v120, v121
    v_cvt_pk_bf16_f32 v149, v122, v123
    v_cvt_pk_bf16_f32 v150, v124, v125
    v_cvt_pk_bf16_f32 v151, v126, v127
    s_mov_b32 exec_hi, 0
    ds_write_b64 v92, v[144:145] offset:0
    ds_write_b64 v92, v[146:147] offset:256
    ds_write_b64 v92, v[148:149] offset:512
    ds_write_b64 v92, v[150:151] offset:768
    s_mov_b64 exec, -1
    s_waitcnt lgkmcnt(0)
    s_barrier
    ds_read_b128 v[168:171], v93 offset:0
    ds_read_b128 v[172:175], v93 offset:1024
    ds_read_b128 v[176:179], v93 offset:2048
    ds_read_b128 v[180:183], v93 offset:3072
    s_waitcnt lgkmcnt(3)
    v_mfma_f32_32x32x16_bf16 v[128:143], v[168:171], v[152:155], 0
    s_waitcnt lgkmcnt(2)
    v_mfma_f32_32x32x16_bf16 v[128:143], v[172:175], v[156:159], v[128:143]
    s_waitcnt lgkmcnt(1)
    v_mfma_f32_32x32x16_bf16 v[128:143], v[176:179], v[160:163], v[128:143]
    s_waitcnt lgkmcnt(0)
    v_mfma_f32_32x32x16_bf16 v[128:143], v[180:183], v[164:167], v[128:143]
    s_nop 11
    v_mov_b32 v232, v140
    v_mov_b32 v233, v140
    s_mul_i32 s56, s8, 114688
    s_add_u32 s56, s56, 4194304
    v_permlane32_swap_b32 v232, v233
    v_add_f32 v233, 0x358637bd, v233
    v_rcp_f32 v233, v233
    s_nop 0
    v_pk_mul_f32 v[128:129], v[128:129], v[232:233] op_sel:[0,1]
    v_pk_mul_f32 v[130:131], v[130:131], v[232:233] op_sel:[0,1]
    v_pk_mul_f32 v[132:133], v[132:133], v[232:233] op_sel:[0,1]
    v_pk_mul_f32 v[134:135], v[134:135], v[232:233] op_sel:[0,1]
    v_pk_mul_f32 v[136:137], v[136:137], v[232:233] op_sel:[0,1]
    v_pk_mul_f32 v[138:139], v[138:139], v[232:233] op_sel:[0,1]
    v_pk_mul_f32 v[140:141], v[140:141], v[232:233] op_sel:[0,1]
    v_pk_mul_f32 v[142:143], v[142:143], v[232:233] op_sel:[0,1]
    v_cvt_pk_bf16_f32 v144, v128, v129
    v_cvt_pk_bf16_f32 v145, v130, v131
    v_cvt_pk_bf16_f32 v146, v132, v133
    v_cvt_pk_bf16_f32 v147, v134, v135
    v_cvt_pk_bf16_f32 v148, v136, v137
    v_cvt_pk_bf16_f32 v149, v138, v139
    v_cvt_pk_bf16_f32 v150, v140, v141
    v_cvt_pk_bf16_f32 v151, v142, v143
    s_cmp_lg_u32 s10, 0
    s_cbranch_scc1 Lslow_73
    buffer_store_dwordx2 v[144:145], v10, s[52:55], s56 offen offset:0
    buffer_store_dwordx2 v[146:147], v10, s[52:55], s56 offen offset:256
    buffer_store_dwordx2 v[148:149], v10, s[52:55], s56 offen offset:512
    buffer_store_dwordx2 v[150:151], v11, s[52:55], s56 offen offset:768
Ljoin_74:
    s_lshl_b32 s13, s8, 2
    s_add_u32 s13, s13, s7
    s_lshl_b32 s13, s13, 7
    s_lshl_b32 s14, s6, 2
    s_add_u32 s13, s13, s14
    s_add_u32 s56, s13, 32768
    s_lshl_b32 s90, s8, 2
    s_add_u32 s90, s90, s23
    s_lshl_b32 s90, s90, 7
    s_add_u32 s90, s90, 32768
    s_mul_i32 s91, s8, 114688
    s_mul_i32 s14, s23, 28672
    s_add_u32 s91, s91, s14
    s_and_b32 s14, s7, 1
    s_mul_i32 s14, s14, 14336
    s_add_u32 s91, s91, s14
    s_nop 0
    s_add_u32 s91, s91, 4194304
    ds_read_b64_tr_b16 v[96:97], v6 offset:0
    ds_read_b64_tr_b16 v[98:99], v6 offset:512
    ds_read_b64_tr_b16 v[100:101], v7 offset:0
    ds_read_b64_tr_b16 v[102:103], v7 offset:512
    ds_read_b64_tr_b16 v[104:105], v8 offset:0
    ds_read_b64_tr_b16 v[106:107], v8 offset:512
    ds_read_b64_tr_b16 v[108:109], v9 offset:0
    ds_read_b64_tr_b16 v[110:111], v9 offset:512
    ds_read_b64_tr_b16 v[112:113], v6 offset:4096
    ds_read_b64_tr_b16 v[114:115], v6 offset:4608
    ds_read_b64_tr_b16 v[116:117], v7 offset:4096
    ds_read_b64_tr_b16 v[118:119], v7 offset:4608
    ds_read_b64_tr_b16 v[120:121], v8 offset:4096
    ds_read_b64_tr_b16 v[122:123], v8 offset:4608
    ds_read_b64_tr_b16 v[124:125], v9 offset:4096
    ds_read_b64_tr_b16 v[126:127], v9 offset:4608
    ds_read_b64_tr_b16 v[128:129], v6 offset:8192
    ds_read_b64_tr_b16 v[130:131], v6 offset:8704
    ds_read_b64_tr_b16 v[132:133], v7 offset:8192
    ds_read_b64_tr_b16 v[134:135], v7 offset:8704
    ds_read_b64_tr_b16 v[136:137], v8 offset:8192
    ds_read_b64_tr_b16 v[138:139], v8 offset:8704
    ds_read_b64_tr_b16 v[140:141], v9 offset:8192
    ds_read_b64_tr_b16 v[142:143], v9 offset:8704
    ds_read_b64_tr_b16 v[144:145], v6 offset:12288
    ds_read_b64_tr_b16 v[146:147], v6 offset:12800
    ds_read_b64_tr_b16 v[148:149], v7 offset:12288
    ds_read_b64_tr_b16 v[150:151], v7 offset:12800
    ds_read_b64_tr_b16 v[152:153], v8 offset:12288
    ds_read_b64_tr_b16 v[154:155], v8 offset:12800
    ds_read_b64_tr_b16 v[156:157], v9 offset:12288
    ds_read_b64_tr_b16 v[158:159], v9 offset:12800
    ds_read_b64_tr_b16 v[160:161], v6 offset:16384
    ds_read_b64_tr_b16 v[162:163], v6 offset:16896
    ds_read_b64_tr_b16 v[164:165], v7 offset:16384
    ds_read_b64_tr_b16 v[166:167], v7 offset:16896
    ds_read_b64_tr_b16 v[168:169], v8 offset:16384
    ds_read_b64_tr_b16 v[170:171], v8 offset:16896
    ds_read_b64_tr_b16 v[172:173], v9 offset:16384
    ds_read_b64_tr_b16 v[174:175], v9 offset:16896
    ds_read_b64_tr_b16 v[176:177], v6 offset:20480
    ds_read_b64_tr_b16 v[178:179], v6 offset:20992
    ds_read_b64_tr_b16 v[180:181], v7 offset:20480
    ds_read_b64_tr_b16 v[182:183], v7 offset:20992
    ds_read_b64_tr_b16 v[184:185], v8 offset:20480
    ds_read_b64_tr_b16 v[186:187], v8 offset:20992
    ds_read_b64_tr_b16 v[188:189], v9 offset:20480
    ds_read_b64_tr_b16 v[190:191], v9 offset:20992
    s_waitcnt vmcnt(0)
    s_mov_b64 exec, 1
    s_cmp_lg_u32 s10, 0
    s_cbranch_scc1 Lslow_75
    buffer_store_dword v30, off, s[52:55], s56
Ljoin_76:
    s_mov_b64 exec, -1
    s_cmp_ge_u32 s6, 14
    s_cbranch_scc1 Lskipw_78
    buffer_load_dword v232, v18, s[52:55], s90 offen sc1
    ds_read_b64_tr_b16 v[192:193], v6 offset:24576
    ds_read_b64_tr_b16 v[194:195], v6 offset:25088
    ds_read_b64_tr_b16 v[196:197], v7 offset:24576
    ds_read_b64_tr_b16 v[198:199], v7 offset:25088
    ds_read_b64_tr_b16 v[200:201], v8 offset:24576
    ds_read_b64_tr_b16 v[202:203], v8 offset:25088
    ds_read_b64_tr_b16 v[204:205], v9 offset:24576
    ds_read_b64_tr_b16 v[206:207], v9 offset:25088
    v_lshrrev_b32 v237, 3, v0
    v_mul_u32_u24 v236, 1792, v237
    v_mul_u32_u24 v239, 144, v237
    v_and_b32 v237, 0x70, v1
    v_add3_u32 v236, v236, v237, s16
    s_mul_i32 s14, s7, 2304
    s_add_u32 s14, s14, 57344
    v_add3_u32 v239, v239, v237, s14
    v_and_b32_e64 v238, 15, v0
    v_mul_u32_u24 v238, 144, v238
    v_bfe_u32 v237, v0, 4, 1
    v_lshl_add_u32 v238, v237, 5, v238
    v_lshrrev_b32_e64 v237, 5, v0
    v_lshl_add_u32 v238, v237, 4, v238
    v_add_u32_e64 v238, s14, v238
    s_mov_b32 s15, 14336
Lpoll_79:
    buffer_load_dword v233, v18, s[52:55], s90 offen sc1
    s_waitcnt vmcnt(1)
    v_cmp_ne_u32 vcc, s9, v232
    s_cbranch_vccz Ldone_80
    buffer_load_dword v232, v18, s[52:55], s90 offen sc1
    s_waitcnt vmcnt(1)
    v_cmp_ne_u32 vcc, s9, v233
    s_cbranch_vccz Ldone_80
    s_sub_u32 s11, s11, 1
    s_cbranch_scc0 Lpoll_79
    s_mov_b32 s11, 0
Ldone_80:
    buffer_load_dwordx4 a[0:3], v1, s[52:55], s91 offen offset:0 sc1
    buffer_load_dwordx4 a[4:7], v1, s[52:55], s91 offen offset:1024 sc1
    buffer_load_dwordx4 a[8:11], v1, s[52:55], s91 offen offset:2048 sc1
    buffer_load_dwordx4 a[12:15], v1, s[52:55], s91 offen offset:3072 sc1
    s_add_u32 s91, s91, 4096
    buffer_load_dwordx4 a[16:19], v1, s[52:55], s91 offen offset:0 sc1
    s_waitcnt vmcnt(4) lgkmcnt(15)
    v_mfma_f32_16x16x32_bf16 v[32:35], v[96:99], a[0:3], v[32:35]
    buffer_load_dwordx4 a[20:23], v1, s[52:55], s91 offen offset:1024 sc1
    ds_read_b64_tr_b16 v[208:209], v6 offset:28672
    ds_read_b64_tr_b16 v[210:211], v6 offset:29184
    v_mfma_f32_16x16x32_bf16 v[36:39], v[100:103], a[0:3], v[36:39]
    ds_read_b64_tr_b16 v[212:213], v7 offset:28672
    ds_read_b64_tr_b16 v[214:215], v7 offset:29184
    v_mfma_f32_16x16x32_bf16 v[40:43], v[104:107], a[0:3], v[40:43]
    ds_read_b64_tr_b16 v[216:217], v8 offset:28672
    ds_read_b64_tr_b16 v[218:219], v8 offset:29184
    v_mfma_f32_16x16x32_bf16 v[44:47], v[108:111], a[0:3], v[44:47]
    ds_read_b64_tr_b16 v[220:221], v9 offset:28672
    ds_read_b64_tr_b16 v[222:223], v9 offset:29184
    s_waitcnt vmcnt(4)
    v_mfma_f32_16x16x32_bf16 v[32:35], v[112:115], a[4:7], v[32:35]
    buffer_load_dwordx4 a[24:27], v1, s[52:55], s91 offen offset:2048 sc1
    ds_read_b64_tr_b16 v[96:97], v6 offset:32768
    ds_read_b64_tr_b16 v[98:99], v6 offset:33280
    v_mfma_f32_16x16x32_bf16 v[36:39], v[116:119], a[4:7], v[36:39]
    ds_read_b64_tr_b16 v[100:101], v7 offset:32768
    ds_read_b64_tr_b16 v[102:103], v7 offset:33280
    v_mfma_f32_16x16x32_bf16 v[40:43], v[120:123], a[4:7], v[40:43]
    ds_read_b64_tr_b16 v[104:105], v8 offset:32768
    ds_read_b64_tr_b16 v[106:107], v8 offset:33280
    v_mfma_f32_16x16x32_bf16 v[44:47], v[124:127], a[4:7], v[44:47]
    ds_read_b64_tr_b16 v[108:109], v9 offset:32768
    ds_read_b64_tr_b16 v[110:111], v9 offset:33280
    s_waitcnt vmcnt(4)
    v_mfma_f32_16x16x32_bf16 v[32:35], v[128:131], a[8:11], v[32:35]
    buffer_load_dwordx4 a[28:31], v1, s[52:55], s91 offen offset:3072 sc1
    ds_read_b64_tr_b16 v[112:113], v6 offset:36864
    ds_read_b64_tr_b16 v[114:115], v6 offset:37376
    v_mfma_f32_16x16x32_bf16 v[36:39], v[132:135], a[8:11], v[36:39]
    ds_read_b64_tr_b16 v[116:117], v7 offset:36864
    ds_read_b64_tr_b16 v[118:119], v7 offset:37376
    v_mfma_f32_16x16x32_bf16 v[40:43], v[136:139], a[8:11], v[40:43]
    ds_read_b64_tr_b16 v[120:121], v8 offset:36864
    ds_read_b64_tr_b16 v[122:123], v8 offset:37376
    v_mfma_f32_16x16x32_bf16 v[44:47], v[140:143], a[8:11], v[44:47]
    ds_read_b64_tr_b16 v[124:125], v9 offset:36864
    ds_read_b64_tr_b16 v[126:127], v9 offset:37376
    s_waitcnt vmcnt(4)
    v_mfma_f32_16x16x32_bf16 v[32:35], v[144:147], a[12:15], v[32:35]
    s_add_u32 s91, s91, 4096
    buffer_load_dwordx4 a[32:35], v1, s[52:55], s91 offen offset:0 sc1
    ds_read_b64_tr_b16 v[128:129], v6 offset:40960
    ds_read_b64_tr_b16 v[130:131], v6 offset:41472
    v_mfma_f32_16x16x32_bf16 v[36:39], v[148:151], a[12:15], v[36:39]
    ds_read_b64_tr_b16 v[132:133], v7 offset:40960
    ds_read_b64_tr_b16 v[134:135], v7 offset:41472
    v_mfma_f32_16x16x32_bf16 v[40:43], v[152:155], a[12:15], v[40:43]
    ds_read_b64_tr_b16 v[136:137], v8 offset:40960
    ds_read_b64_tr_b16 v[138:139], v8 offset:41472
    v_mfma_f32_16x16x32_bf16 v[44:47], v[156:159], a[12:15], v[44:47]
    ds_read_b64_tr_b16 v[140:141], v9 offset:40960
    ds_read_b64_tr_b16 v[142:143], v9 offset:41472
    s_waitcnt vmcnt(4)
    v_mfma_f32_16x16x32_bf16 v[32:35], v[160:163], a[16:19], v[32:35]
    buffer_load_dwordx4 a[36:39], v1, s[52:55], s91 offen offset:1024 sc1
    ds_read_b64_tr_b16 v[144:145], v6 offset:45056
    ds_read_b64_tr_b16 v[146:147], v6 offset:45568
    v_mfma_f32_16x16x32_bf16 v[36:39], v[164:167], a[16:19], v[36:39]
    ds_read_b64_tr_b16 v[148:149], v7 offset:45056
    ds_read_b64_tr_b16 v[150:151], v7 offset:45568
    v_mfma_f32_16x16x32_bf16 v[40:43], v[168:171], a[16:19], v[40:43]
    ds_read_b64_tr_b16 v[152:153], v8 offset:45056
    ds_read_b64_tr_b16 v[154:155], v8 offset:45568
    v_mfma_f32_16x16x32_bf16 v[44:47], v[172:175], a[16:19], v[44:47]
    ds_read_b64_tr_b16 v[156:157], v9 offset:45056
    ds_read_b64_tr_b16 v[158:159], v9 offset:45568
    s_waitcnt vmcnt(4) lgkmcnt(15)
    v_mfma_f32_16x16x32_bf16 v[32:35], v[176:179], a[20:23], v[32:35]
    buffer_load_dwordx4 a[40:43], v1, s[52:55], s91 offen offset:2048 sc1
    ds_read_b64_tr_b16 v[160:161], v6 offset:49152
    ds_read_b64_tr_b16 v[162:163], v6 offset:49664
    v_mfma_f32_16x16x32_bf16 v[36:39], v[180:183], a[20:23], v[36:39]
    ds_read_b64_tr_b16 v[164:165], v7 offset:49152
    ds_read_b64_tr_b16 v[166:167], v7 offset:49664
    v_mfma_f32_16x16x32_bf16 v[40:43], v[184:187], a[20:23], v[40:43]
    ds_read_b64_tr_b16 v[168:169], v8 offset:49152
    ds_read_b64_tr_b16 v[170:171], v8 offset:49664
    v_mfma_f32_16x16x32_bf16 v[44:47], v[188:191], a[20:23], v[44:47]
    ds_read_b64_tr_b16 v[172:173], v9 offset:49152
    ds_read_b64_tr_b16 v[174:175], v9 offset:49664
    s_waitcnt vmcnt(4)
    v_mfma_f32_16x16x32_bf16 v[32:35], v[192:195], a[24:27], v[32:35]
    buffer_load_dwordx4 a[44:47], v1, s[52:55], s91 offen offset:3072 sc1
    ds_read_b64_tr_b16 v[176:177], v6 offset:53248
    ds_read_b64_tr_b16 v[178:179], v6 offset:53760
    v_mfma_f32_16x16x32_bf16 v[36:39], v[196:199], a[24:27], v[36:39]
    ds_read_b64_tr_b16 v[180:181], v7 offset:53248
    ds_read_b64_tr_b16 v[182:183], v7 offset:53760
    v_mfma_f32_16x16x32_bf16 v[40:43], v[200:203], a[24:27], v[40:43]
    ds_read_b64_tr_b16 v[184:185], v8 offset:53248
    ds_read_b64_tr_b16 v[186:187], v8 offset:53760
    v_mfma_f32_16x16x32_bf16 v[44:47], v[204:207], a[24:27], v[44:47]
    ds_read_b64_tr_b16 v[188:189], v9 offset:53248
    ds_read_b64_tr_b16 v[190:191], v9 offset:53760
    s_waitcnt vmcnt(4)
    v_mfma_f32_16x16x32_bf16 v[32:35], v[208:211], a[28:31], v[32:35]
    s_add_u32 s91, s91, 4096
    buffer_load_dwordx4 a[48:51], v1, s[52:55], s91 offen offset:0 sc1
    v_mfma_f32_16x16x32_bf16 v[36:39], v[212:215], a[28:31], v[36:39]
    v_mfma_f32_16x16x32_bf16 v[40:43], v[216:219], a[28:31], v[40:43]
    v_mfma_f32_16x16x32_bf16 v[44:47], v[220:223], a[28:31], v[44:47]
    s_waitcnt vmcnt(4)
    v_mfma_f32_16x16x32_bf16 v[32:35], v[96:99], a[32:35], v[32:35]
    buffer_load_dwordx4 a[52:55], v1, s[52:55], s91 offen offset:1024 sc1
    v_mfma_f32_16x16x32_bf16 v[36:39], v[100:103], a[32:35], v[36:39]
    v_mfma_f32_16x16x32_bf16 v[40:43], v[104:107], a[32:35], v[40:43]
    v_mfma_f32_16x16x32_bf16 v[44:47], v[108:111], a[32:35], v[44:47]
    s_waitcnt vmcnt(4)
    v_mfma_f32_16x16x32_bf16 v[32:35], v[112:115], a[36:39], v[32:35]
    v_mfma_f32_16x16x32_bf16 v[36:39], v[116:119], a[36:39], v[36:39]
    v_mfma_f32_16x16x32_bf16 v[40:43], v[120:123], a[36:39], v[40:43]
    v_mfma_f32_16x16x32_bf16 v[44:47], v[124:127], a[36:39], v[44:47]
    s_waitcnt vmcnt(3) lgkmcnt(15)
    v_mfma_f32_16x16x32_bf16 v[32:35], v[128:131], a[40:43], v[32:35]
    v_mfma_f32_16x16x32_bf16 v[36:39], v[132:135], a[40:43], v[36:39]
    v_mfma_f32_16x16x32_bf16 v[40:43], v[136:139], a[40:43], v[40:43]
    v_mfma_f32_16x16x32_bf16 v[44:47], v[140:143], a[40:43], v[44:47]
    s_waitcnt vmcnt(2)
    v_mfma_f32_16x16x32_bf16 v[32:35], v[144:147], a[44:47], v[32:35]
    v_mfma_f32_16x16x32_bf16 v[36:39], v[148:151], a[44:47], v[36:39]
    v_mfma_f32_16x16x32_bf16 v[40:43], v[152:155], a[44:47], v[40:43]
    v_mfma_f32_16x16x32_bf16 v[44:47], v[156:159], a[44:47], v[44:47]
    s_waitcnt vmcnt(1) lgkmcnt(8)
    v_mfma_f32_16x16x32_bf16 v[32:35], v[160:163], a[48:51], v[32:35]
    v_mfma_f32_16x16x32_bf16 v[36:39], v[164:167], a[48:51], v[36:39]
    v_mfma_f32_16x16x32_bf16 v[40:43], v[168:171], a[48:51], v[40:43]
    v_mfma_f32_16x16x32_bf16 v[44:47], v[172:175], a[48:51], v[44:47]
    s_waitcnt vmcnt(0) lgkmcnt(0)
    v_mfma_f32_16x16x32_bf16 v[32:35], v[176:179], a[52:55], v[32:35]
    v_mfma_f32_16x16x32_bf16 v[36:39], v[180:183], a[52:55], v[36:39]
    v_mfma_f32_16x16x32_bf16 v[40:43], v[184:187], a[52:55], v[40:43]
    v_mfma_f32_16x16x32_bf16 v[44:47], v[188:191], a[52:55], v[44:47]
    s_nop 4
    v_cvt_pk_bf16_f32 v144, v32, v33
    v_cvt_pk_bf16_f32 v145, v34, v35
    v_cvt_pk_bf16_f32 v146, v36, v37
    v_cvt_pk_bf16_f32 v147, v38, v39
    v_cvt_pk_bf16_f32 v148, v40, v41
    v_cvt_pk_bf16_f32 v149, v42, v43
    v_cvt_pk_bf16_f32 v150, v44, v45
    v_cvt_pk_bf16_f32 v151, v46, v47
    v_permlane16_swap_b32 v144, v146
    v_permlane16_swap_b32 v145, v147
    v_permlane16_swap_b32 v148, v150
    v_permlane16_swap_b32 v149, v151
    ds_write_b128 v238, v[144:147]
    ds_write_b128 v238, v[148:151] offset:64
    ds_read_b128 v[152:155], v239
    ds_read_b128 v[156:159], v239 offset:1152
    s_waitcnt lgkmcnt(1)
    buffer_store_dwordx4 v[152:155], v236, s[48:51], 0 offen
    s_waitcnt lgkmcnt(0)
    buffer_store_dwordx4 v[156:159], v236, s[48:51], s15 offen
Lskip_77:
L_fin:
    s_or_b32 s13, s2, s7
    s_cmp_eq_u32 s13, 0
    s_cselect_b32 s13, 0, 1073741824
    s_mov_b64 exec, 1
    buffer_store_dword v30, off, s[52:55], s13 sc1
    s_mov_b64 exec, -1
L_end:
    s_endpgm
Ls0retry_1:
    s_mov_b32 s69, 786432
    buffer_load_dwordx4 v[168:171], v176, s[52:55], s69 offen sc1
    s_mov_b32 s69, 786432
    buffer_load_dwordx4 v[172:175], v177, s[52:55], s69 offen sc1
    s_waitcnt vmcnt(0)
    v_cmp_ne_u32 s[66:67], s9, v175
    v_cmp_ne_u32 vcc, s9, v171
    s_and_b64 s[66:67], s[66:67], s[70:71]
    s_or_b64 vcc, vcc, s[66:67]
    s_cbranch_scc0 Ls0ok_2
    s_sub_u32 s11, s11, 1
    s_cbranch_scc0 Ls0retry_1
    s_mov_b32 s11, 0
    s_branch Ls0ok_2
Lhv_3:
    s_cmp_eq_u32 s7, 3
    s_cselect_b32 exec_hi, 0x0000ff00, exec_hi
    ds_write_b16 v31, v244
    ds_write_b16_d16_hi v31, v244 offset:8
    ds_write_b16 v31, v245 offset:16
    ds_write_b16_d16_hi v31, v245 offset:24
    s_branch Lhj_4
Ltabretry_5:
    s_lshl_b32 s69, s8, 7
    v_lshl_add_u32 v252, v0, 3, s69
    s_xor_b32 s69, s69, 128
    v_mov_b32_e64 v253, s6
    v_lshl_add_u32 v253, v253, 3, s69
    v_cmp_lt_u32_e64 vcc, 15, v0
    s_mov_b32 s69, 4096
    s_nop 0
    v_cndmask_b32 v252, v252, v253, vcc
    buffer_load_dwordx2 v[242:243], v252, s[52:55], s69 offen sc1
    s_waitcnt vmcnt(0)
    v_cmp_ne_u32 vcc, s9, v242
    s_cbranch_vccz Ltabok_6
    s_sub_u32 s11, s11, 1
    s_cbranch_scc0 Ltabretry_5
    s_mov_b32 s11, 0
    s_branch Ltabok_6
Lslow_7:
    buffer_store_dwordx2 v[144:145], v10, s[52:55], s56 offen offset:0 sc1
    buffer_store_dwordx2 v[146:147], v10, s[52:55], s56 offen offset:256 sc1
    buffer_store_dwordx2 v[148:149], v10, s[52:55], s56 offen offset:512 sc1
    buffer_store_dwordx2 v[150:151], v11, s[52:55], s56 offen offset:768 sc1
    s_branch Ljoin_8
Lslow_9:
    buffer_store_dword v30, off, s[52:55], s56 sc1
    s_branch Ljoin_10
Lskipw_12:
    s_waitcnt vmcnt(0) lgkmcnt(0)
    s_branch Lskip_11
Lslow_15:
    buffer_store_dwordx4 v[144:147], v14, s[48:51], 0 offen sc1
    buffer_store_dwordx4 v[148:151], v14, s[48:51], s88 offen sc1
    s_branch Ljoin_16
Lslow_17:
    buffer_store_dword v232, v15, s[52:55], s14 offen sc1
    s_branch Ljoin_18
Lslow_19:
    buffer_store_dword v30, off, s[52:55], s13 sc1
    s_branch Ljoin_20
Lslow_23:
    buffer_store_dwordx4 v[144:147], v1, s[52:55], s13 offen sc1
    s_branch Ljoin_24
Lkvretry_28:
    s_nop 7
    s_nop 7
    s_add_u32 s13, s56, 0
    buffer_load_dwordx4 v[184:187], v252, s[52:55], s13 offen offset:0 sc1
    buffer_load_dwordx4 v[188:191], v252, s[52:55], s13 offen offset:256 sc1
    buffer_load_dwordx4 v[192:195], v252, s[52:55], s13 offen offset:512 sc1
    buffer_load_dwordx4 v[196:199], v252, s[52:55], s13 offen offset:768 sc1
    s_add_u32 s13, s56, 4096
    buffer_load_dwordx4 v[200:203], v253, s[52:55], s13 offen offset:0 sc1
    buffer_load_dwordx4 v[204:207], v253, s[52:55], s13 offen offset:256 sc1
    buffer_load_dwordx4 v[208:211], v253, s[52:55], s13 offen offset:512 sc1
    buffer_load_dwordx4 v[212:215], v253, s[52:55], s13 offen offset:768 sc1
    s_waitcnt vmcnt(7)
    v_mfma_f32_16x16x32_bf16 v[112:115], v[76:79], v[184:187], 0
    v_xor_b32_e64 v240, v187, v241
    s_waitcnt vmcnt(6)
    v_mfma_f32_16x16x32_bf16 v[116:119], v[76:79], v[188:191], 0
    v_bitop3_b32 v240, v191, v241, v240 bitop3:0xbe
    s_waitcnt vmcnt(5)
    v_mfma_f32_16x16x32_bf16 v[120:123], v[76:79], v[192:195], 0
    v_bitop3_b32 v240, v195, v241, v240 bitop3:0xbe
    s_waitcnt vmcnt(4)
    v_mfma_f32_16x16x32_bf16 v[124:127], v[76:79], v[196:199], 0
    v_bitop3_b32 v240, v199, v241, v240 bitop3:0xbe
    s_waitcnt vmcnt(3)
    v_mfma_f32_16x16x32_bf16 v[112:115], v[76:79], v[200:203], v[112:115]
    v_bitop3_b32 v240, v203, v241, v240 bitop3:0xbe
    s_waitcnt vmcnt(2)
    v_mfma_f32_16x16x32_bf16 v[116:119], v[76:79], v[204:207], v[116:119]
    v_bitop3_b32 v240, v207, v241, v240 bitop3:0xbe
    s_waitcnt vmcnt(1)
    v_mfma_f32_16x16x32_bf16 v[120:123], v[76:79], v[208:211], v[120:123]
    v_bitop3_b32 v240, v211, v241, v240 bitop3:0xbe
    s_waitcnt vmcnt(0)
    v_mfma_f32_16x16x32_bf16 v[124:127], v[76:79], v[212:215], v[124:127]
    v_bitop3_b32 v240, v215, v241, v240 bitop3:0xbe
    v_cmp_lt_u32 vcc, 0xffff, v240
    s_nop 7
    s_cbranch_vccz Lkvback_29
    s_sub_u32 s11, s11, 1
    s_cbranch_scc0 Lkvretry_28
    s_mov_b32 s11, 0
    s_branch Lkvback_29
Lslow_30:
    buffer_store_dwordx2 v[144:145], v10, s[52:55], s56 offen offset:0 sc1
    buffer_store_dwordx2 v[146:147], v10, s[52:55], s56 offen offset:256 sc1
    buffer_store_dwordx2 v[148:149], v10, s[52:55], s56 offen offset:512 sc1
    buffer_store_dwordx2 v[150:151], v11, s[52:55], s56 offen offset:768 sc1
    s_branch Ljoin_31
Lslow_32:
    buffer_store_dword v30, off, s[52:55], s56 sc1
    s_branch Ljoin_33
Lskipw_35:
    s_waitcnt vmcnt(0) lgkmcnt(0)
    s_branch Lskip_34
Lslow_38:
    buffer_store_dwordx4 v[144:147], v14, s[48:51], 0 offen sc1
    buffer_store_dwordx4 v[148:151], v14, s[48:51], s88 offen sc1
    s_branch Ljoin_39
Lslow_40:
    buffer_store_dword v232, v15, s[52:55], s14 offen sc1
    s_branch Ljoin_41
Lslow_42:
    buffer_store_dword v30, off, s[52:55], s13 sc1
    s_branch Ljoin_43
Lhaloretry_46:
    s_nop 7
    buffer_load_dwordx2 v[252:253], v86, s[52:55], 0 offen sc1
    buffer_load_dwordx2 v[254:255], v12, s[52:55], 0 offen offset:256 sc1
    buffer_load_dwordx4 a[200:203], v85, s[52:55], 0 offen offset:0 sc1
    buffer_load_dwordx4 a[204:207], v85, s[52:55], 0 offen offset:512 sc1
    buffer_load_dwordx4 a[208:211], v85, s[52:55], 0 offen offset:1024 sc1
    buffer_load_dwordx4 a[212:215], v85, s[52:55], 0 offen offset:1536 sc1
    buffer_load_dwordx4 a[216:219], v85, s[52:55], 0 offen offset:2048 sc1
    buffer_load_dwordx4 a[220:223], v85, s[52:55], 0 offen offset:2560 sc1
    buffer_load_dwordx4 a[224:227], v85, s[52:55], 0 offen offset:3072 sc1
    buffer_load_dwordx4 a[228:231], v85, s[52:55], 0 offen offset:3584 sc1
    s_mov_b32 s69, 4096
    buffer_load_dwordx4 a[232:235], v85, s[52:55], s69 offen offset:0 sc1
    s_mov_b32 s69, 4096
    buffer_load_dwordx4 a[236:239], v85, s[52:55], s69 offen offset:512 sc1
    s_mov_b32 s69, 4096
    buffer_load_dwordx4 a[240:243], v85, s[52:55], s69 offen offset:1024 sc1
    s_mov_b32 s69, 4096
    buffer_load_dwordx4 a[244:247], v85, s[52:55], s69 offen offset:1536 sc1
    s_mov_b32 s69, 4096
    buffer_load_dwordx4 a[248:251], v85, s[52:55], s69 offen offset:2048 sc1
    s_mov_b32 s69, 4096
    buffer_load_dwordx4 a[252:255], v85, s[52:55], s69 offen offset:2560 sc1
    s_waitcnt vmcnt(0) lgkmcnt(0)
    ds_read_b64_tr_b16 a[0:1], v4 offset:0
    ds_read_b64_tr_b16 a[2:3], v4 offset:256
    ds_read_b64_tr_b16 a[4:5], v4 offset:2048
    ds_read_b64_tr_b16 a[6:7], v4 offset:2304
    ds_read_b64_tr_b16 a[8:9], v4 offset:4096
    ds_read_b64_tr_b16 a[10:11], v4 offset:4352
    ds_read_b64_tr_b16 a[12:13], v4 offset:6144
    ds_read_b64_tr_b16 a[14:15], v4 offset:6400
    v_add_f32 v242, v252, v254
    v_add_f32_e64 v243, v253, v255
    v_max3_u32 v232, v252, v253, v254
    v_max_u32 v232, v232, v255
    s_waitcnt lgkmcnt(6)
    v_mfma_f32_16x16x32_bf16 v[244:247], a[0:3], a[200:203], 0
    ds_read_b64_tr_b16 a[16:17], v4 offset:8192
    ds_read_b64_tr_b16 a[18:19], v4 offset:8448
    v_accvgpr_read_b32 v233, a203
    v_permlane32_swap_b32 v242, v243
    v_max_u32_e64 v232, v232, v233
    s_waitcnt lgkmcnt(6)
    v_mfma_f32_16x16x32_bf16 v[244:247], a[4:7], a[204:207], v[244:247]
    ds_read_b64_tr_b16 a[20:21], v4 offset:10240
    ds_read_b64_tr_b16 a[22:23], v4 offset:10496
    v_accvgpr_read_b32 v233, a207
    v_add_f32_e64 v242, v242, v243
    v_max_u32 v232, v232, v233
    s_waitcnt lgkmcnt(6)
    v_mfma_f32_16x16x32_bf16 v[244:247], a[8:11], a[208:211], v[244:247]
    ds_read_b64_tr_b16 a[24:25], v4 offset:12288
    ds_read_b64_tr_b16 a[26:27], v4 offset:12544
    v_accvgpr_read_b32 v233, a211
    v_mov_b32_e64 v243, v242
    v_max_u32 v232, v232, v233
    s_waitcnt lgkmcnt(6)
    v_mfma_f32_16x16x32_bf16 v[244:247], a[12:15], a[212:215], v[244:247]
    ds_read_b64_tr_b16 a[28:29], v4 offset:14336
    ds_read_b64_tr_b16 a[30:31], v4 offset:14592
    v_accvgpr_read_b32 v233, a215
    v_permlane16_swap_b32 v242, v243
    v_max_u32_e64 v232, v232, v233
    s_waitcnt lgkmcnt(6)
    v_mfma_f32_16x16x32_bf16 v[244:247], a[16:19], a[216:219], v[244:247]
    ds_read_b64_tr_b16 a[32:33], v4 offset:16384
    ds_read_b64_tr_b16 a[34:35], v4 offset:16640
    v_accvgpr_read_b32 v233, a219
    v_add_f32_e64 v242, v242, v243
    v_max_u32 v232, v232, v233
    s_waitcnt lgkmcnt(6)
    v_mfma_f32_16x16x32_bf16 v[244:247], a[20:23], a[220:223], v[244:247]
    ds_read_b64_tr_b16 a[36:37], v4 offset:18432
    ds_read_b64_tr_b16 a[38:39], v4 offset:18688
    v_accvgpr_read_b32 v233, a223
    v_mov_b32_e64 v243, v242
    v_max_u32 v232, v232, v233
    s_waitcnt lgkmcnt(6)
    v_mfma_f32_16x16x32_bf16 v[244:247], a[24:27], a[224:227], v[244:247]
    ds_read_b64_tr_b16 a[40:41], v4 offset:20480
    ds_read_b64_tr_b16 a[42:43], v4 offset:20736
    v_accvgpr_read_b32 v233, a227
    v_permlane32_swap_b32 v242, v243
    v_max_u32_e64 v232, v232, v233
    s_waitcnt lgkmcnt(6)
    v_mfma_f32_16x16x32_bf16 v[244:247], a[28:31], a[228:231], v[244:247]
    ds_read_b64_tr_b16 a[44:45], v4 offset:22528
    ds_read_b64_tr_b16 a[46:47], v4 offset:22784
    v_accvgpr_read_b32 v233, a231
    v_mul_f32 v242, 0x3b124925, v242
    v_max_u32 v232, v232, v233
    s_waitcnt lgkmcnt(6)
    v_mfma_f32_16x16x32_bf16 v[244:247], a[32:35], a[232:235], v[244:247]
    ds_read_b64_tr_b16 a[48:49], v4 offset:24576
    ds_read_b64_tr_b16 a[50:51], v4 offset:24832
    v_accvgpr_read_b32 v233, a235
    v_mul_f32 v243, 0x3b124925, v243
    v_max_u32 v232, v232, v233
    s_waitcnt lgkmcnt(6)
    v_mfma_f32_16x16x32_bf16 v[244:247], a[36:39], a[236:239], v[244:247]
    ds_read_b64_tr_b16 a[52:53], v4 offset:26624
    ds_read_b64_tr_b16 a[54:55], v4 offset:26880
    v_accvgpr_read_b32 v233, a239
    v_fma_f32 v243, -v242, v242, v243
    v_max_u32 v232, v232, v233
    s_waitcnt lgkmcnt(6)
    v_mfma_f32_16x16x32_bf16 v[244:247], a[40:43], a[240:243], v[244:247]
    v_accvgpr_read_b32 v233, a243
    v_max_f32_e64 v243, 0, v243
    v_max_u32 v232, v232, v233
    s_waitcnt lgkmcnt(4)
    v_mfma_f32_16x16x32_bf16 v[244:247], a[44:47], a[244:247], v[244:247]
    v_accvgpr_read_b32 v233, a247
    v_add_f32 v243, 0x3727c5ac, v243
    v_max_u32 v232, v232, v233
    s_waitcnt lgkmcnt(2)
    v_mfma_f32_16x16x32_bf16 v[244:247], a[48:51], a[248:251], v[244:247]
    v_accvgpr_read_b32 v233, a251
    v_rsq_f32_e64 v240, v243
    v_max_u32 v232, v232, v233
    s_waitcnt lgkmcnt(0)
    v_mfma_f32_16x16x32_bf16 v[244:247], a[52:55], a[252:255], v[244:247]
    v_accvgpr_read_b32 v233, a255
    v_mul_f32 v241, v240, v242
    v_max_u32 v232, v232, v233
    v_cmp_eq_u32 vcc, -1, v232
    s_nop 7
    s_cbranch_vccz Lhalook_47
    s_sub_u32 s11, s11, 1
    s_cbranch_scc0 Lhaloretry_46
    s_mov_b32 s11, 0
    s_branch Lhalook_47
Lhv_48:
    s_cmp_eq_u32 s7, 3
    s_cselect_b32 exec_hi, 0x0000ff00, exec_hi
    ds_write_b16 v31, v244
    ds_write_b16_d16_hi v31, v244 offset:8
    ds_write_b16 v31, v245 offset:16
    ds_write_b16_d16_hi v31, v245 offset:24
    s_branch Lhj_49
Lslow_50:
    buffer_store_dwordx2 v[144:145], v10, s[52:55], s56 offen offset:0 sc1
    buffer_store_dwordx2 v[146:147], v10, s[52:55], s56 offen offset:256 sc1
    buffer_store_dwordx2 v[148:149], v10, s[52:55], s56 offen offset:512 sc1
    buffer_store_dwordx2 v[150:151], v11, s[52:55], s56 offen offset:768 sc1
    s_branch Ljoin_51
Lslow_52:
    buffer_store_dword v30, off, s[52:55], s56 sc1
    s_branch Ljoin_53
Lskipw_55:
    s_waitcnt vmcnt(0) lgkmcnt(0)
    ds_write_b128 v254, a[164:167] offset:53248
    ds_write_b128 v255, a[168:171] offset:0
    ds_write_b128 v255, a[172:175] offset:4096
    ds_write_b128 v255, a[176:179] offset:8192
    ds_write_b128 v255, a[180:183] offset:12288
    ds_write_b128 v255, a[184:187] offset:16384
    ds_write_b128 v255, a[188:191] offset:20480
    ds_write_b128 v255, a[192:195] offset:24576
    ds_write_b128 v254, a[196:199] offset:0
    ds_write_b128 v254, a[116:119] offset:4096
    ds_write_b128 v254, a[120:123] offset:8192
    ds_write_b128 v254, a[124:127] offset:12288
    ds_write_b128 v254, a[128:131] offset:16384
    ds_write_b128 v254, a[132:135] offset:20480
    ds_write_b128 v254, a[136:139] offset:24576
    s_branch Lskip_54
Lslow_58:
    buffer_store_dwordx4 v[144:147], v14, s[48:51], 0 offen sc1
    buffer_store_dwordx4 v[148:151], v14, s[48:51], s88 offen sc1
    s_branch Ljoin_59
Lslow_60:
    buffer_store_dword v232, v15, s[52:55], s14 offen sc1
    s_branch Ljoin_61
Lslow_62:
    buffer_store_dword v30, off, s[52:55], s13 sc1
    s_branch Ljoin_63
Lslow_66:
    buffer_store_dwordx4 v[144:147], v1, s[52:55], s13 offen sc1
    s_branch Ljoin_67
Lkvretry_71:
    s_nop 7
    s_nop 7
    s_add_u32 s13, s56, 0
    buffer_load_dwordx4 v[184:187], v252, s[52:55], s13 offen offset:0 sc1
    buffer_load_dwordx4 v[188:191], v252, s[52:55], s13 offen offset:256 sc1
    buffer_load_dwordx4 v[192:195], v252, s[52:55], s13 offen offset:512 sc1
    buffer_load_dwordx4 v[196:199], v252, s[52:55], s13 offen offset:768 sc1
    s_add_u32 s13, s56, 4096
    buffer_load_dwordx4 v[200:203], v253, s[52:55], s13 offen offset:0 sc1
    buffer_load_dwordx4 v[204:207], v253, s[52:55], s13 offen offset:256 sc1
    buffer_load_dwordx4 v[208:211], v253, s[52:55], s13 offen offset:512 sc1
    buffer_load_dwordx4 v[212:215], v253, s[52:55], s13 offen offset:768 sc1
    s_waitcnt vmcnt(7)
    v_mfma_f32_16x16x32_bf16 v[112:115], v[76:79], v[184:187], 0
    v_xor_b32_e64 v240, v187, v241
    s_waitcnt vmcnt(6)
    v_mfma_f32_16x16x32_bf16 v[116:119], v[76:79], v[188:191], 0
    v_bitop3_b32 v240, v191, v241, v240 bitop3:0xbe
    s_waitcnt vmcnt(5)
    v_mfma_f32_16x16x32_bf16 v[120:123], v[76:79], v[192:195], 0
    v_bitop3_b32 v240, v195, v241, v240 bitop3:0xbe
    s_waitcnt vmcnt(4)
    v_mfma_f32_16x16x32_bf16 v[124:127], v[76:79], v[196:199], 0
    v_bitop3_b32 v240, v199, v241, v240 bitop3:0xbe
    s_waitcnt vmcnt(3)
    v_mfma_f32_16x16x32_bf16 v[112:115], v[76:79], v[200:203], v[112:115]
    v_bitop3_b32 v240, v203, v241, v240 bitop3:0xbe
    s_waitcnt vmcnt(2)
    v_mfma_f32_16x16x32_bf16 v[116:119], v[76:79], v[204:207], v[116:119]
    v_bitop3_b32 v240, v207, v241, v240 bitop3:0xbe
    s_waitcnt vmcnt(1)
    v_mfma_f32_16x16x32_bf16 v[120:123], v[76:79], v[208:211], v[120:123]
    v_bitop3_b32 v240, v211, v241, v240 bitop3:0xbe
    s_waitcnt vmcnt(0)
    v_mfma_f32_16x16x32_bf16 v[124:127], v[76:79], v[212:215], v[124:127]
    v_bitop3_b32 v240, v215, v241, v240 bitop3:0xbe
    v_cmp_lt_u32 vcc, 0xffff, v240
    s_nop 7
    s_cbranch_vccz Lkvback_72
    s_sub_u32 s11, s11, 1
    s_cbranch_scc0 Lkvretry_71
    s_mov_b32 s11, 0
    s_branch Lkvback_72
Lslow_73:
    buffer_store_dwordx2 v[144:145], v10, s[52:55], s56 offen offset:0 sc1
    buffer_store_dwordx2 v[146:147], v10, s[52:55], s56 offen offset:256 sc1
    buffer_store_dwordx2 v[148:149], v10, s[52:55], s56 offen offset:512 sc1
    buffer_store_dwordx2 v[150:151], v11, s[52:55], s56 offen offset:768 sc1
    s_branch Ljoin_74
Lslow_75:
    buffer_store_dword v30, off, s[52:55], s56 sc1
    s_branch Ljoin_76
Lskipw_78:
    s_waitcnt vmcnt(0) lgkmcnt(0)
    s_branch Lskip_77
L_code_end:
    s_endpgm
.section .rodata,"a"
.p2align 6
.amdhsa_kernel interleave_layers__sliding_local_dilated__linear_kernel_hedgehog__prompt_kernel
  .amdhsa_next_free_vgpr 512
  .amdhsa_next_free_sgpr 102
  .amdhsa_accum_offset 256
  .amdhsa_group_segment_fixed_size 0
  .amdhsa_kernarg_size 80
  .amdhsa_user_sgpr_count 2
  .amdhsa_user_sgpr_kernarg_segment_ptr 1
  .amdhsa_system_sgpr_workgroup_id_x 1
.end_amdhsa_kernel
```
